```python
import torch

def _softmax(x, axis=-1):
    return torch.softmax(x, dim=axis)

def _gelu(x):
    return torch.nn.functional.gelu(x, approximate='tanh')

def _silu(x):
    return torch.nn.functional.silu(x)

def _sigmoid(x):
    return torch.sigmoid(x)

def _layernorm(x, axis=-1, eps=1e-05):
    m = x.mean(dim=axis, keepdim=True)
    v = x.var(dim=axis, keepdim=True, unbiased=False)
    return (x - m) / torch.sqrt(v + eps)

def _scatter_add(tgt, idx, src, axis=0):
    return tgt.clone().index_add_(axis, idx, src)

def _segment_sum(src, seg, n):
    out = torch.zeros((n,) + src.shape[1:], dtype=src.dtype)
    return out.index_add_(0, seg, src)

def _pad(x, pw):
    flat = tuple((v for pair in reversed(pw) for v in pair))
    return torch.nn.functional.pad(x, flat)
kernel_name = 'parallel_sum__memory_aug_recurrent_mem_tr__dense_activation_silu__prompt'

def setup_inputs():

    _w = lambda a: (lambda t: t.to(torch.bfloat16) if t.is_floating_point() else t)(torch.as_tensor(a))

    def _A_setup():
        B, S, Dm = (1, 2048, 512)
        H, Dh = (32, 128)
        M, seg = (8, 32)
        seg = min(seg, S)
        S = S // seg * seg
        return {'x': _w((lambda *s: torch.randn(*s, dtype=torch.bfloat16) * 0.05)(B, S, Dm)), 'mem0': _w((lambda *s: torch.randn(*s, dtype=torch.bfloat16) * 0.4)(B, M, Dm)), 'Wq': _w((lambda *s: torch.randn(*s, dtype=torch.bfloat16) * 3.2)(Dm, H, Dh) * Dm ** (-0.5)), 'Wk': _w((lambda *s: torch.randn(*s, dtype=torch.bfloat16) * 3.2)(Dm, H, Dh) * Dm ** (-0.5)), 'Wv': _w((lambda *s: torch.randn(*s, dtype=torch.bfloat16) * 0.4)(Dm, H, Dh) * Dm ** (-0.5)), 'Wo': _w((lambda *s: torch.randn(*s, dtype=torch.bfloat16) * 0.4)(H, Dh, Dm) * (H * Dh) ** (-0.5)), 'seg_len': seg}
    _A_in = _A_setup()

    def _B_setup():
        B, S, D, F = (1, 2048, 512, 1792)
        return {'x': _w((lambda *s: torch.randn(*s, dtype=torch.bfloat16) * 0.05)(B, S, D)), 'w1': _w((lambda *s: torch.randn(*s, dtype=torch.bfloat16) * 1.6)(D, F) * D ** (-0.5)), 'w2': _w((lambda *s: torch.randn(*s, dtype=torch.bfloat16) * 0.1)(F, D) * F ** (-0.5))}
    _B_in = _B_setup()
    return {'A_x': _A_in['x'], 'A_mem0': _A_in['mem0'], 'A_Wq': _A_in['Wq'], 'A_Wk': _A_in['Wk'], 'A_Wv': _A_in['Wv'], 'A_Wo': _A_in['Wo'], 'A_seg_len': _A_in['seg_len'], 'B_x': _B_in['x'], 'B_w1': _B_in['w1'], 'B_w2': _B_in['w2']}

def reference(A_x, A_mem0, A_Wq, A_Wk, A_Wv, A_Wo, A_seg_len, B_x, B_w1, B_w2):

    def _A_ref(x, mem0, Wq, Wk, Wv, Wo, seg_len):
        B, S, Dm = x.shape
        H, Dh = (Wq.shape[1], Wq.shape[2])
        M = mem0.shape[1]
        scale = Dh ** (-0.5)
        n_seg = S // seg_len
        L = M + seg_len
        idx = torch.arange(L)
        mask = (idx[:, None] < M) | (idx[:, None] >= idx[None, :])
        mem = mem0
        outs = []
        for s in range(n_seg):
            xs = x[:, s * seg_len:(s + 1) * seg_len, :].clone()
            h = torch.concatenate([mem, xs], axis=1)
            q = torch.einsum('btd,dhe->bhte', h, Wq)
            k = torch.einsum('btd,dhe->bhte', h, Wk)
            v = torch.einsum('btd,dhe->bhte', h, Wv)
            scores = torch.einsum('bhqe,bhke->bhqk', q, k) * scale
            scores = torch.where(mask[None, None], scores, -1000000000.0)
            p = _softmax(scores, axis=-1)
            o = torch.einsum('bhqk,bhke->bhqe', p, v)
            o = torch.einsum('bhte,hed->btd', o, Wo)
            mem = o[:, :M, :].clone()
            outs.append(o[:, M:, :])
        return torch.concatenate(outs, axis=1)

    def _B_ref(x, w1, w2):
        h = torch.einsum('bsd,df->bsf', x, w1)
        h = _silu(h)
        out = torch.einsum('bsf,fd->bsd', h, w2)
        return out
    x = A_x
    xn = _layernorm(x, axis=-1)
    return x + _A_ref(xn, A_mem0, A_Wq, A_Wk, A_Wv, A_Wo, A_seg_len) + _B_ref(xn, B_w1, B_w2)
```

```asm
; @launch grid=(256,1,1) block=(256,1,1) lds=163840
.amdgcn_target "amdgcn-amd-amdhsa--gfx950"
.text
.globl parallel_sum__memory_aug_recurrent_mem_tr__dense_activation_silu__prompt_kernel
.p2align 8
.type parallel_sum__memory_aug_recurrent_mem_tr__dense_activation_silu__prompt_kernel,@function
parallel_sum__memory_aug_recurrent_mem_tr__dense_activation_silu__prompt_kernel:
    s_load_dwordx16 s[64:79], s[0:1], 0
    s_load_dwordx8 s[80:87], s[0:1], 64
    s_load_dwordx2 s[88:89], s[0:1], 96
    s_getreg_b32 s90, hwreg(HW_REG_XCC_ID)
    s_and_b32 s90, s90, 7
    s_waitcnt lgkmcnt(0)
    s_mov_b32 s36, s64
    s_and_b32 s37, s65, 0xffff
    s_mov_b32 s38, 2097152
    s_mov_b32 s39, 0x20000
    s_mov_b32 s32, s66
    s_and_b32 s33, s67, 0xffff
    s_mov_b32 s34, 8192
    s_mov_b32 s35, 0x20000
    s_mov_b32 s16, s68
    s_and_b32 s17, s69, 0xffff
    s_mov_b32 s18, 4194304
    s_mov_b32 s19, 0x20000
    s_mov_b32 s20, s70
    s_and_b32 s21, s71, 0xffff
    s_mov_b32 s22, 4194304
    s_mov_b32 s23, 0x20000
    s_mov_b32 s24, s72
    s_and_b32 s25, s73, 0xffff
    s_mov_b32 s26, 4194304
    s_mov_b32 s27, 0x20000
    s_mov_b32 s28, s74
    s_and_b32 s29, s75, 0xffff
    s_mov_b32 s30, 4194304
    s_mov_b32 s31, 0x20000
    s_mov_b32 s40, s80
    s_and_b32 s41, s81, 0xffff
    s_mov_b32 s42, 1835008
    s_mov_b32 s43, 0x20000
    s_mov_b32 s44, s82
    s_and_b32 s45, s83, 0xffff
    s_mov_b32 s46, 1835008
    s_mov_b32 s47, 0x20000
    s_mov_b32 s48, s84
    s_and_b32 s49, s85, 0xffff
    s_mov_b32 s50, 2097152
    s_mov_b32 s51, 0x20000
    s_mov_b32 s12, s86
    s_and_b32 s13, s87, 0xffff
    s_mov_b32 s14, 256
    s_mov_b32 s15, 0x20000
    s_mov_b32 s8, s88
    s_and_b32 s9, s89, 0xffff
    s_mov_b32 s10, 268435456
    s_mov_b32 s11, 0x20000
    s_mov_b32 s66, s90
    v_lshrrev_b32 v1, 6, v0
    s_nop 0
    v_readfirstlane_b32 s92, v1
    s_nop 0
    s_cmp_lg_u32 s92, 0
    s_cbranch_scc1 L_role_skip
    s_mov_b64 exec, 1
    s_mov_b32 s93, 0
    v_mov_b32 v3, 0
L_role_try:
    s_lshl_b32 s91, s90, 2
    v_mov_b32 v1, 1
    v_mov_b32 v2, s91
    buffer_atomic_add v1, v2, s[12:15], 0 offen sc0
    s_waitcnt vmcnt(0)
    v_readfirstlane_b32 s91, v1
    s_nop 0
    s_cmp_lt_u32 s91, 32
    s_cbranch_scc1 L_role_got
L_role_scan:
    buffer_load_dwordx4 v[4:7], v3, s[12:15], 0 offen sc1
    buffer_load_dwordx4 v[8:11], v3, s[12:15], 0 offen offset:16 sc1
    s_waitcnt vmcnt(0)
    s_mov_b32 s90, 8
    s_mov_b32 s94, 0
    v_readfirstlane_b32 s92, v11
    s_nop 0
    s_min_u32 s95, s92, 64
    s_add_u32 s94, s94, s95
    s_cmp_lt_u32 s92, 32
    s_cselect_b32 s90, 7, s90
    v_readfirstlane_b32 s92, v10
    s_nop 0
    s_min_u32 s95, s92, 64
    s_add_u32 s94, s94, s95
    s_cmp_lt_u32 s92, 32
    s_cselect_b32 s90, 6, s90
    v_readfirstlane_b32 s92, v9
    s_nop 0
    s_min_u32 s95, s92, 64
    s_add_u32 s94, s94, s95
    s_cmp_lt_u32 s92, 32
    s_cselect_b32 s90, 5, s90
    v_readfirstlane_b32 s92, v8
    s_nop 0
    s_min_u32 s95, s92, 64
    s_add_u32 s94, s94, s95
    s_cmp_lt_u32 s92, 32
    s_cselect_b32 s90, 4, s90
    v_readfirstlane_b32 s92, v7
    s_nop 0
    s_min_u32 s95, s92, 64
    s_add_u32 s94, s94, s95
    s_cmp_lt_u32 s92, 32
    s_cselect_b32 s90, 3, s90
    v_readfirstlane_b32 s92, v6
    s_nop 0
    s_min_u32 s95, s92, 64
    s_add_u32 s94, s94, s95
    s_cmp_lt_u32 s92, 32
    s_cselect_b32 s90, 2, s90
    v_readfirstlane_b32 s92, v5
    s_nop 0
    s_min_u32 s95, s92, 64
    s_add_u32 s94, s94, s95
    s_cmp_lt_u32 s92, 32
    s_cselect_b32 s90, 1, s90
    v_readfirstlane_b32 s92, v4
    s_nop 0
    s_min_u32 s95, s92, 64
    s_add_u32 s94, s94, s95
    s_cmp_lt_u32 s92, 32
    s_cselect_b32 s90, 0, s90
    s_cmp_eq_u32 s90, 8
    s_cbranch_scc1 L_role_got
    s_cmp_ge_u32 s94, 256
    s_cbranch_scc1 L_role_try
    s_add_u32 s93, s93, 1
    s_cmp_gt_u32 s93, 2000
    s_cbranch_scc1 L_role_try
    s_sleep 32
    s_branch L_role_scan
L_role_got:
    s_and_b32 s90, s90, 7
    s_lshl_b32 s92, s90, 16
    s_min_u32 s91, s91, 64
    s_or_b32 s92, s92, s91
    v_mov_b32 v1, s92
    ds_write_b32 v3, v1
    s_waitcnt lgkmcnt(0)
    s_mov_b64 exec, -1
L_role_skip:
    s_barrier
    v_mov_b32 v2, 0
    ds_read_b32 v1, v2
    s_waitcnt lgkmcnt(0)
    v_readfirstlane_b32 s91, v1
    s_nop 0
    s_lshr_b32 s90, s91, 16
    s_and_b32 s91, s91, 0xffff
    s_barrier
    s_lshl_b32 s95, s90, 5
    s_add_u32 s95, s95, s91
    s_cmp_ge_u32 s91, 32
    s_cbranch_scc1 L_exit
    v_mov_b32 v2, 0
    s_cmp_lg_u32 s90, 0
    s_cbranch_scc1 L_worker
    s_mov_b32 s52, s91
    v_lshrrev_b32 v104, 6, v0
    s_nop 0
    v_readfirstlane_b32 s53, v104
    v_and_b32 v105, 63, v0
    v_and_b32 v106, 15, v0
    v_bfe_u32 v107, v0, 4, 2
    v_lshlrev_b32 v0, 4, v105
    v_bfe_u32 v108, v106, 1, 1
    v_mul_u32_u24 v109, 0xAAAA, v108
    v_add_u32 v1, 0x4444, v109
    v_lshlrev_b32 v109, 8, v107
    v_lshl_add_u32 v109, v108, 7, v109
    v_lshrrev_b32 v110, 2, v106
    v_lshl_add_u32 v109, v110, 5, v109
    v_and_b32 v110, 1, v106
    v_lshl_add_u32 v2, v110, 4, v109
    s_lshl_b32 s63, s53, 12
    s_add_u32 s63, s63, 16384
    v_add_u32 v3, s63, v0
    v_xor_b32 v4, 0x1000, v3
    s_lshl_b32 s63, s53, 15
    s_add_u32 s63, s63, 32768
    v_add_u32 v8, s63, v0
    s_lshl_b32 s63, s52, 6
    s_lshl_b32 s64, s53, 14
    s_add_u32 s63, s63, s64
    v_lshrrev_b32 v109, 3, v106
    v_lshl_add_u32 v109, v107, 1, v109
    v_lshlrev_b32 v109, 11, v109
    v_and_b32 v110, 7, v106
    v_lshl_add_u32 v109, v110, 3, v109
    v_add_u32 v5, s63, v109
    s_lshl_b32 s63, s52, 11
    s_lshl_b32 s64, s53, 16
    s_add_u32 s63, s63, s64
    v_add_u32 v6, s63, v0
    s_lshl_b32 s63, s53, 11
    s_lshl_b32 s64, s52, 5
    s_add_u32 s63, s63, s64
    s_and_b32 s64, s52, 6
    v_bfe_u32 v110, v106, 2, 1
    v_add_u32 v111, s64, v110
    v_lshlrev_b32 v109, 4, v110
    v_lshl_add_u32 v109, v108, 10, v109
    v_lshl_add_u32 v109, v107, 2, v109
    v_add_u32 v109, s63, v109
    v_and_b32 v110, 9, v106
    v_cmp_eq_u32 vcc, 0, v110
    v_mov_b32 v110, 0x40000000
    s_nop 0
    v_cndmask_b32 v7, v110, v109, vcc
    s_lshl_b32 s63, s53, 8
    s_lshr_b32 s64, s52, 3
    s_lshl_b32 s64, s64, 5
    s_add_u32 s63, s63, s64
    s_and_b32 s64, s52, 1
    s_lshl_b32 s64, s64, 4
    s_add_u32 s63, s63, s64
    v_lshlrev_b32 v111, 10, v111
    v_lshl_add_u32 v111, v108, 7, v111
    v_lshl_add_u32 v111, v107, 2, v111
    v_add_u32 v111, s63, v111
    buffer_load_dword v112, v111, s[32:35], 0 offen
    v_bfe_u32 v109, v106, 2, 1
    v_lshlrev_b32 v109, 4, v109
    v_mov_b32 v110, 0x3F80
    v_lshlrev_b32 v9, v109, v110
    v_and_b32 v109, 1, v106
    v_lshlrev_b32 v109, 4, v109
    v_lshlrev_b32 v109, v109, v110
    v_lshrrev_b32 v110, 2, v106
    v_cmp_eq_u32 vcc, v110, v107
    v_mov_b32 v17, 0
    v_mov_b32 v18, 0
    v_cndmask_b32 v16, 0, v109, vcc
    v_mov_b32 v19, v16
    v_mov_b32 v20, 0x3F803F80
    v_mov_b32 v21, 0x3F803F80
    v_mov_b32 v22, 0x3F803F80
    v_mov_b32 v23, 0x3F803F80
    v_mov_b32 v14, 0
    v_mov_b32 v15, 0
    v_mov_b32 v48, 0
    v_mov_b32 v49, 0
    v_mov_b32 v50, 0
    v_mov_b32 v51, 0
    s_mov_b32 s68, 0xCCCCCCCC
    s_mov_b32 s69, 0xCCCCCCCC
    s_mov_b32 s78, 0x3e0293ee
    s_mov_b32 s79, 0x3e0293ee
    s_mov_b32 s86, 0xffbfffbf
    s_mov_b32 s87, 0x5d800000
    s_mov_b32 s70, 0x11111111
    s_mov_b32 s71, 0x11111111
    s_mov_b32 s72, 0x44444444
    s_mov_b32 s73, 0x44444444
    s_mov_b32 s74, 0x22222222
    s_mov_b32 s75, 0x22222222
    s_mov_b32 s76, 0x88888888
    s_mov_b32 s77, 0x88888888
    v_bfe_u32 v113, v106, 2, 1
    v_bfe_u32 v114, v106, 3, 1
    v_lshrrev_b32 v109, 1, v107
    v_lshlrev_b32 v116, 4, v109
    v_and_b32 v109, 1, v107
    v_lshl_add_u32 v116, v109, 2, v116
    v_add_u32 v116, v116, v113
    v_lshl_add_u32 v116, v114, 3, v116
    v_lshl_add_u32 v115, v109, 1, v113
    v_lshl_add_u32 v115, v114, 2, v115
    s_lshl_b32 s63, s53, 1
    v_xor_b32 v109, s63, v115
    v_lshlrev_b32 v109, 5, v109
    v_lshl_add_u32 v109, v116, 8, v109
    v_and_b32 v110, 3, v106
    v_lshl_add_u32 v109, v110, 3, v109
    v_add_u32 v52, 32768, v109
    v_xor_b32 v53, 32, v52
    v_add_u32 v54, 0x10000, v52
    v_add_u32 v55, 0x10000, v53
    v_and_b32 v109, 1, v107
    v_lshlrev_b32 v116, 4, v109
    v_lshrrev_b32 v109, 1, v107
    v_lshl_add_u32 v116, v109, 2, v116
    v_add_u32 v116, v116, v113
    v_xor_b32 v109, s53, v115
    v_lshlrev_b32 v109, 5, v109
    v_lshl_add_u32 v109, v116, 8, v109
    v_lshl_add_u32 v109, v110, 3, v109
    v_add_u32 v56, 32768, v109
    v_xor_b32 v57, 128, v56
    v_add_u32 v58, 0x10000, v56
    v_add_u32 v59, 0x10000, v57
    s_xor_b32 s63, s53, 0
    s_and_b32 s64, s63, 1
    s_lshl_b32 s64, s64, 7
    v_xor_b32 v96, s64, v56
    s_lshl_b32 s63, s63, 13
    v_add_u32 v96, s63, v96
    v_add_u32 v100, 0x10000, v96
    s_xor_b32 s63, s53, 1
    s_and_b32 s64, s63, 1
    s_lshl_b32 s64, s64, 7
    v_xor_b32 v97, s64, v56
    s_lshl_b32 s63, s63, 13
    v_add_u32 v97, s63, v97
    v_add_u32 v101, 0x10000, v97
    s_xor_b32 s63, s53, 2
    s_and_b32 s64, s63, 1
    s_lshl_b32 s64, s64, 7
    v_xor_b32 v98, s64, v56
    s_lshl_b32 s63, s63, 13
    v_add_u32 v98, s63, v98
    v_add_u32 v102, 0x10000, v98
    s_xor_b32 s63, s53, 3
    s_and_b32 s64, s63, 1
    s_lshl_b32 s64, s64, 7
    v_xor_b32 v99, s64, v56
    s_lshl_b32 s63, s63, 13
    v_add_u32 v99, s63, v99
    v_add_u32 v103, 0x10000, v99
    v_and_b32 v109, 1, v107
    s_lshl_b32 s63, s53, 1
    v_or_b32 v109, s63, v109
    v_lshlrev_b32 v109, 1, v109
    v_xor_b32 v109, v109, v106
    v_lshlrev_b32 v109, 4, v109
    s_lshl_b32 s63, s53, 15
    s_lshl_b32 s64, s52, 8
    s_add_u32 s63, s63, s64
    v_lshl_add_u32 v60, v107, 13, v109
    v_add_u32 v60, s63, v60
    s_lshl_b32 s63, s53, 14
    s_lshl_b32 s64, s52, 17
    s_add_u32 s63, s63, s64
    v_lshl_add_u32 v61, v107, 10, v109
    v_add_u32 v61, s63, v61
    s_lshl_b32 s63, s53, 11
    s_add_u32 s63, s63, 32768
    v_add_u32 v8, s63, v0
    v_add_u32 v12, 0x10000, v8
    s_lshl_b32 s63, s53, 10
    s_add_u32 m0, s63, 32768
    s_mov_b32 s64, 0
    buffer_load_dwordx4 v60, s[16:19], s64 offen nt lds
    s_lshl_b32 s63, s53, 10
    s_add_u32 m0, s63, 36864
    s_mov_b32 s64, 131072
    buffer_load_dwordx4 v60, s[16:19], s64 offen nt lds
    s_lshl_b32 s63, s53, 10
    s_add_u32 m0, s63, 40960
    s_mov_b32 s64, 262144
    buffer_load_dwordx4 v60, s[16:19], s64 offen nt lds
    s_lshl_b32 s63, s53, 10
    s_add_u32 m0, s63, 45056
    s_mov_b32 s64, 393216
    buffer_load_dwordx4 v60, s[16:19], s64 offen nt lds
    s_lshl_b32 s63, s53, 10
    s_add_u32 m0, s63, 49152
    s_mov_b32 s64, 524288
    buffer_load_dwordx4 v60, s[16:19], s64 offen nt lds
    s_lshl_b32 s63, s53, 10
    s_add_u32 m0, s63, 53248
    s_mov_b32 s64, 655360
    buffer_load_dwordx4 v60, s[16:19], s64 offen nt lds
    s_lshl_b32 s63, s53, 10
    s_add_u32 m0, s63, 57344
    s_mov_b32 s64, 786432
    buffer_load_dwordx4 v60, s[16:19], s64 offen nt lds
    s_lshl_b32 s63, s53, 10
    s_add_u32 m0, s63, 61440
    s_mov_b32 s64, 917504
    buffer_load_dwordx4 v60, s[16:19], s64 offen nt lds
    s_lshl_b32 s63, s53, 10
    s_add_u32 m0, s63, 65536
    s_mov_b32 s64, 1048576
    buffer_load_dwordx4 v60, s[16:19], s64 offen nt lds
    s_lshl_b32 s63, s53, 10
    s_add_u32 m0, s63, 69632
    s_mov_b32 s64, 1179648
    buffer_load_dwordx4 v60, s[16:19], s64 offen nt lds
    s_lshl_b32 s63, s53, 10
    s_add_u32 m0, s63, 73728
    s_mov_b32 s64, 1310720
    buffer_load_dwordx4 v60, s[16:19], s64 offen nt lds
    s_lshl_b32 s63, s53, 10
    s_add_u32 m0, s63, 77824
    s_mov_b32 s64, 1441792
    buffer_load_dwordx4 v60, s[16:19], s64 offen nt lds
    s_lshl_b32 s63, s53, 10
    s_add_u32 m0, s63, 81920
    s_mov_b32 s64, 1572864
    buffer_load_dwordx4 v60, s[16:19], s64 offen nt lds
    s_lshl_b32 s63, s53, 10
    s_add_u32 m0, s63, 86016
    s_mov_b32 s64, 1703936
    buffer_load_dwordx4 v60, s[16:19], s64 offen nt lds
    s_lshl_b32 s63, s53, 10
    s_add_u32 m0, s63, 90112
    s_mov_b32 s64, 1835008
    buffer_load_dwordx4 v60, s[16:19], s64 offen nt lds
    s_lshl_b32 s63, s53, 10
    s_add_u32 m0, s63, 94208
    s_mov_b32 s64, 1966080
    buffer_load_dwordx4 v60, s[16:19], s64 offen nt lds
    s_lshl_b32 s63, s53, 10
    s_add_u32 m0, s63, 98304
    s_mov_b32 s64, 2097152
    buffer_load_dwordx4 v60, s[16:19], s64 offen nt lds
    s_lshl_b32 s63, s53, 10
    s_add_u32 m0, s63, 102400
    s_mov_b32 s64, 2228224
    buffer_load_dwordx4 v60, s[16:19], s64 offen nt lds
    s_lshl_b32 s63, s53, 10
    s_add_u32 m0, s63, 106496
    s_mov_b32 s64, 2359296
    buffer_load_dwordx4 v60, s[16:19], s64 offen nt lds
    s_lshl_b32 s63, s53, 10
    s_add_u32 m0, s63, 110592
    s_mov_b32 s64, 2490368
    buffer_load_dwordx4 v60, s[16:19], s64 offen nt lds
    s_lshl_b32 s63, s53, 10
    s_add_u32 m0, s63, 114688
    s_mov_b32 s64, 2621440
    buffer_load_dwordx4 v60, s[16:19], s64 offen nt lds
    s_lshl_b32 s63, s53, 10
    s_add_u32 m0, s63, 118784
    s_mov_b32 s64, 2752512
    buffer_load_dwordx4 v60, s[16:19], s64 offen nt lds
    s_lshl_b32 s63, s53, 10
    s_add_u32 m0, s63, 122880
    s_mov_b32 s64, 2883584
    buffer_load_dwordx4 v60, s[16:19], s64 offen nt lds
    s_lshl_b32 s63, s53, 10
    s_add_u32 m0, s63, 126976
    s_mov_b32 s64, 3014656
    buffer_load_dwordx4 v60, s[16:19], s64 offen nt lds
    s_lshl_b32 s63, s53, 10
    s_add_u32 m0, s63, 131072
    s_mov_b32 s64, 3145728
    buffer_load_dwordx4 v60, s[16:19], s64 offen nt lds
    s_lshl_b32 s63, s53, 10
    s_add_u32 m0, s63, 135168
    s_mov_b32 s64, 3276800
    buffer_load_dwordx4 v60, s[16:19], s64 offen nt lds
    s_lshl_b32 s63, s53, 10
    s_add_u32 m0, s63, 139264
    s_mov_b32 s64, 3407872
    buffer_load_dwordx4 v60, s[16:19], s64 offen nt lds
    s_lshl_b32 s63, s53, 10
    s_add_u32 m0, s63, 143360
    s_mov_b32 s64, 3538944
    buffer_load_dwordx4 v60, s[16:19], s64 offen nt lds
    s_lshl_b32 s63, s53, 10
    s_add_u32 m0, s63, 147456
    s_mov_b32 s64, 3670016
    buffer_load_dwordx4 v60, s[16:19], s64 offen nt lds
    s_lshl_b32 s63, s53, 10
    s_add_u32 m0, s63, 151552
    s_mov_b32 s64, 3801088
    buffer_load_dwordx4 v60, s[16:19], s64 offen nt lds
    s_lshl_b32 s63, s53, 10
    s_add_u32 m0, s63, 155648
    s_mov_b32 s64, 3932160
    buffer_load_dwordx4 v60, s[16:19], s64 offen nt lds
    s_lshl_b32 s63, s53, 10
    s_add_u32 m0, s63, 159744
    s_mov_b32 s64, 4063232
    buffer_load_dwordx4 v60, s[16:19], s64 offen nt lds
    v_mov_b32 v32, s86
    v_mov_b32 v33, s86
    v_mov_b32 v34, s86
    v_mov_b32 v35, s86
    s_mov_b32 s63, 0
    s_mov_b32 s64, 262144
    buffer_store_dwordx4 v[32:35], v6, s[8:11], s63 offen sc1
    buffer_store_dwordx4 v[32:35], v6, s[8:11], s63 offen offset:1024 sc1
    buffer_store_dwordx4 v[32:35], v6, s[8:11], s64 offen sc1
    buffer_store_dwordx4 v[32:35], v6, s[8:11], s64 offen offset:1024 sc1
    s_mov_b32 s63, 532480
    s_mov_b32 s64, 540672
    buffer_store_dword v32, v7, s[8:11], s63 offen sc1
    buffer_store_dword v32, v7, s[8:11], s64 offen sc1
    s_lshl_b32 s63, s53, 11
    v_add_u32 v109, s63, v0
    ds_write_b128 v109, v[32:35] offset:0
    ds_write_b128 v109, v[32:35] offset:1024
    ds_write_b128 v109, v[32:35] offset:8192
    ds_write_b128 v109, v[32:35] offset:9216
    v_pk_mov_b32 v[36:37], 0, 0
    v_pk_mov_b32 v[38:39], 0, 0
    ds_write_b128 v3, v[36:39] offset:1024
    s_waitcnt vmcnt(38)
    v_cmp_eq_u32 vcc, s86, v112
    v_xor_b32 v109, 0x00400040, v112
    s_nop 0
    v_cndmask_b32 v112, v112, v109, vcc
    s_mov_b32 s63, 524288
    buffer_store_dword v112, v7, s[8:11], s63 offen sc1
    s_lshl_b32 s63, s52, 7
    s_lshl_b32 s64, s53, 2
    s_add_u32 s63, s63, s64
    s_add_u32 s88, s63, 589824
    buffer_store_dword v17, v17, s[8:11], s88 offen sc1
    s_waitcnt vmcnt(32)
    s_barrier
    s_cmp_lg_u32 s53, 0
    s_cbranch_scc1 R_cw_2
    ds_read_b64_tr_b16 a[0:1], v52 offset:0
    ds_read_b64_tr_b16 a[2:3], v52 offset:512
    ds_read_b64_tr_b16 a[4:5], v52 offset:8192
    ds_read_b64_tr_b16 a[6:7], v52 offset:8704
    ds_read_b64_tr_b16 a[64:65], v53 offset:0
    ds_read_b64_tr_b16 a[66:67], v53 offset:512
    ds_read_b64_tr_b16 a[68:69], v53 offset:8192
    ds_read_b64_tr_b16 a[70:71], v53 offset:8704
    ds_read_b64_tr_b16 a[8:9], v52 offset:16384
    ds_read_b64_tr_b16 a[10:11], v52 offset:16896
    ds_read_b64_tr_b16 a[12:13], v52 offset:24576
    ds_read_b64_tr_b16 a[14:15], v52 offset:25088
    ds_read_b64_tr_b16 a[72:73], v53 offset:16384
    ds_read_b64_tr_b16 a[74:75], v53 offset:16896
    ds_read_b64_tr_b16 a[76:77], v53 offset:24576
    ds_read_b64_tr_b16 a[78:79], v53 offset:25088
    s_branch R_cend_1
R_cw_2:
    s_cmp_lg_u32 s53, 1
    s_cbranch_scc1 R_cw_3
    ds_read_b64_tr_b16 a[16:17], v52 offset:0
    ds_read_b64_tr_b16 a[18:19], v52 offset:512
    ds_read_b64_tr_b16 a[20:21], v52 offset:8192
    ds_read_b64_tr_b16 a[22:23], v52 offset:8704
    ds_read_b64_tr_b16 a[80:81], v53 offset:0
    ds_read_b64_tr_b16 a[82:83], v53 offset:512
    ds_read_b64_tr_b16 a[84:85], v53 offset:8192
    ds_read_b64_tr_b16 a[86:87], v53 offset:8704
    ds_read_b64_tr_b16 a[24:25], v52 offset:16384
    ds_read_b64_tr_b16 a[26:27], v52 offset:16896
    ds_read_b64_tr_b16 a[28:29], v52 offset:24576
    ds_read_b64_tr_b16 a[30:31], v52 offset:25088
    ds_read_b64_tr_b16 a[88:89], v53 offset:16384
    ds_read_b64_tr_b16 a[90:91], v53 offset:16896
    ds_read_b64_tr_b16 a[92:93], v53 offset:24576
    ds_read_b64_tr_b16 a[94:95], v53 offset:25088
    s_branch R_cend_1
R_cw_3:
    s_cmp_lg_u32 s53, 2
    s_cbranch_scc1 R_cw_4
    ds_read_b64_tr_b16 a[32:33], v52 offset:0
    ds_read_b64_tr_b16 a[34:35], v52 offset:512
    ds_read_b64_tr_b16 a[36:37], v52 offset:8192
    ds_read_b64_tr_b16 a[38:39], v52 offset:8704
    ds_read_b64_tr_b16 a[96:97], v53 offset:0
    ds_read_b64_tr_b16 a[98:99], v53 offset:512
    ds_read_b64_tr_b16 a[100:101], v53 offset:8192
    ds_read_b64_tr_b16 a[102:103], v53 offset:8704
    ds_read_b64_tr_b16 a[40:41], v52 offset:16384
    ds_read_b64_tr_b16 a[42:43], v52 offset:16896
    ds_read_b64_tr_b16 a[44:45], v52 offset:24576
    ds_read_b64_tr_b16 a[46:47], v52 offset:25088
    ds_read_b64_tr_b16 a[104:105], v53 offset:16384
    ds_read_b64_tr_b16 a[106:107], v53 offset:16896
    ds_read_b64_tr_b16 a[108:109], v53 offset:24576
    ds_read_b64_tr_b16 a[110:111], v53 offset:25088
    s_branch R_cend_1
R_cw_4:
    ds_read_b64_tr_b16 a[48:49], v52 offset:0
    ds_read_b64_tr_b16 a[50:51], v52 offset:512
    ds_read_b64_tr_b16 a[52:53], v52 offset:8192
    ds_read_b64_tr_b16 a[54:55], v52 offset:8704
    ds_read_b64_tr_b16 a[112:113], v53 offset:0
    ds_read_b64_tr_b16 a[114:115], v53 offset:512
    ds_read_b64_tr_b16 a[116:117], v53 offset:8192
    ds_read_b64_tr_b16 a[118:119], v53 offset:8704
    ds_read_b64_tr_b16 a[56:57], v52 offset:16384
    ds_read_b64_tr_b16 a[58:59], v52 offset:16896
    ds_read_b64_tr_b16 a[60:61], v52 offset:24576
    ds_read_b64_tr_b16 a[62:63], v52 offset:25088
    ds_read_b64_tr_b16 a[120:121], v53 offset:16384
    ds_read_b64_tr_b16 a[122:123], v53 offset:16896
    ds_read_b64_tr_b16 a[124:125], v53 offset:24576
    ds_read_b64_tr_b16 a[126:127], v53 offset:25088
R_cend_1:
    s_waitcnt lgkmcnt(0)
    s_barrier
    s_lshl_b32 s63, s53, 10
    s_add_u32 m0, s63, 32768
    s_mov_b32 s64, 0
    buffer_load_dwordx4 v60, s[24:27], s64 offen nt lds
    s_lshl_b32 s63, s53, 10
    s_add_u32 m0, s63, 36864
    s_mov_b32 s64, 131072
    buffer_load_dwordx4 v60, s[24:27], s64 offen nt lds
    s_lshl_b32 s63, s53, 10
    s_add_u32 m0, s63, 40960
    s_mov_b32 s64, 262144
    buffer_load_dwordx4 v60, s[24:27], s64 offen nt lds
    s_lshl_b32 s63, s53, 10
    s_add_u32 m0, s63, 45056
    s_mov_b32 s64, 393216
    buffer_load_dwordx4 v60, s[24:27], s64 offen nt lds
    s_lshl_b32 s63, s53, 10
    s_add_u32 m0, s63, 49152
    s_mov_b32 s64, 524288
    buffer_load_dwordx4 v60, s[24:27], s64 offen nt lds
    s_lshl_b32 s63, s53, 10
    s_add_u32 m0, s63, 53248
    s_mov_b32 s64, 655360
    buffer_load_dwordx4 v60, s[24:27], s64 offen nt lds
    s_lshl_b32 s63, s53, 10
    s_add_u32 m0, s63, 57344
    s_mov_b32 s64, 786432
    buffer_load_dwordx4 v60, s[24:27], s64 offen nt lds
    s_lshl_b32 s63, s53, 10
    s_add_u32 m0, s63, 61440
    s_mov_b32 s64, 917504
    buffer_load_dwordx4 v60, s[24:27], s64 offen nt lds
    s_waitcnt vmcnt(32)
    s_barrier
    s_cmp_lg_u32 s53, 0
    s_cbranch_scc1 R_cw_7
    ds_read_b64_tr_b16 a[16:17], v52 offset:32768
    ds_read_b64_tr_b16 a[18:19], v52 offset:33280
    ds_read_b64_tr_b16 a[20:21], v52 offset:40960
    ds_read_b64_tr_b16 a[22:23], v52 offset:41472
    ds_read_b64_tr_b16 a[80:81], v53 offset:32768
    ds_read_b64_tr_b16 a[82:83], v53 offset:33280
    ds_read_b64_tr_b16 a[84:85], v53 offset:40960
    ds_read_b64_tr_b16 a[86:87], v53 offset:41472
    ds_read_b64_tr_b16 a[24:25], v52 offset:49152
    ds_read_b64_tr_b16 a[26:27], v52 offset:49664
    ds_read_b64_tr_b16 a[28:29], v52 offset:57344
    ds_read_b64_tr_b16 a[30:31], v52 offset:57856
    ds_read_b64_tr_b16 a[88:89], v53 offset:49152
    ds_read_b64_tr_b16 a[90:91], v53 offset:49664
    ds_read_b64_tr_b16 a[92:93], v53 offset:57344
    ds_read_b64_tr_b16 a[94:95], v53 offset:57856
    s_branch R_cend_6
R_cw_7:
    s_cmp_lg_u32 s53, 1
    s_cbranch_scc1 R_cw_8
    ds_read_b64_tr_b16 a[0:1], v52 offset:32768
    ds_read_b64_tr_b16 a[2:3], v52 offset:33280
    ds_read_b64_tr_b16 a[4:5], v52 offset:40960
    ds_read_b64_tr_b16 a[6:7], v52 offset:41472
    ds_read_b64_tr_b16 a[64:65], v53 offset:32768
    ds_read_b64_tr_b16 a[66:67], v53 offset:33280
    ds_read_b64_tr_b16 a[68:69], v53 offset:40960
    ds_read_b64_tr_b16 a[70:71], v53 offset:41472
    ds_read_b64_tr_b16 a[8:9], v52 offset:49152
    ds_read_b64_tr_b16 a[10:11], v52 offset:49664
    ds_read_b64_tr_b16 a[12:13], v52 offset:57344
    ds_read_b64_tr_b16 a[14:15], v52 offset:57856
    ds_read_b64_tr_b16 a[72:73], v53 offset:49152
    ds_read_b64_tr_b16 a[74:75], v53 offset:49664
    ds_read_b64_tr_b16 a[76:77], v53 offset:57344
    ds_read_b64_tr_b16 a[78:79], v53 offset:57856
    s_branch R_cend_6
R_cw_8:
    s_cmp_lg_u32 s53, 2
    s_cbranch_scc1 R_cw_9
    ds_read_b64_tr_b16 a[48:49], v52 offset:32768
    ds_read_b64_tr_b16 a[50:51], v52 offset:33280
    ds_read_b64_tr_b16 a[52:53], v52 offset:40960
    ds_read_b64_tr_b16 a[54:55], v52 offset:41472
    ds_read_b64_tr_b16 a[112:113], v53 offset:32768
    ds_read_b64_tr_b16 a[114:115], v53 offset:33280
    ds_read_b64_tr_b16 a[116:117], v53 offset:40960
    ds_read_b64_tr_b16 a[118:119], v53 offset:41472
    ds_read_b64_tr_b16 a[56:57], v52 offset:49152
    ds_read_b64_tr_b16 a[58:59], v52 offset:49664
    ds_read_b64_tr_b16 a[60:61], v52 offset:57344
    ds_read_b64_tr_b16 a[62:63], v52 offset:57856
    ds_read_b64_tr_b16 a[120:121], v53 offset:49152
    ds_read_b64_tr_b16 a[122:123], v53 offset:49664
    ds_read_b64_tr_b16 a[124:125], v53 offset:57344
    ds_read_b64_tr_b16 a[126:127], v53 offset:57856
    s_branch R_cend_6
R_cw_9:
    ds_read_b64_tr_b16 a[32:33], v52 offset:32768
    ds_read_b64_tr_b16 a[34:35], v52 offset:33280
    ds_read_b64_tr_b16 a[36:37], v52 offset:40960
    ds_read_b64_tr_b16 a[38:39], v52 offset:41472
    ds_read_b64_tr_b16 a[96:97], v53 offset:32768
    ds_read_b64_tr_b16 a[98:99], v53 offset:33280
    ds_read_b64_tr_b16 a[100:101], v53 offset:40960
    ds_read_b64_tr_b16 a[102:103], v53 offset:41472
    ds_read_b64_tr_b16 a[40:41], v52 offset:49152
    ds_read_b64_tr_b16 a[42:43], v52 offset:49664
    ds_read_b64_tr_b16 a[44:45], v52 offset:57344
    ds_read_b64_tr_b16 a[46:47], v52 offset:57856
    ds_read_b64_tr_b16 a[104:105], v53 offset:49152
    ds_read_b64_tr_b16 a[106:107], v53 offset:49664
    ds_read_b64_tr_b16 a[108:109], v53 offset:57344
    ds_read_b64_tr_b16 a[110:111], v53 offset:57856
R_cend_6:
    s_waitcnt lgkmcnt(0)
    s_barrier
    s_lshl_b32 s63, s53, 10
    s_add_u32 m0, s63, 65536
    s_mov_b32 s64, 1048576
    buffer_load_dwordx4 v60, s[24:27], s64 offen nt lds
    s_lshl_b32 s63, s53, 10
    s_add_u32 m0, s63, 69632
    s_mov_b32 s64, 1179648
    buffer_load_dwordx4 v60, s[24:27], s64 offen nt lds
    s_lshl_b32 s63, s53, 10
    s_add_u32 m0, s63, 73728
    s_mov_b32 s64, 1310720
    buffer_load_dwordx4 v60, s[24:27], s64 offen nt lds
    s_lshl_b32 s63, s53, 10
    s_add_u32 m0, s63, 77824
    s_mov_b32 s64, 1441792
    buffer_load_dwordx4 v60, s[24:27], s64 offen nt lds
    s_lshl_b32 s63, s53, 10
    s_add_u32 m0, s63, 81920
    s_mov_b32 s64, 1572864
    buffer_load_dwordx4 v60, s[24:27], s64 offen nt lds
    s_lshl_b32 s63, s53, 10
    s_add_u32 m0, s63, 86016
    s_mov_b32 s64, 1703936
    buffer_load_dwordx4 v60, s[24:27], s64 offen nt lds
    s_lshl_b32 s63, s53, 10
    s_add_u32 m0, s63, 90112
    s_mov_b32 s64, 1835008
    buffer_load_dwordx4 v60, s[24:27], s64 offen nt lds
    s_lshl_b32 s63, s53, 10
    s_add_u32 m0, s63, 94208
    s_mov_b32 s64, 1966080
    buffer_load_dwordx4 v60, s[24:27], s64 offen nt lds
    s_waitcnt vmcnt(32)
    s_barrier
    s_cmp_lg_u32 s53, 0
    s_cbranch_scc1 R_cw_12
    ds_read_b64_tr_b16 a[32:33], v54 offset:0
    ds_read_b64_tr_b16 a[34:35], v54 offset:512
    ds_read_b64_tr_b16 a[36:37], v54 offset:8192
    ds_read_b64_tr_b16 a[38:39], v54 offset:8704
    ds_read_b64_tr_b16 a[96:97], v55 offset:0
    ds_read_b64_tr_b16 a[98:99], v55 offset:512
    ds_read_b64_tr_b16 a[100:101], v55 offset:8192
    ds_read_b64_tr_b16 a[102:103], v55 offset:8704
    ds_read_b64_tr_b16 a[40:41], v54 offset:16384
    ds_read_b64_tr_b16 a[42:43], v54 offset:16896
    ds_read_b64_tr_b16 a[44:45], v54 offset:24576
    ds_read_b64_tr_b16 a[46:47], v54 offset:25088
    ds_read_b64_tr_b16 a[104:105], v55 offset:16384
    ds_read_b64_tr_b16 a[106:107], v55 offset:16896
    ds_read_b64_tr_b16 a[108:109], v55 offset:24576
    ds_read_b64_tr_b16 a[110:111], v55 offset:25088
    s_branch R_cend_11
R_cw_12:
    s_cmp_lg_u32 s53, 1
    s_cbranch_scc1 R_cw_13
    ds_read_b64_tr_b16 a[48:49], v54 offset:0
    ds_read_b64_tr_b16 a[50:51], v54 offset:512
    ds_read_b64_tr_b16 a[52:53], v54 offset:8192
    ds_read_b64_tr_b16 a[54:55], v54 offset:8704
    ds_read_b64_tr_b16 a[112:113], v55 offset:0
    ds_read_b64_tr_b16 a[114:115], v55 offset:512
    ds_read_b64_tr_b16 a[116:117], v55 offset:8192
    ds_read_b64_tr_b16 a[118:119], v55 offset:8704
    ds_read_b64_tr_b16 a[56:57], v54 offset:16384
    ds_read_b64_tr_b16 a[58:59], v54 offset:16896
    ds_read_b64_tr_b16 a[60:61], v54 offset:24576
    ds_read_b64_tr_b16 a[62:63], v54 offset:25088
    ds_read_b64_tr_b16 a[120:121], v55 offset:16384
    ds_read_b64_tr_b16 a[122:123], v55 offset:16896
    ds_read_b64_tr_b16 a[124:125], v55 offset:24576
    ds_read_b64_tr_b16 a[126:127], v55 offset:25088
    s_branch R_cend_11
R_cw_13:
    s_cmp_lg_u32 s53, 2
    s_cbranch_scc1 R_cw_14
    ds_read_b64_tr_b16 a[0:1], v54 offset:0
    ds_read_b64_tr_b16 a[2:3], v54 offset:512
    ds_read_b64_tr_b16 a[4:5], v54 offset:8192
    ds_read_b64_tr_b16 a[6:7], v54 offset:8704
    ds_read_b64_tr_b16 a[64:65], v55 offset:0
    ds_read_b64_tr_b16 a[66:67], v55 offset:512
    ds_read_b64_tr_b16 a[68:69], v55 offset:8192
    ds_read_b64_tr_b16 a[70:71], v55 offset:8704
    ds_read_b64_tr_b16 a[8:9], v54 offset:16384
    ds_read_b64_tr_b16 a[10:11], v54 offset:16896
    ds_read_b64_tr_b16 a[12:13], v54 offset:24576
    ds_read_b64_tr_b16 a[14:15], v54 offset:25088
    ds_read_b64_tr_b16 a[72:73], v55 offset:16384
    ds_read_b64_tr_b16 a[74:75], v55 offset:16896
    ds_read_b64_tr_b16 a[76:77], v55 offset:24576
    ds_read_b64_tr_b16 a[78:79], v55 offset:25088
    s_branch R_cend_11
R_cw_14:
    ds_read_b64_tr_b16 a[16:17], v54 offset:0
    ds_read_b64_tr_b16 a[18:19], v54 offset:512
    ds_read_b64_tr_b16 a[20:21], v54 offset:8192
    ds_read_b64_tr_b16 a[22:23], v54 offset:8704
    ds_read_b64_tr_b16 a[80:81], v55 offset:0
    ds_read_b64_tr_b16 a[82:83], v55 offset:512
    ds_read_b64_tr_b16 a[84:85], v55 offset:8192
    ds_read_b64_tr_b16 a[86:87], v55 offset:8704
    ds_read_b64_tr_b16 a[24:25], v54 offset:16384
    ds_read_b64_tr_b16 a[26:27], v54 offset:16896
    ds_read_b64_tr_b16 a[28:29], v54 offset:24576
    ds_read_b64_tr_b16 a[30:31], v54 offset:25088
    ds_read_b64_tr_b16 a[88:89], v55 offset:16384
    ds_read_b64_tr_b16 a[90:91], v55 offset:16896
    ds_read_b64_tr_b16 a[92:93], v55 offset:24576
    ds_read_b64_tr_b16 a[94:95], v55 offset:25088
R_cend_11:
    s_waitcnt lgkmcnt(0)
    s_barrier
    s_lshl_b32 s63, s53, 10
    s_add_u32 m0, s63, 98304
    s_mov_b32 s64, 2097152
    buffer_load_dwordx4 v60, s[24:27], s64 offen nt lds
    s_lshl_b32 s63, s53, 10
    s_add_u32 m0, s63, 102400
    s_mov_b32 s64, 2228224
    buffer_load_dwordx4 v60, s[24:27], s64 offen nt lds
    s_lshl_b32 s63, s53, 10
    s_add_u32 m0, s63, 106496
    s_mov_b32 s64, 2359296
    buffer_load_dwordx4 v60, s[24:27], s64 offen nt lds
    s_lshl_b32 s63, s53, 10
    s_add_u32 m0, s63, 110592
    s_mov_b32 s64, 2490368
    buffer_load_dwordx4 v60, s[24:27], s64 offen nt lds
    s_lshl_b32 s63, s53, 10
    s_add_u32 m0, s63, 114688
    s_mov_b32 s64, 2621440
    buffer_load_dwordx4 v60, s[24:27], s64 offen nt lds
    s_lshl_b32 s63, s53, 10
    s_add_u32 m0, s63, 118784
    s_mov_b32 s64, 2752512
    buffer_load_dwordx4 v60, s[24:27], s64 offen nt lds
    s_lshl_b32 s63, s53, 10
    s_add_u32 m0, s63, 122880
    s_mov_b32 s64, 2883584
    buffer_load_dwordx4 v60, s[24:27], s64 offen nt lds
    s_lshl_b32 s63, s53, 10
    s_add_u32 m0, s63, 126976
    s_mov_b32 s64, 3014656
    buffer_load_dwordx4 v60, s[24:27], s64 offen nt lds
    s_waitcnt vmcnt(32)
    s_barrier
    s_cmp_lg_u32 s53, 0
    s_cbranch_scc1 R_cw_17
    ds_read_b64_tr_b16 a[48:49], v54 offset:32768
    ds_read_b64_tr_b16 a[50:51], v54 offset:33280
    ds_read_b64_tr_b16 a[52:53], v54 offset:40960
    ds_read_b64_tr_b16 a[54:55], v54 offset:41472
    ds_read_b64_tr_b16 a[112:113], v55 offset:32768
    ds_read_b64_tr_b16 a[114:115], v55 offset:33280
    ds_read_b64_tr_b16 a[116:117], v55 offset:40960
    ds_read_b64_tr_b16 a[118:119], v55 offset:41472
    ds_read_b64_tr_b16 a[56:57], v54 offset:49152
    ds_read_b64_tr_b16 a[58:59], v54 offset:49664
    ds_read_b64_tr_b16 a[60:61], v54 offset:57344
    ds_read_b64_tr_b16 a[62:63], v54 offset:57856
    ds_read_b64_tr_b16 a[120:121], v55 offset:49152
    ds_read_b64_tr_b16 a[122:123], v55 offset:49664
    ds_read_b64_tr_b16 a[124:125], v55 offset:57344
    ds_read_b64_tr_b16 a[126:127], v55 offset:57856
    s_branch R_cend_16
R_cw_17:
    s_cmp_lg_u32 s53, 1
    s_cbranch_scc1 R_cw_18
    ds_read_b64_tr_b16 a[32:33], v54 offset:32768
    ds_read_b64_tr_b16 a[34:35], v54 offset:33280
    ds_read_b64_tr_b16 a[36:37], v54 offset:40960
    ds_read_b64_tr_b16 a[38:39], v54 offset:41472
    ds_read_b64_tr_b16 a[96:97], v55 offset:32768
    ds_read_b64_tr_b16 a[98:99], v55 offset:33280
    ds_read_b64_tr_b16 a[100:101], v55 offset:40960
    ds_read_b64_tr_b16 a[102:103], v55 offset:41472
    ds_read_b64_tr_b16 a[40:41], v54 offset:49152
    ds_read_b64_tr_b16 a[42:43], v54 offset:49664
    ds_read_b64_tr_b16 a[44:45], v54 offset:57344
    ds_read_b64_tr_b16 a[46:47], v54 offset:57856
    ds_read_b64_tr_b16 a[104:105], v55 offset:49152
    ds_read_b64_tr_b16 a[106:107], v55 offset:49664
    ds_read_b64_tr_b16 a[108:109], v55 offset:57344
    ds_read_b64_tr_b16 a[110:111], v55 offset:57856
    s_branch R_cend_16
R_cw_18:
    s_cmp_lg_u32 s53, 2
    s_cbranch_scc1 R_cw_19
    ds_read_b64_tr_b16 a[16:17], v54 offset:32768
    ds_read_b64_tr_b16 a[18:19], v54 offset:33280
    ds_read_b64_tr_b16 a[20:21], v54 offset:40960
    ds_read_b64_tr_b16 a[22:23], v54 offset:41472
    ds_read_b64_tr_b16 a[80:81], v55 offset:32768
    ds_read_b64_tr_b16 a[82:83], v55 offset:33280
    ds_read_b64_tr_b16 a[84:85], v55 offset:40960
    ds_read_b64_tr_b16 a[86:87], v55 offset:41472
    ds_read_b64_tr_b16 a[24:25], v54 offset:49152
    ds_read_b64_tr_b16 a[26:27], v54 offset:49664
    ds_read_b64_tr_b16 a[28:29], v54 offset:57344
    ds_read_b64_tr_b16 a[30:31], v54 offset:57856
    ds_read_b64_tr_b16 a[88:89], v55 offset:49152
    ds_read_b64_tr_b16 a[90:91], v55 offset:49664
    ds_read_b64_tr_b16 a[92:93], v55 offset:57344
    ds_read_b64_tr_b16 a[94:95], v55 offset:57856
    s_branch R_cend_16
R_cw_19:
    ds_read_b64_tr_b16 a[0:1], v54 offset:32768
    ds_read_b64_tr_b16 a[2:3], v54 offset:33280
    ds_read_b64_tr_b16 a[4:5], v54 offset:40960
    ds_read_b64_tr_b16 a[6:7], v54 offset:41472
    ds_read_b64_tr_b16 a[64:65], v55 offset:32768
    ds_read_b64_tr_b16 a[66:67], v55 offset:33280
    ds_read_b64_tr_b16 a[68:69], v55 offset:40960
    ds_read_b64_tr_b16 a[70:71], v55 offset:41472
    ds_read_b64_tr_b16 a[8:9], v54 offset:49152
    ds_read_b64_tr_b16 a[10:11], v54 offset:49664
    ds_read_b64_tr_b16 a[12:13], v54 offset:57344
    ds_read_b64_tr_b16 a[14:15], v54 offset:57856
    ds_read_b64_tr_b16 a[72:73], v55 offset:49152
    ds_read_b64_tr_b16 a[74:75], v55 offset:49664
    ds_read_b64_tr_b16 a[76:77], v55 offset:57344
    ds_read_b64_tr_b16 a[78:79], v55 offset:57856
R_cend_16:
    s_waitcnt lgkmcnt(0)
    s_barrier
    s_lshl_b32 s63, s53, 10
    s_add_u32 m0, s63, 131072
    s_mov_b32 s64, 3145728
    buffer_load_dwordx4 v60, s[24:27], s64 offen nt lds
    s_lshl_b32 s63, s53, 10
    s_add_u32 m0, s63, 135168
    s_mov_b32 s64, 3276800
    buffer_load_dwordx4 v60, s[24:27], s64 offen nt lds
    s_lshl_b32 s63, s53, 10
    s_add_u32 m0, s63, 139264
    s_mov_b32 s64, 3407872
    buffer_load_dwordx4 v60, s[24:27], s64 offen nt lds
    s_lshl_b32 s63, s53, 10
    s_add_u32 m0, s63, 143360
    s_mov_b32 s64, 3538944
    buffer_load_dwordx4 v60, s[24:27], s64 offen nt lds
    s_lshl_b32 s63, s53, 10
    s_add_u32 m0, s63, 147456
    s_mov_b32 s64, 3670016
    buffer_load_dwordx4 v60, s[24:27], s64 offen nt lds
    s_lshl_b32 s63, s53, 10
    s_add_u32 m0, s63, 151552
    s_mov_b32 s64, 3801088
    buffer_load_dwordx4 v60, s[24:27], s64 offen nt lds
    s_lshl_b32 s63, s53, 10
    s_add_u32 m0, s63, 155648
    s_mov_b32 s64, 3932160
    buffer_load_dwordx4 v60, s[24:27], s64 offen nt lds
    s_lshl_b32 s63, s53, 10
    s_add_u32 m0, s63, 159744
    s_mov_b32 s64, 4063232
    buffer_load_dwordx4 v60, s[24:27], s64 offen nt lds
    s_waitcnt vmcnt(24)
    s_barrier
    s_cmp_lg_u32 s53, 0
    s_cbranch_scc1 R_noarr_21
    s_cmp_eq_u32 s66, 0
    s_cselect_b32 s63, 0x10001, 1
    v_mov_b32 v109, s63
    v_mov_b32 v110, 32
    s_mov_b64 exec, 1
    buffer_atomic_add v109, v110, s[12:15], 0 offen
    s_mov_b64 exec, -1
R_noarr_21:
    s_cmp_lg_u32 s53, 0
    s_cbranch_scc1 R_cw_23
    ds_read_b64_tr_b16 a[128:129], v52 offset:0
    ds_read_b64_tr_b16 a[130:131], v52 offset:512
    ds_read_b64_tr_b16 a[132:133], v52 offset:8192
    ds_read_b64_tr_b16 a[134:135], v52 offset:8704
    ds_read_b64_tr_b16 a[192:193], v53 offset:0
    ds_read_b64_tr_b16 a[194:195], v53 offset:512
    ds_read_b64_tr_b16 a[196:197], v53 offset:8192
    ds_read_b64_tr_b16 a[198:199], v53 offset:8704
    ds_read_b64_tr_b16 a[136:137], v52 offset:16384
    ds_read_b64_tr_b16 a[138:139], v52 offset:16896
    ds_read_b64_tr_b16 a[140:141], v52 offset:24576
    ds_read_b64_tr_b16 a[142:143], v52 offset:25088
    ds_read_b64_tr_b16 a[200:201], v53 offset:16384
    ds_read_b64_tr_b16 a[202:203], v53 offset:16896
    ds_read_b64_tr_b16 a[204:205], v53 offset:24576
    ds_read_b64_tr_b16 a[206:207], v53 offset:25088
    s_branch R_cend_22
R_cw_23:
    s_cmp_lg_u32 s53, 1
    s_cbranch_scc1 R_cw_24
    ds_read_b64_tr_b16 a[144:145], v52 offset:0
    ds_read_b64_tr_b16 a[146:147], v52 offset:512
    ds_read_b64_tr_b16 a[148:149], v52 offset:8192
    ds_read_b64_tr_b16 a[150:151], v52 offset:8704
    ds_read_b64_tr_b16 a[208:209], v53 offset:0
    ds_read_b64_tr_b16 a[210:211], v53 offset:512
    ds_read_b64_tr_b16 a[212:213], v53 offset:8192
    ds_read_b64_tr_b16 a[214:215], v53 offset:8704
    ds_read_b64_tr_b16 a[152:153], v52 offset:16384
    ds_read_b64_tr_b16 a[154:155], v52 offset:16896
    ds_read_b64_tr_b16 a[156:157], v52 offset:24576
    ds_read_b64_tr_b16 a[158:159], v52 offset:25088
    ds_read_b64_tr_b16 a[216:217], v53 offset:16384
    ds_read_b64_tr_b16 a[218:219], v53 offset:16896
    ds_read_b64_tr_b16 a[220:221], v53 offset:24576
    ds_read_b64_tr_b16 a[222:223], v53 offset:25088
    s_branch R_cend_22
R_cw_24:
    s_cmp_lg_u32 s53, 2
    s_cbranch_scc1 R_cw_25
    ds_read_b64_tr_b16 a[160:161], v52 offset:0
    ds_read_b64_tr_b16 a[162:163], v52 offset:512
    ds_read_b64_tr_b16 a[164:165], v52 offset:8192
    ds_read_b64_tr_b16 a[166:167], v52 offset:8704
    ds_read_b64_tr_b16 a[224:225], v53 offset:0
    ds_read_b64_tr_b16 a[226:227], v53 offset:512
    ds_read_b64_tr_b16 a[228:229], v53 offset:8192
    ds_read_b64_tr_b16 a[230:231], v53 offset:8704
    ds_read_b64_tr_b16 a[168:169], v52 offset:16384
    ds_read_b64_tr_b16 a[170:171], v52 offset:16896
    ds_read_b64_tr_b16 a[172:173], v52 offset:24576
    ds_read_b64_tr_b16 a[174:175], v52 offset:25088
    ds_read_b64_tr_b16 a[232:233], v53 offset:16384
    ds_read_b64_tr_b16 a[234:235], v53 offset:16896
    ds_read_b64_tr_b16 a[236:237], v53 offset:24576
    ds_read_b64_tr_b16 a[238:239], v53 offset:25088
    s_branch R_cend_22
R_cw_25:
    ds_read_b64_tr_b16 a[176:177], v52 offset:0
    ds_read_b64_tr_b16 a[178:179], v52 offset:512
    ds_read_b64_tr_b16 a[180:181], v52 offset:8192
    ds_read_b64_tr_b16 a[182:183], v52 offset:8704
    ds_read_b64_tr_b16 a[240:241], v53 offset:0
    ds_read_b64_tr_b16 a[242:243], v53 offset:512
    ds_read_b64_tr_b16 a[244:245], v53 offset:8192
    ds_read_b64_tr_b16 a[246:247], v53 offset:8704
    ds_read_b64_tr_b16 a[184:185], v52 offset:16384
    ds_read_b64_tr_b16 a[186:187], v52 offset:16896
    ds_read_b64_tr_b16 a[188:189], v52 offset:24576
    ds_read_b64_tr_b16 a[190:191], v52 offset:25088
    ds_read_b64_tr_b16 a[248:249], v53 offset:16384
    ds_read_b64_tr_b16 a[250:251], v53 offset:16896
    ds_read_b64_tr_b16 a[252:253], v53 offset:24576
    ds_read_b64_tr_b16 a[254:255], v53 offset:25088
R_cend_22:
    s_waitcnt lgkmcnt(0)
    s_barrier
    s_lshl_b32 s63, s53, 12
    s_add_u32 m0, s63, 32768
    s_mov_b32 s64, 0
    buffer_load_dwordx4 v61, s[28:31], s64 offen nt lds
    s_lshl_b32 s63, s53, 12
    s_add_u32 m0, s63, 33792
    s_mov_b32 s64, 4096
    buffer_load_dwordx4 v61, s[28:31], s64 offen nt lds
    s_lshl_b32 s63, s53, 12
    s_add_u32 m0, s63, 34816
    s_mov_b32 s64, 8192
    buffer_load_dwordx4 v61, s[28:31], s64 offen nt lds
    s_lshl_b32 s63, s53, 12
    s_add_u32 m0, s63, 35840
    s_mov_b32 s64, 12288
    buffer_load_dwordx4 v61, s[28:31], s64 offen nt lds
    s_lshl_b32 s63, s53, 12
    s_add_u32 m0, s63, 49152
    s_mov_b32 s64, 65536
    buffer_load_dwordx4 v61, s[28:31], s64 offen nt lds
    s_lshl_b32 s63, s53, 12
    s_add_u32 m0, s63, 50176
    s_mov_b32 s64, 69632
    buffer_load_dwordx4 v61, s[28:31], s64 offen nt lds
    s_lshl_b32 s63, s53, 12
    s_add_u32 m0, s63, 51200
    s_mov_b32 s64, 73728
    buffer_load_dwordx4 v61, s[28:31], s64 offen nt lds
    s_lshl_b32 s63, s53, 12
    s_add_u32 m0, s63, 52224
    s_mov_b32 s64, 77824
    buffer_load_dwordx4 v61, s[28:31], s64 offen nt lds
    s_waitcnt vmcnt(24)
    s_barrier
    s_cmp_lg_u32 s53, 0
    s_cbranch_scc1 R_cw_28
    ds_read_b64_tr_b16 a[144:145], v52 offset:32768
    ds_read_b64_tr_b16 a[146:147], v52 offset:33280
    ds_read_b64_tr_b16 a[148:149], v52 offset:40960
    ds_read_b64_tr_b16 a[150:151], v52 offset:41472
    ds_read_b64_tr_b16 a[208:209], v53 offset:32768
    ds_read_b64_tr_b16 a[210:211], v53 offset:33280
    ds_read_b64_tr_b16 a[212:213], v53 offset:40960
    ds_read_b64_tr_b16 a[214:215], v53 offset:41472
    ds_read_b64_tr_b16 a[152:153], v52 offset:49152
    ds_read_b64_tr_b16 a[154:155], v52 offset:49664
    ds_read_b64_tr_b16 a[156:157], v52 offset:57344
    ds_read_b64_tr_b16 a[158:159], v52 offset:57856
    ds_read_b64_tr_b16 a[216:217], v53 offset:49152
    ds_read_b64_tr_b16 a[218:219], v53 offset:49664
    ds_read_b64_tr_b16 a[220:221], v53 offset:57344
    ds_read_b64_tr_b16 a[222:223], v53 offset:57856
    s_branch R_cend_27
R_cw_28:
    s_cmp_lg_u32 s53, 1
    s_cbranch_scc1 R_cw_29
    ds_read_b64_tr_b16 a[128:129], v52 offset:32768
    ds_read_b64_tr_b16 a[130:131], v52 offset:33280
    ds_read_b64_tr_b16 a[132:133], v52 offset:40960
    ds_read_b64_tr_b16 a[134:135], v52 offset:41472
    ds_read_b64_tr_b16 a[192:193], v53 offset:32768
    ds_read_b64_tr_b16 a[194:195], v53 offset:33280
    ds_read_b64_tr_b16 a[196:197], v53 offset:40960
    ds_read_b64_tr_b16 a[198:199], v53 offset:41472
    ds_read_b64_tr_b16 a[136:137], v52 offset:49152
    ds_read_b64_tr_b16 a[138:139], v52 offset:49664
    ds_read_b64_tr_b16 a[140:141], v52 offset:57344
    ds_read_b64_tr_b16 a[142:143], v52 offset:57856
    ds_read_b64_tr_b16 a[200:201], v53 offset:49152
    ds_read_b64_tr_b16 a[202:203], v53 offset:49664
    ds_read_b64_tr_b16 a[204:205], v53 offset:57344
    ds_read_b64_tr_b16 a[206:207], v53 offset:57856
    s_branch R_cend_27
R_cw_29:
    s_cmp_lg_u32 s53, 2
    s_cbranch_scc1 R_cw_30
    ds_read_b64_tr_b16 a[176:177], v52 offset:32768
    ds_read_b64_tr_b16 a[178:179], v52 offset:33280
    ds_read_b64_tr_b16 a[180:181], v52 offset:40960
    ds_read_b64_tr_b16 a[182:183], v52 offset:41472
    ds_read_b64_tr_b16 a[240:241], v53 offset:32768
    ds_read_b64_tr_b16 a[242:243], v53 offset:33280
    ds_read_b64_tr_b16 a[244:245], v53 offset:40960
    ds_read_b64_tr_b16 a[246:247], v53 offset:41472
    ds_read_b64_tr_b16 a[184:185], v52 offset:49152
    ds_read_b64_tr_b16 a[186:187], v52 offset:49664
    ds_read_b64_tr_b16 a[188:189], v52 offset:57344
    ds_read_b64_tr_b16 a[190:191], v52 offset:57856
    ds_read_b64_tr_b16 a[248:249], v53 offset:49152
    ds_read_b64_tr_b16 a[250:251], v53 offset:49664
    ds_read_b64_tr_b16 a[252:253], v53 offset:57344
    ds_read_b64_tr_b16 a[254:255], v53 offset:57856
    s_branch R_cend_27
R_cw_30:
    ds_read_b64_tr_b16 a[160:161], v52 offset:32768
    ds_read_b64_tr_b16 a[162:163], v52 offset:33280
    ds_read_b64_tr_b16 a[164:165], v52 offset:40960
    ds_read_b64_tr_b16 a[166:167], v52 offset:41472
    ds_read_b64_tr_b16 a[224:225], v53 offset:32768
    ds_read_b64_tr_b16 a[226:227], v53 offset:33280
    ds_read_b64_tr_b16 a[228:229], v53 offset:40960
    ds_read_b64_tr_b16 a[230:231], v53 offset:41472
    ds_read_b64_tr_b16 a[168:169], v52 offset:49152
    ds_read_b64_tr_b16 a[170:171], v52 offset:49664
    ds_read_b64_tr_b16 a[172:173], v52 offset:57344
    ds_read_b64_tr_b16 a[174:175], v52 offset:57856
    ds_read_b64_tr_b16 a[232:233], v53 offset:49152
    ds_read_b64_tr_b16 a[234:235], v53 offset:49664
    ds_read_b64_tr_b16 a[236:237], v53 offset:57344
    ds_read_b64_tr_b16 a[238:239], v53 offset:57856
R_cend_27:
    s_waitcnt lgkmcnt(0)
    s_barrier
    s_lshl_b32 s63, s53, 12
    s_add_u32 m0, s63, 65536
    s_mov_b32 s64, 256
    buffer_load_dwordx4 v61, s[28:31], s64 offen nt lds
    s_lshl_b32 s63, s53, 12
    s_add_u32 m0, s63, 66560
    s_mov_b32 s64, 4352
    buffer_load_dwordx4 v61, s[28:31], s64 offen nt lds
    s_lshl_b32 s63, s53, 12
    s_add_u32 m0, s63, 67584
    s_mov_b32 s64, 8448
    buffer_load_dwordx4 v61, s[28:31], s64 offen nt lds
    s_lshl_b32 s63, s53, 12
    s_add_u32 m0, s63, 68608
    s_mov_b32 s64, 12544
    buffer_load_dwordx4 v61, s[28:31], s64 offen nt lds
    s_lshl_b32 s63, s53, 12
    s_add_u32 m0, s63, 81920
    s_mov_b32 s64, 65792
    buffer_load_dwordx4 v61, s[28:31], s64 offen nt lds
    s_lshl_b32 s63, s53, 12
    s_add_u32 m0, s63, 82944
    s_mov_b32 s64, 69888
    buffer_load_dwordx4 v61, s[28:31], s64 offen nt lds
    s_lshl_b32 s63, s53, 12
    s_add_u32 m0, s63, 83968
    s_mov_b32 s64, 73984
    buffer_load_dwordx4 v61, s[28:31], s64 offen nt lds
    s_lshl_b32 s63, s53, 12
    s_add_u32 m0, s63, 84992
    s_mov_b32 s64, 78080
    buffer_load_dwordx4 v61, s[28:31], s64 offen nt lds
    s_waitcnt vmcnt(24)
    s_barrier
    s_cmp_lg_u32 s53, 0
    s_cbranch_scc1 R_cw_33
    ds_read_b64_tr_b16 a[160:161], v54 offset:0
    ds_read_b64_tr_b16 a[162:163], v54 offset:512
    ds_read_b64_tr_b16 a[164:165], v54 offset:8192
    ds_read_b64_tr_b16 a[166:167], v54 offset:8704
    ds_read_b64_tr_b16 a[224:225], v55 offset:0
    ds_read_b64_tr_b16 a[226:227], v55 offset:512
    ds_read_b64_tr_b16 a[228:229], v55 offset:8192
    ds_read_b64_tr_b16 a[230:231], v55 offset:8704
    ds_read_b64_tr_b16 a[168:169], v54 offset:16384
    ds_read_b64_tr_b16 a[170:171], v54 offset:16896
    ds_read_b64_tr_b16 a[172:173], v54 offset:24576
    ds_read_b64_tr_b16 a[174:175], v54 offset:25088
    ds_read_b64_tr_b16 a[232:233], v55 offset:16384
    ds_read_b64_tr_b16 a[234:235], v55 offset:16896
    ds_read_b64_tr_b16 a[236:237], v55 offset:24576
    ds_read_b64_tr_b16 a[238:239], v55 offset:25088
    s_branch R_cend_32
R_cw_33:
    s_cmp_lg_u32 s53, 1
    s_cbranch_scc1 R_cw_34
    ds_read_b64_tr_b16 a[176:177], v54 offset:0
    ds_read_b64_tr_b16 a[178:179], v54 offset:512
    ds_read_b64_tr_b16 a[180:181], v54 offset:8192
    ds_read_b64_tr_b16 a[182:183], v54 offset:8704
    ds_read_b64_tr_b16 a[240:241], v55 offset:0
    ds_read_b64_tr_b16 a[242:243], v55 offset:512
    ds_read_b64_tr_b16 a[244:245], v55 offset:8192
    ds_read_b64_tr_b16 a[246:247], v55 offset:8704
    ds_read_b64_tr_b16 a[184:185], v54 offset:16384
    ds_read_b64_tr_b16 a[186:187], v54 offset:16896
    ds_read_b64_tr_b16 a[188:189], v54 offset:24576
    ds_read_b64_tr_b16 a[190:191], v54 offset:25088
    ds_read_b64_tr_b16 a[248:249], v55 offset:16384
    ds_read_b64_tr_b16 a[250:251], v55 offset:16896
    ds_read_b64_tr_b16 a[252:253], v55 offset:24576
    ds_read_b64_tr_b16 a[254:255], v55 offset:25088
    s_branch R_cend_32
R_cw_34:
    s_cmp_lg_u32 s53, 2
    s_cbranch_scc1 R_cw_35
    ds_read_b64_tr_b16 a[128:129], v54 offset:0
    ds_read_b64_tr_b16 a[130:131], v54 offset:512
    ds_read_b64_tr_b16 a[132:133], v54 offset:8192
    ds_read_b64_tr_b16 a[134:135], v54 offset:8704
    ds_read_b64_tr_b16 a[192:193], v55 offset:0
    ds_read_b64_tr_b16 a[194:195], v55 offset:512
    ds_read_b64_tr_b16 a[196:197], v55 offset:8192
    ds_read_b64_tr_b16 a[198:199], v55 offset:8704
    ds_read_b64_tr_b16 a[136:137], v54 offset:16384
    ds_read_b64_tr_b16 a[138:139], v54 offset:16896
    ds_read_b64_tr_b16 a[140:141], v54 offset:24576
    ds_read_b64_tr_b16 a[142:143], v54 offset:25088
    ds_read_b64_tr_b16 a[200:201], v55 offset:16384
    ds_read_b64_tr_b16 a[202:203], v55 offset:16896
    ds_read_b64_tr_b16 a[204:205], v55 offset:24576
    ds_read_b64_tr_b16 a[206:207], v55 offset:25088
    s_branch R_cend_32
R_cw_35:
    ds_read_b64_tr_b16 a[144:145], v54 offset:0
    ds_read_b64_tr_b16 a[146:147], v54 offset:512
    ds_read_b64_tr_b16 a[148:149], v54 offset:8192
    ds_read_b64_tr_b16 a[150:151], v54 offset:8704
    ds_read_b64_tr_b16 a[208:209], v55 offset:0
    ds_read_b64_tr_b16 a[210:211], v55 offset:512
    ds_read_b64_tr_b16 a[212:213], v55 offset:8192
    ds_read_b64_tr_b16 a[214:215], v55 offset:8704
    ds_read_b64_tr_b16 a[152:153], v54 offset:16384
    ds_read_b64_tr_b16 a[154:155], v54 offset:16896
    ds_read_b64_tr_b16 a[156:157], v54 offset:24576
    ds_read_b64_tr_b16 a[158:159], v54 offset:25088
    ds_read_b64_tr_b16 a[216:217], v55 offset:16384
    ds_read_b64_tr_b16 a[218:219], v55 offset:16896
    ds_read_b64_tr_b16 a[220:221], v55 offset:24576
    ds_read_b64_tr_b16 a[222:223], v55 offset:25088
R_cend_32:
    s_waitcnt lgkmcnt(0)
    s_barrier
    s_lshl_b32 s63, s53, 12
    s_add_u32 m0, s63, 98304
    s_mov_b32 s64, 512
    buffer_load_dwordx4 v61, s[28:31], s64 offen nt lds
    s_lshl_b32 s63, s53, 12
    s_add_u32 m0, s63, 99328
    s_mov_b32 s64, 4608
    buffer_load_dwordx4 v61, s[28:31], s64 offen nt lds
    s_lshl_b32 s63, s53, 12
    s_add_u32 m0, s63, 100352
    s_mov_b32 s64, 8704
    buffer_load_dwordx4 v61, s[28:31], s64 offen nt lds
    s_lshl_b32 s63, s53, 12
    s_add_u32 m0, s63, 101376
    s_mov_b32 s64, 12800
    buffer_load_dwordx4 v61, s[28:31], s64 offen nt lds
    s_lshl_b32 s63, s53, 12
    s_add_u32 m0, s63, 114688
    s_mov_b32 s64, 66048
    buffer_load_dwordx4 v61, s[28:31], s64 offen nt lds
    s_lshl_b32 s63, s53, 12
    s_add_u32 m0, s63, 115712
    s_mov_b32 s64, 70144
    buffer_load_dwordx4 v61, s[28:31], s64 offen nt lds
    s_lshl_b32 s63, s53, 12
    s_add_u32 m0, s63, 116736
    s_mov_b32 s64, 74240
    buffer_load_dwordx4 v61, s[28:31], s64 offen nt lds
    s_lshl_b32 s63, s53, 12
    s_add_u32 m0, s63, 117760
    s_mov_b32 s64, 78336
    buffer_load_dwordx4 v61, s[28:31], s64 offen nt lds
    s_waitcnt vmcnt(24)
    s_barrier
    s_cmp_lg_u32 s53, 0
    s_cbranch_scc1 R_cw_38
    ds_read_b64_tr_b16 a[176:177], v54 offset:32768
    ds_read_b64_tr_b16 a[178:179], v54 offset:33280
    ds_read_b64_tr_b16 a[180:181], v54 offset:40960
    ds_read_b64_tr_b16 a[182:183], v54 offset:41472
    ds_read_b64_tr_b16 a[240:241], v55 offset:32768
    ds_read_b64_tr_b16 a[242:243], v55 offset:33280
    ds_read_b64_tr_b16 a[244:245], v55 offset:40960
    ds_read_b64_tr_b16 a[246:247], v55 offset:41472
    ds_read_b64_tr_b16 a[184:185], v54 offset:49152
    ds_read_b64_tr_b16 a[186:187], v54 offset:49664
    ds_read_b64_tr_b16 a[188:189], v54 offset:57344
    ds_read_b64_tr_b16 a[190:191], v54 offset:57856
    ds_read_b64_tr_b16 a[248:249], v55 offset:49152
    ds_read_b64_tr_b16 a[250:251], v55 offset:49664
    ds_read_b64_tr_b16 a[252:253], v55 offset:57344
    ds_read_b64_tr_b16 a[254:255], v55 offset:57856
    s_branch R_cend_37
R_cw_38:
    s_cmp_lg_u32 s53, 1
    s_cbranch_scc1 R_cw_39
    ds_read_b64_tr_b16 a[160:161], v54 offset:32768
    ds_read_b64_tr_b16 a[162:163], v54 offset:33280
    ds_read_b64_tr_b16 a[164:165], v54 offset:40960
    ds_read_b64_tr_b16 a[166:167], v54 offset:41472
    ds_read_b64_tr_b16 a[224:225], v55 offset:32768
    ds_read_b64_tr_b16 a[226:227], v55 offset:33280
    ds_read_b64_tr_b16 a[228:229], v55 offset:40960
    ds_read_b64_tr_b16 a[230:231], v55 offset:41472
    ds_read_b64_tr_b16 a[168:169], v54 offset:49152
    ds_read_b64_tr_b16 a[170:171], v54 offset:49664
    ds_read_b64_tr_b16 a[172:173], v54 offset:57344
    ds_read_b64_tr_b16 a[174:175], v54 offset:57856
    ds_read_b64_tr_b16 a[232:233], v55 offset:49152
    ds_read_b64_tr_b16 a[234:235], v55 offset:49664
    ds_read_b64_tr_b16 a[236:237], v55 offset:57344
    ds_read_b64_tr_b16 a[238:239], v55 offset:57856
    s_branch R_cend_37
R_cw_39:
    s_cmp_lg_u32 s53, 2
    s_cbranch_scc1 R_cw_40
    ds_read_b64_tr_b16 a[144:145], v54 offset:32768
    ds_read_b64_tr_b16 a[146:147], v54 offset:33280
    ds_read_b64_tr_b16 a[148:149], v54 offset:40960
    ds_read_b64_tr_b16 a[150:151], v54 offset:41472
    ds_read_b64_tr_b16 a[208:209], v55 offset:32768
    ds_read_b64_tr_b16 a[210:211], v55 offset:33280
    ds_read_b64_tr_b16 a[212:213], v55 offset:40960
    ds_read_b64_tr_b16 a[214:215], v55 offset:41472
    ds_read_b64_tr_b16 a[152:153], v54 offset:49152
    ds_read_b64_tr_b16 a[154:155], v54 offset:49664
    ds_read_b64_tr_b16 a[156:157], v54 offset:57344
    ds_read_b64_tr_b16 a[158:159], v54 offset:57856
    ds_read_b64_tr_b16 a[216:217], v55 offset:49152
    ds_read_b64_tr_b16 a[218:219], v55 offset:49664
    ds_read_b64_tr_b16 a[220:221], v55 offset:57344
    ds_read_b64_tr_b16 a[222:223], v55 offset:57856
    s_branch R_cend_37
R_cw_40:
    ds_read_b64_tr_b16 a[128:129], v54 offset:32768
    ds_read_b64_tr_b16 a[130:131], v54 offset:33280
    ds_read_b64_tr_b16 a[132:133], v54 offset:40960
    ds_read_b64_tr_b16 a[134:135], v54 offset:41472
    ds_read_b64_tr_b16 a[192:193], v55 offset:32768
    ds_read_b64_tr_b16 a[194:195], v55 offset:33280
    ds_read_b64_tr_b16 a[196:197], v55 offset:40960
    ds_read_b64_tr_b16 a[198:199], v55 offset:41472
    ds_read_b64_tr_b16 a[136:137], v54 offset:49152
    ds_read_b64_tr_b16 a[138:139], v54 offset:49664
    ds_read_b64_tr_b16 a[140:141], v54 offset:57344
    ds_read_b64_tr_b16 a[142:143], v54 offset:57856
    ds_read_b64_tr_b16 a[200:201], v55 offset:49152
    ds_read_b64_tr_b16 a[202:203], v55 offset:49664
    ds_read_b64_tr_b16 a[204:205], v55 offset:57344
    ds_read_b64_tr_b16 a[206:207], v55 offset:57856
R_cend_37:
    s_waitcnt lgkmcnt(0)
    s_barrier
    s_lshl_b32 s63, s53, 12
    s_add_u32 m0, s63, 131072
    s_mov_b32 s64, 768
    buffer_load_dwordx4 v61, s[28:31], s64 offen nt lds
    s_lshl_b32 s63, s53, 12
    s_add_u32 m0, s63, 132096
    s_mov_b32 s64, 4864
    buffer_load_dwordx4 v61, s[28:31], s64 offen nt lds
    s_lshl_b32 s63, s53, 12
    s_add_u32 m0, s63, 133120
    s_mov_b32 s64, 8960
    buffer_load_dwordx4 v61, s[28:31], s64 offen nt lds
    s_lshl_b32 s63, s53, 12
    s_add_u32 m0, s63, 134144
    s_mov_b32 s64, 13056
    buffer_load_dwordx4 v61, s[28:31], s64 offen nt lds
    s_lshl_b32 s63, s53, 12
    s_add_u32 m0, s63, 147456
    s_mov_b32 s64, 66304
    buffer_load_dwordx4 v61, s[28:31], s64 offen nt lds
    s_lshl_b32 s63, s53, 12
    s_add_u32 m0, s63, 148480
    s_mov_b32 s64, 70400
    buffer_load_dwordx4 v61, s[28:31], s64 offen nt lds
    s_lshl_b32 s63, s53, 12
    s_add_u32 m0, s63, 149504
    s_mov_b32 s64, 74496
    buffer_load_dwordx4 v61, s[28:31], s64 offen nt lds
    s_lshl_b32 s63, s53, 12
    s_add_u32 m0, s63, 150528
    s_mov_b32 s64, 78592
    buffer_load_dwordx4 v61, s[28:31], s64 offen nt lds
    s_waitcnt vmcnt(24)
    s_barrier
    ds_read_b64_tr_b16 v[128:129], v96 offset:0
    ds_read_b64_tr_b16 v[130:131], v96 offset:512
    ds_read_b64_tr_b16 v[132:133], v96 offset:2048
    ds_read_b64_tr_b16 v[134:135], v96 offset:2560
    ds_read_b64_tr_b16 v[136:137], v97 offset:0
    ds_read_b64_tr_b16 v[138:139], v97 offset:512
    ds_read_b64_tr_b16 v[140:141], v97 offset:2048
    ds_read_b64_tr_b16 v[142:143], v97 offset:2560
    ds_read_b64_tr_b16 v[144:145], v98 offset:0
    ds_read_b64_tr_b16 v[146:147], v98 offset:512
    ds_read_b64_tr_b16 v[148:149], v98 offset:2048
    ds_read_b64_tr_b16 v[150:151], v98 offset:2560
    ds_read_b64_tr_b16 v[152:153], v99 offset:0
    ds_read_b64_tr_b16 v[154:155], v99 offset:512
    ds_read_b64_tr_b16 v[156:157], v99 offset:2048
    ds_read_b64_tr_b16 v[158:159], v99 offset:2560
    s_waitcnt lgkmcnt(0)
    s_barrier
    s_lshl_b32 s63, s53, 10
    s_add_u32 m0, s63, 32768
    s_mov_b32 s64, 0
    buffer_load_dwordx4 v60, s[20:23], s64 offen nt lds
    s_lshl_b32 s63, s53, 10
    s_add_u32 m0, s63, 36864
    s_mov_b32 s64, 131072
    buffer_load_dwordx4 v60, s[20:23], s64 offen nt lds
    s_lshl_b32 s63, s53, 10
    s_add_u32 m0, s63, 40960
    s_mov_b32 s64, 262144
    buffer_load_dwordx4 v60, s[20:23], s64 offen nt lds
    s_lshl_b32 s63, s53, 10
    s_add_u32 m0, s63, 45056
    s_mov_b32 s64, 393216
    buffer_load_dwordx4 v60, s[20:23], s64 offen nt lds
    s_lshl_b32 s63, s53, 10
    s_add_u32 m0, s63, 49152
    s_mov_b32 s64, 524288
    buffer_load_dwordx4 v60, s[20:23], s64 offen nt lds
    s_lshl_b32 s63, s53, 10
    s_add_u32 m0, s63, 53248
    s_mov_b32 s64, 655360
    buffer_load_dwordx4 v60, s[20:23], s64 offen nt lds
    s_lshl_b32 s63, s53, 10
    s_add_u32 m0, s63, 57344
    s_mov_b32 s64, 786432
    buffer_load_dwordx4 v60, s[20:23], s64 offen nt lds
    s_lshl_b32 s63, s53, 10
    s_add_u32 m0, s63, 61440
    s_mov_b32 s64, 917504
    buffer_load_dwordx4 v60, s[20:23], s64 offen nt lds
    s_waitcnt vmcnt(24)
    s_barrier
    ds_read_b64_tr_b16 v[160:161], v96 offset:32768
    ds_read_b64_tr_b16 v[162:163], v96 offset:33280
    ds_read_b64_tr_b16 v[164:165], v96 offset:34816
    ds_read_b64_tr_b16 v[166:167], v96 offset:35328
    ds_read_b64_tr_b16 v[168:169], v97 offset:32768
    ds_read_b64_tr_b16 v[170:171], v97 offset:33280
    ds_read_b64_tr_b16 v[172:173], v97 offset:34816
    ds_read_b64_tr_b16 v[174:175], v97 offset:35328
    ds_read_b64_tr_b16 v[176:177], v98 offset:32768
    ds_read_b64_tr_b16 v[178:179], v98 offset:33280
    ds_read_b64_tr_b16 v[180:181], v98 offset:34816
    ds_read_b64_tr_b16 v[182:183], v98 offset:35328
    ds_read_b64_tr_b16 v[184:185], v99 offset:32768
    ds_read_b64_tr_b16 v[186:187], v99 offset:33280
    ds_read_b64_tr_b16 v[188:189], v99 offset:34816
    ds_read_b64_tr_b16 v[190:191], v99 offset:35328
    s_waitcnt lgkmcnt(0)
    s_barrier
    s_lshl_b32 s63, s53, 10
    s_add_u32 m0, s63, 65536
    s_mov_b32 s64, 1048576
    buffer_load_dwordx4 v60, s[20:23], s64 offen nt lds
    s_lshl_b32 s63, s53, 10
    s_add_u32 m0, s63, 69632
    s_mov_b32 s64, 1179648
    buffer_load_dwordx4 v60, s[20:23], s64 offen nt lds
    s_lshl_b32 s63, s53, 10
    s_add_u32 m0, s63, 73728
    s_mov_b32 s64, 1310720
    buffer_load_dwordx4 v60, s[20:23], s64 offen nt lds
    s_lshl_b32 s63, s53, 10
    s_add_u32 m0, s63, 77824
    s_mov_b32 s64, 1441792
    buffer_load_dwordx4 v60, s[20:23], s64 offen nt lds
    s_lshl_b32 s63, s53, 10
    s_add_u32 m0, s63, 81920
    s_mov_b32 s64, 1572864
    buffer_load_dwordx4 v60, s[20:23], s64 offen nt lds
    s_lshl_b32 s63, s53, 10
    s_add_u32 m0, s63, 86016
    s_mov_b32 s64, 1703936
    buffer_load_dwordx4 v60, s[20:23], s64 offen nt lds
    s_lshl_b32 s63, s53, 10
    s_add_u32 m0, s63, 90112
    s_mov_b32 s64, 1835008
    buffer_load_dwordx4 v60, s[20:23], s64 offen nt lds
    s_lshl_b32 s63, s53, 10
    s_add_u32 m0, s63, 94208
    s_mov_b32 s64, 1966080
    buffer_load_dwordx4 v60, s[20:23], s64 offen nt lds
    s_waitcnt vmcnt(24)
    s_barrier
    ds_read_b64_tr_b16 v[192:193], v100 offset:0
    ds_read_b64_tr_b16 v[194:195], v100 offset:512
    ds_read_b64_tr_b16 v[196:197], v100 offset:2048
    ds_read_b64_tr_b16 v[198:199], v100 offset:2560
    ds_read_b64_tr_b16 v[200:201], v101 offset:0
    ds_read_b64_tr_b16 v[202:203], v101 offset:512
    ds_read_b64_tr_b16 v[204:205], v101 offset:2048
    ds_read_b64_tr_b16 v[206:207], v101 offset:2560
    ds_read_b64_tr_b16 v[208:209], v102 offset:0
    ds_read_b64_tr_b16 v[210:211], v102 offset:512
    ds_read_b64_tr_b16 v[212:213], v102 offset:2048
    ds_read_b64_tr_b16 v[214:215], v102 offset:2560
    ds_read_b64_tr_b16 v[216:217], v103 offset:0
    ds_read_b64_tr_b16 v[218:219], v103 offset:512
    ds_read_b64_tr_b16 v[220:221], v103 offset:2048
    ds_read_b64_tr_b16 v[222:223], v103 offset:2560
    s_waitcnt lgkmcnt(0)
    s_barrier
    s_lshl_b32 s63, s53, 10
    s_add_u32 m0, s63, 98304
    s_mov_b32 s64, 2097152
    buffer_load_dwordx4 v60, s[20:23], s64 offen nt lds
    s_lshl_b32 s63, s53, 10
    s_add_u32 m0, s63, 102400
    s_mov_b32 s64, 2228224
    buffer_load_dwordx4 v60, s[20:23], s64 offen nt lds
    s_lshl_b32 s63, s53, 10
    s_add_u32 m0, s63, 106496
    s_mov_b32 s64, 2359296
    buffer_load_dwordx4 v60, s[20:23], s64 offen nt lds
    s_lshl_b32 s63, s53, 10
    s_add_u32 m0, s63, 110592
    s_mov_b32 s64, 2490368
    buffer_load_dwordx4 v60, s[20:23], s64 offen nt lds
    s_lshl_b32 s63, s53, 10
    s_add_u32 m0, s63, 114688
    s_mov_b32 s64, 2621440
    buffer_load_dwordx4 v60, s[20:23], s64 offen nt lds
    s_lshl_b32 s63, s53, 10
    s_add_u32 m0, s63, 118784
    s_mov_b32 s64, 2752512
    buffer_load_dwordx4 v60, s[20:23], s64 offen nt lds
    s_lshl_b32 s63, s53, 10
    s_add_u32 m0, s63, 122880
    s_mov_b32 s64, 2883584
    buffer_load_dwordx4 v60, s[20:23], s64 offen nt lds
    s_lshl_b32 s63, s53, 10
    s_add_u32 m0, s63, 126976
    s_mov_b32 s64, 3014656
    buffer_load_dwordx4 v60, s[20:23], s64 offen nt lds
    s_waitcnt vmcnt(24)
    s_barrier
    ds_read_b64_tr_b16 v[224:225], v100 offset:32768
    ds_read_b64_tr_b16 v[226:227], v100 offset:33280
    ds_read_b64_tr_b16 v[228:229], v100 offset:34816
    ds_read_b64_tr_b16 v[230:231], v100 offset:35328
    ds_read_b64_tr_b16 v[232:233], v101 offset:32768
    ds_read_b64_tr_b16 v[234:235], v101 offset:33280
    ds_read_b64_tr_b16 v[236:237], v101 offset:34816
    ds_read_b64_tr_b16 v[238:239], v101 offset:35328
    ds_read_b64_tr_b16 v[240:241], v102 offset:32768
    ds_read_b64_tr_b16 v[242:243], v102 offset:33280
    ds_read_b64_tr_b16 v[244:245], v102 offset:34816
    ds_read_b64_tr_b16 v[246:247], v102 offset:35328
    ds_read_b64_tr_b16 v[248:249], v103 offset:32768
    ds_read_b64_tr_b16 v[250:251], v103 offset:33280
    ds_read_b64_tr_b16 v[252:253], v103 offset:34816
    ds_read_b64_tr_b16 v[254:255], v103 offset:35328
    s_waitcnt lgkmcnt(0)
    s_barrier
    s_lshl_b32 s63, s53, 10
    s_add_u32 m0, s63, 131072
    s_mov_b32 s64, 3145728
    buffer_load_dwordx4 v60, s[20:23], s64 offen nt lds
    s_lshl_b32 s63, s53, 10
    s_add_u32 m0, s63, 135168
    s_mov_b32 s64, 3276800
    buffer_load_dwordx4 v60, s[20:23], s64 offen nt lds
    s_lshl_b32 s63, s53, 10
    s_add_u32 m0, s63, 139264
    s_mov_b32 s64, 3407872
    buffer_load_dwordx4 v60, s[20:23], s64 offen nt lds
    s_lshl_b32 s63, s53, 10
    s_add_u32 m0, s63, 143360
    s_mov_b32 s64, 3538944
    buffer_load_dwordx4 v60, s[20:23], s64 offen nt lds
    s_lshl_b32 s63, s53, 10
    s_add_u32 m0, s63, 147456
    s_mov_b32 s64, 3670016
    buffer_load_dwordx4 v60, s[20:23], s64 offen nt lds
    s_lshl_b32 s63, s53, 10
    s_add_u32 m0, s63, 151552
    s_mov_b32 s64, 3801088
    buffer_load_dwordx4 v60, s[20:23], s64 offen nt lds
    s_lshl_b32 s63, s53, 10
    s_add_u32 m0, s63, 155648
    s_mov_b32 s64, 3932160
    buffer_load_dwordx4 v60, s[20:23], s64 offen nt lds
    s_lshl_b32 s63, s53, 10
    s_add_u32 m0, s63, 159744
    s_mov_b32 s64, 4063232
    buffer_load_dwordx4 v60, s[20:23], s64 offen nt lds
    s_waitcnt vmcnt(24)
    s_barrier
    ds_read_b64_tr_b16 v[64:65], v52 offset:0
    ds_read_b64_tr_b16 v[66:67], v52 offset:512
    ds_read_b64_tr_b16 v[68:69], v52 offset:8192
    ds_read_b64_tr_b16 v[70:71], v52 offset:8704
    ds_read_b64_tr_b16 v[72:73], v53 offset:0
    ds_read_b64_tr_b16 v[74:75], v53 offset:512
    ds_read_b64_tr_b16 v[76:77], v53 offset:8192
    ds_read_b64_tr_b16 v[78:79], v53 offset:8704
    ds_read_b64_tr_b16 v[80:81], v52 offset:16384
    ds_read_b64_tr_b16 v[82:83], v52 offset:16896
    ds_read_b64_tr_b16 v[84:85], v52 offset:24576
    ds_read_b64_tr_b16 v[86:87], v52 offset:25088
    ds_read_b64_tr_b16 v[88:89], v53 offset:16384
    ds_read_b64_tr_b16 v[90:91], v53 offset:16896
    ds_read_b64_tr_b16 v[92:93], v53 offset:24576
    ds_read_b64_tr_b16 v[94:95], v53 offset:25088
    s_waitcnt lgkmcnt(0)
    s_barrier
    v_mov_b32 v109, v8
    ds_write_b128 v109, v[64:67] offset:0
    ds_write_b128 v109, v[68:71] offset:1024
    s_cmp_eq_u32 s53, 3
    s_cbranch_scc1 R_res_42
    ds_write_b128 v109, v[72:75] offset:8192
    ds_write_b128 v109, v[76:79] offset:9216
    ds_write_b128 v109, v[80:83] offset:16384
    ds_write_b128 v109, v[84:87] offset:17408
    ds_write_b128 v109, v[88:91] offset:24576
    ds_write_b128 v109, v[92:95] offset:25600
    s_branch R_rese_43
R_res_42:
    v_mov_b32 v24, v72
    v_mov_b32 v25, v73
    v_mov_b32 v26, v74
    v_mov_b32 v27, v75
    v_mov_b32 v28, v76
    v_mov_b32 v29, v77
    v_mov_b32 v30, v78
    v_mov_b32 v31, v79
    v_mov_b32 v32, v80
    v_mov_b32 v33, v81
    v_mov_b32 v34, v82
    v_mov_b32 v35, v83
    v_mov_b32 v36, v84
    v_mov_b32 v37, v85
    v_mov_b32 v38, v86
    v_mov_b32 v39, v87
    v_mov_b32 v40, v88
    v_mov_b32 v41, v89
    v_mov_b32 v42, v90
    v_mov_b32 v43, v91
    v_mov_b32 v44, v92
    v_mov_b32 v45, v93
    v_mov_b32 v46, v94
    v_mov_b32 v47, v95
R_rese_43:
    s_waitcnt lgkmcnt(0)
    s_waitcnt vmcnt(16)
    s_barrier
    ds_read_b64_tr_b16 v[64:65], v52 offset:32768
    ds_read_b64_tr_b16 v[66:67], v52 offset:33280
    ds_read_b64_tr_b16 v[68:69], v52 offset:40960
    ds_read_b64_tr_b16 v[70:71], v52 offset:41472
    ds_read_b64_tr_b16 v[72:73], v53 offset:32768
    ds_read_b64_tr_b16 v[74:75], v53 offset:33280
    ds_read_b64_tr_b16 v[76:77], v53 offset:40960
    ds_read_b64_tr_b16 v[78:79], v53 offset:41472
    ds_read_b64_tr_b16 v[80:81], v52 offset:49152
    ds_read_b64_tr_b16 v[82:83], v52 offset:49664
    ds_read_b64_tr_b16 v[84:85], v52 offset:57344
    ds_read_b64_tr_b16 v[86:87], v52 offset:57856
    ds_read_b64_tr_b16 v[88:89], v53 offset:49152
    ds_read_b64_tr_b16 v[90:91], v53 offset:49664
    ds_read_b64_tr_b16 v[92:93], v53 offset:57344
    ds_read_b64_tr_b16 v[94:95], v53 offset:57856
    s_waitcnt lgkmcnt(0)
    s_barrier
    v_mov_b32 v109, v8
    ds_write_b128 v109, v[64:67] offset:32768
    ds_write_b128 v109, v[68:71] offset:33792
    s_cmp_eq_u32 s53, 2
    s_cbranch_scc1 R_res_44
    ds_write_b128 v109, v[72:75] offset:40960
    ds_write_b128 v109, v[76:79] offset:41984
    ds_write_b128 v109, v[80:83] offset:49152
    ds_write_b128 v109, v[84:87] offset:50176
    ds_write_b128 v109, v[88:91] offset:57344
    ds_write_b128 v109, v[92:95] offset:58368
    s_branch R_rese_45
R_res_44:
    v_mov_b32 v24, v72
    v_mov_b32 v25, v73
    v_mov_b32 v26, v74
    v_mov_b32 v27, v75
    v_mov_b32 v28, v76
    v_mov_b32 v29, v77
    v_mov_b32 v30, v78
    v_mov_b32 v31, v79
    v_mov_b32 v32, v80
    v_mov_b32 v33, v81
    v_mov_b32 v34, v82
    v_mov_b32 v35, v83
    v_mov_b32 v36, v84
    v_mov_b32 v37, v85
    v_mov_b32 v38, v86
    v_mov_b32 v39, v87
    v_mov_b32 v40, v88
    v_mov_b32 v41, v89
    v_mov_b32 v42, v90
    v_mov_b32 v43, v91
    v_mov_b32 v44, v92
    v_mov_b32 v45, v93
    v_mov_b32 v46, v94
    v_mov_b32 v47, v95
R_rese_45:
    s_waitcnt lgkmcnt(0)
    s_waitcnt vmcnt(8)
    s_barrier
    ds_read_b64_tr_b16 v[64:65], v54 offset:0
    ds_read_b64_tr_b16 v[66:67], v54 offset:512
    ds_read_b64_tr_b16 v[68:69], v54 offset:8192
    ds_read_b64_tr_b16 v[70:71], v54 offset:8704
    ds_read_b64_tr_b16 v[72:73], v55 offset:0
    ds_read_b64_tr_b16 v[74:75], v55 offset:512
    ds_read_b64_tr_b16 v[76:77], v55 offset:8192
    ds_read_b64_tr_b16 v[78:79], v55 offset:8704
    ds_read_b64_tr_b16 v[80:81], v54 offset:16384
    ds_read_b64_tr_b16 v[82:83], v54 offset:16896
    ds_read_b64_tr_b16 v[84:85], v54 offset:24576
    ds_read_b64_tr_b16 v[86:87], v54 offset:25088
    ds_read_b64_tr_b16 v[88:89], v55 offset:16384
    ds_read_b64_tr_b16 v[90:91], v55 offset:16896
    ds_read_b64_tr_b16 v[92:93], v55 offset:24576
    ds_read_b64_tr_b16 v[94:95], v55 offset:25088
    s_waitcnt lgkmcnt(0)
    s_barrier
    v_add_u32 v109, 0x10000, v8
    ds_write_b128 v109, v[64:67] offset:0
    ds_write_b128 v109, v[68:71] offset:1024
    s_cmp_eq_u32 s53, 1
    s_cbranch_scc1 R_res_46
    ds_write_b128 v109, v[72:75] offset:8192
    ds_write_b128 v109, v[76:79] offset:9216
    ds_write_b128 v109, v[80:83] offset:16384
    ds_write_b128 v109, v[84:87] offset:17408
    ds_write_b128 v109, v[88:91] offset:24576
    ds_write_b128 v109, v[92:95] offset:25600
    s_branch R_rese_47
R_res_46:
    v_mov_b32 v24, v72
    v_mov_b32 v25, v73
    v_mov_b32 v26, v74
    v_mov_b32 v27, v75
    v_mov_b32 v28, v76
    v_mov_b32 v29, v77
    v_mov_b32 v30, v78
    v_mov_b32 v31, v79
    v_mov_b32 v32, v80
    v_mov_b32 v33, v81
    v_mov_b32 v34, v82
    v_mov_b32 v35, v83
    v_mov_b32 v36, v84
    v_mov_b32 v37, v85
    v_mov_b32 v38, v86
    v_mov_b32 v39, v87
    v_mov_b32 v40, v88
    v_mov_b32 v41, v89
    v_mov_b32 v42, v90
    v_mov_b32 v43, v91
    v_mov_b32 v44, v92
    v_mov_b32 v45, v93
    v_mov_b32 v46, v94
    v_mov_b32 v47, v95
R_rese_47:
    s_waitcnt lgkmcnt(0)
    s_waitcnt vmcnt(0)
    s_barrier
    ds_read_b64_tr_b16 v[64:65], v54 offset:32768
    ds_read_b64_tr_b16 v[66:67], v54 offset:33280
    ds_read_b64_tr_b16 v[68:69], v54 offset:40960
    ds_read_b64_tr_b16 v[70:71], v54 offset:41472
    ds_read_b64_tr_b16 v[72:73], v55 offset:32768
    ds_read_b64_tr_b16 v[74:75], v55 offset:33280
    ds_read_b64_tr_b16 v[76:77], v55 offset:40960
    ds_read_b64_tr_b16 v[78:79], v55 offset:41472
    ds_read_b64_tr_b16 v[80:81], v54 offset:49152
    ds_read_b64_tr_b16 v[82:83], v54 offset:49664
    ds_read_b64_tr_b16 v[84:85], v54 offset:57344
    ds_read_b64_tr_b16 v[86:87], v54 offset:57856
    ds_read_b64_tr_b16 v[88:89], v55 offset:49152
    ds_read_b64_tr_b16 v[90:91], v55 offset:49664
    ds_read_b64_tr_b16 v[92:93], v55 offset:57344
    ds_read_b64_tr_b16 v[94:95], v55 offset:57856
    s_waitcnt lgkmcnt(0)
    s_barrier
    v_add_u32 v109, 0x10000, v8
    ds_write_b128 v109, v[64:67] offset:32768
    ds_write_b128 v109, v[68:71] offset:33792
    s_cmp_eq_u32 s53, 0
    s_cbranch_scc1 R_res_48
    ds_write_b128 v109, v[72:75] offset:40960
    ds_write_b128 v109, v[76:79] offset:41984
    ds_write_b128 v109, v[80:83] offset:49152
    ds_write_b128 v109, v[84:87] offset:50176
    ds_write_b128 v109, v[88:91] offset:57344
    ds_write_b128 v109, v[92:95] offset:58368
    s_branch R_rese_49
R_res_48:
    v_mov_b32 v24, v72
    v_mov_b32 v25, v73
    v_mov_b32 v26, v74
    v_mov_b32 v27, v75
    v_mov_b32 v28, v76
    v_mov_b32 v29, v77
    v_mov_b32 v30, v78
    v_mov_b32 v31, v79
    v_mov_b32 v32, v80
    v_mov_b32 v33, v81
    v_mov_b32 v34, v82
    v_mov_b32 v35, v83
    v_mov_b32 v36, v84
    v_mov_b32 v37, v85
    v_mov_b32 v38, v86
    v_mov_b32 v39, v87
    v_mov_b32 v40, v88
    v_mov_b32 v41, v89
    v_mov_b32 v42, v90
    v_mov_b32 v43, v91
    v_mov_b32 v44, v92
    v_mov_b32 v45, v93
    v_mov_b32 v46, v94
    v_mov_b32 v47, v95
R_rese_49:
    s_waitcnt lgkmcnt(0)
    v_mov_b32 v104, v24
    v_mov_b32 v105, v25
    v_mov_b32 v106, v26
    v_mov_b32 v107, v27
    v_mov_b32 v108, v28
    v_mov_b32 v109, v29
    v_mov_b32 v110, v30
    v_mov_b32 v111, v31
    v_mov_b32 v112, v32
    v_mov_b32 v113, v33
    v_mov_b32 v114, v34
    v_mov_b32 v115, v35
    v_mov_b32 v116, v36
    v_mov_b32 v117, v37
    v_mov_b32 v118, v38
    v_mov_b32 v119, v39
    v_mov_b32 v120, v40
    v_mov_b32 v121, v41
    v_mov_b32 v122, v42
    v_mov_b32 v123, v43
    v_mov_b32 v124, v44
    v_mov_b32 v125, v45
    v_mov_b32 v126, v46
    v_mov_b32 v127, v47
    s_xor_b32 s63, s53, 0
    s_lshl_b32 s36, s63, 11
    s_lshl_b32 s63, s63, 15
    s_lshl_b32 s64, s53, 11
    s_add_u32 s63, s63, s64
    s_add_u32 s40, s63, 32768
    s_xor_b32 s63, s53, 1
    s_lshl_b32 s37, s63, 11
    s_lshl_b32 s63, s63, 15
    s_lshl_b32 s64, s53, 11
    s_add_u32 s63, s63, s64
    s_add_u32 s41, s63, 32768
    s_xor_b32 s63, s53, 2
    s_lshl_b32 s38, s63, 11
    s_lshl_b32 s63, s63, 15
    s_lshl_b32 s64, s53, 11
    s_add_u32 s63, s63, s64
    s_add_u32 s42, s63, 32768
    s_xor_b32 s63, s53, 3
    s_lshl_b32 s39, s63, 11
    s_lshl_b32 s63, s63, 15
    s_lshl_b32 s64, s53, 11
    s_add_u32 s63, s63, s64
    s_add_u32 s43, s63, 32768
    s_mov_b32 s54, 0
    s_mov_b32 s55, 0
    s_mov_b32 s57, 0
    s_mov_b32 s89, 262144
    s_mov_b32 s60, 524288
    s_mov_b32 s59, 532480
    s_mov_b32 s61, 540672
    s_lshl_b32 s67, s53, 11
    s_lshl_b32 s63, s52, 13
    s_lshl_b32 s64, s53, 11
    s_add_u32 s62, s63, s64
    s_lshr_b32 s65, s62, 1
    s_sub_u32 s65, s65, 0x20000
    s_mov_b32 s2, 0
    s_mov_b32 s3, 65536
    s_mov_b32 s4, 131072
    s_mov_b32 s5, 196608
    s_barrier
    v_mov_b32 v13, 32
R_iw_50:
    buffer_load_dword v10, v13, s[12:15], 0 offen sc1
    s_waitcnt vmcnt(0)
    v_readfirstlane_b32 s63, v10
    s_add_u32 s55, s55, 1
    s_cmp_gt_u32 s55, 0x200000
    s_cbranch_scc1 R_fail
    s_and_b32 s64, s63, 0xffff
    s_cmp_ge_u32 s64, 32
    s_cbranch_scc1 R_iw_ok
    s_sleep 8
    s_branch R_iw_50
R_iw_ok:
    s_lshr_b32 s63, s63, 16
    s_cmp_eq_u32 s63, 32
    s_cbranch_scc0 R_safe_entry
    s_mov_b32 s63, 0
    s_lshl_b32 s63, s63, 2
    s_add_u32 s63, s63, 128
    s_cmp_lg_u32 s53, 0
    s_cbranch_scc1 R_kvok_52
R_kvw_51:
    buffer_load_dword v52, v17, s[12:15], s63 offen sc1
    s_waitcnt vmcnt(0)
    v_readfirstlane_b32 s64, v52
    s_nop 0
    s_lshr_b32 s64, s64, 16
    s_cmp_ge_u32 s64, 128
    s_cbranch_scc1 R_kvok_52
    s_sleep 8
    s_add_u32 s55, s55, 1
    s_cmp_gt_u32 s55, 0x200000
    s_cbranch_scc1 R_fail
    s_branch R_kvw_51
R_kvok_52:
    s_barrier
    s_mov_b32 s46, 0x1000
    s_add_u32 s1, s43, 8192
    s_add_u32 s6, s43, 16384
    s_add_u32 s44, s43, 24576
    s_add_u32 s45, s67, 8192
    v_add_u32 v8, s40, v0
    s_add_u32 s63, s62, 16777216
    s_mov_b32 m0, s1
    s_nop 0
    buffer_load_dwordx4 v0, s[8:11], s63 offen sc1 lds
    buffer_load_dwordx4 v0, s[8:11], s63 offen offset:1024 sc1 lds
    s_add_u32 s63, s62, 33554432
    s_mov_b32 m0, s6
    s_nop 0
    buffer_load_dwordx4 v0, s[8:11], s63 offen sc1 lds
    buffer_load_dwordx4 v0, s[8:11], s63 offen offset:1024 sc1 lds
    s_add_u32 s62, s62, 262144
    s_waitcnt vmcnt(0)
    v_add_u32 v24, s1, v0
    v_add_u32 v25, s6, v0
    s_mov_b32 s63, s1
    s_mov_b32 s1, s44
    s_mov_b32 s44, s63
    s_mov_b32 s63, s6
    s_mov_b32 s6, s45
    s_mov_b32 s45, s63
    ds_read_b128 v[52:55], v8 offset:0
    ds_read_b128 v[56:59], v8 offset:1024
    ds_read_b128 v[88:91], v8 offset:8192
    ds_read_b128 v[92:95], v8 offset:9216
    ds_read_b128 v[96:99], v8 offset:16384
    ds_read_b128 v[100:103], v8 offset:17408
    s_lshl_b32 s63, s53, 11
    s_add_u32 s58, s60, s63
    s_mov_b32 m0, s67
    s_mov_b32 s101, s61
    v_add_u32 v10, s67, v0
    v_mov_b32 v11, 0
    v_pk_mov_b32 v[64:65], 0, 0
    v_pk_mov_b32 v[66:67], 0, 0
    v_pk_mov_b32 v[68:69], 0, 0
    v_pk_mov_b32 v[70:71], 0, 0
    v_pk_mov_b32 v[72:73], 0, 0
    v_pk_mov_b32 v[74:75], 0, 0
    v_pk_mov_b32 v[76:77], 0, 0
    v_pk_mov_b32 v[78:79], 0, 0
    v_pk_mov_b32 v[80:81], 0, 0
    v_pk_mov_b32 v[82:83], 0, 0
    v_pk_mov_b32 v[84:85], 0, 0
    v_pk_mov_b32 v[86:87], 0, 0
    v_mov_b32 v28, s86
    v_mov_b32 v29, s86
    v_mov_b32 v30, s86
    v_mov_b32 v31, s86
    s_waitcnt vmcnt(0) lgkmcnt(0)
.p2align 6
R_loop_f:
    buffer_load_dwordx4 v[32:35], v0, s[8:11], s58 offen sc1
    buffer_load_dwordx4 v[36:39], v0, s[8:11], s58 offen offset:1024 sc1
    s_nop 15
R_mp_f:
    buffer_load_dwordx4 v[40:43], v0, s[8:11], s58 offen sc1
    buffer_load_dwordx4 v[44:47], v0, s[8:11], s58 offen offset:1024 sc1
    s_waitcnt vmcnt(2)
    ds_write_b128 v10, v[32:35]
    v_max3_u32 v13, v32, v33, v34
    v_max3_u32 v13, v13, v35, v36
    v_max3_u32 v13, v13, v37, v38
    v_max_u32 v13, v13, v39
    v_cmp_eq_u32 vcc, s86, v13
    ds_write_b128 v10, v[36:39] offset:1024
    s_cbranch_vccz R_mok0_f
    buffer_load_dwordx4 v[32:35], v0, s[8:11], s58 offen sc1
    buffer_load_dwordx4 v[36:39], v0, s[8:11], s58 offen offset:1024 sc1
    s_waitcnt vmcnt(2)
    ds_write_b128 v10, v[40:43]
    v_max3_u32 v13, v40, v41, v42
    v_max3_u32 v13, v13, v43, v44
    v_max3_u32 v13, v13, v45, v46
    v_max_u32 v13, v13, v47
    v_cmp_eq_u32 vcc, s86, v13
    ds_write_b128 v10, v[44:47] offset:1024
    s_cbranch_vccz R_mok1_f
    s_add_u32 s55, s55, 1
    s_cmp_gt_u32 s55, 0x200000
    s_cbranch_scc1 R_fail
    s_branch R_mp_f
R_mok1_f:
    v_smfmac_f32_16x16x64_bf16 v[64:67], v[40:43], a[0:7], v1
    v_add_u32 v13, s37, v0
    v_smfmac_f32_16x16x64_bf16 v[68:71], v[40:43], a[64:71], v1
    v_smfmac_f32_16x16x64_bf16 v[64:67], v[44:47], a[8:15], v1
    v_smfmac_f32_16x16x64_bf16 v[68:71], v[44:47], a[72:79], v1
    s_waitcnt lgkmcnt(0)
    s_barrier
    v_smfmac_f32_16x16x64_bf16 v[72:75], v[40:43], v[52:59], v1
    s_waitcnt vmcnt(0)
    ds_read_b128 v[32:35], v13
    ds_read_b128 v[36:39], v13 offset:1024
    ds_read_b128 v[52:55], v8 offset:24576
    ds_read_b128 v[56:59], v8 offset:25600
    v_add_u32 v12, s41, v0
    v_smfmac_f32_16x16x64_bf16 v[76:79], v[40:43], v[88:95], v1
    s_add_u32 s63, s62, 16777216
    s_mov_b32 m0, s1
    ds_read_b128 v[88:91], v12 offset:0
    ds_read_b128 v[92:95], v12 offset:1024
    v_smfmac_f32_16x16x64_bf16 v[72:75], v[44:47], v[96:103], v1
    buffer_load_dwordx4 v0, s[8:11], s63 offen sc1 lds
    ds_read_b128 v[96:99], v12 offset:8192
    ds_read_b128 v[100:103], v12 offset:9216
    v_add_u32 v2, s38, v0
    v_smfmac_f32_16x16x64_bf16 v[80:83], v[40:43], a[128:135], v1
    buffer_load_dwordx4 v0, s[8:11], s63 offen offset:1024 sc1 lds
    s_add_u32 s63, s62, 33554432
    s_mov_b32 m0, s6
    v_smfmac_f32_16x16x64_bf16 v[84:87], v[40:43], a[192:199], v1
    v_smfmac_f32_16x16x64_bf16 v[80:83], v[44:47], a[136:143], v1
    v_smfmac_f32_16x16x64_bf16 v[84:87], v[44:47], a[200:207], v1
    s_waitcnt lgkmcnt(4)
    v_smfmac_f32_16x16x64_bf16 v[76:79], v[44:47], v[52:59], v1
    ds_read_b128 v[52:55], v12 offset:16384
    ds_read_b128 v[56:59], v12 offset:17408
    v_mov_b32 v40, v32
    v_mov_b32 v41, v33
    v_mov_b32 v42, v34
    v_mov_b32 v43, v35
    v_mov_b32 v44, v36
    v_mov_b32 v45, v37
    v_mov_b32 v46, v38
    v_mov_b32 v47, v39
    s_branch R_mok_f
R_mok0_f:
    v_smfmac_f32_16x16x64_bf16 v[64:67], v[32:35], a[0:7], v1
    v_add_u32 v13, s37, v0
    v_smfmac_f32_16x16x64_bf16 v[68:71], v[32:35], a[64:71], v1
    v_smfmac_f32_16x16x64_bf16 v[64:67], v[36:39], a[8:15], v1
    v_smfmac_f32_16x16x64_bf16 v[68:71], v[36:39], a[72:79], v1
    s_waitcnt lgkmcnt(0)
    s_barrier
    v_smfmac_f32_16x16x64_bf16 v[72:75], v[32:35], v[52:59], v1
    s_waitcnt vmcnt(0)
    ds_read_b128 v[40:43], v13
    ds_read_b128 v[44:47], v13 offset:1024
    ds_read_b128 v[52:55], v8 offset:24576
    ds_read_b128 v[56:59], v8 offset:25600
    v_add_u32 v12, s41, v0
    v_smfmac_f32_16x16x64_bf16 v[76:79], v[32:35], v[88:95], v1
    s_add_u32 s63, s62, 16777216
    s_mov_b32 m0, s1
    ds_read_b128 v[88:91], v12 offset:0
    ds_read_b128 v[92:95], v12 offset:1024
    v_smfmac_f32_16x16x64_bf16 v[72:75], v[36:39], v[96:103], v1
    buffer_load_dwordx4 v0, s[8:11], s63 offen sc1 lds
    ds_read_b128 v[96:99], v12 offset:8192
    ds_read_b128 v[100:103], v12 offset:9216
    v_add_u32 v2, s38, v0
    v_smfmac_f32_16x16x64_bf16 v[80:83], v[32:35], a[128:135], v1
    buffer_load_dwordx4 v0, s[8:11], s63 offen offset:1024 sc1 lds
    s_add_u32 s63, s62, 33554432
    s_mov_b32 m0, s6
    v_smfmac_f32_16x16x64_bf16 v[84:87], v[32:35], a[192:199], v1
    v_smfmac_f32_16x16x64_bf16 v[80:83], v[36:39], a[136:143], v1
    v_smfmac_f32_16x16x64_bf16 v[84:87], v[36:39], a[200:207], v1
    s_waitcnt lgkmcnt(4)
    v_smfmac_f32_16x16x64_bf16 v[76:79], v[36:39], v[52:59], v1
    ds_read_b128 v[52:55], v12 offset:16384
    ds_read_b128 v[56:59], v12 offset:17408
R_mok_f:
    v_smfmac_f32_16x16x64_bf16 v[64:67], v[40:43], a[16:23], v1
    ds_read_b128 v[32:35], v2 offset:0
    v_add_u32 v8, s42, v0
    s_waitcnt lgkmcnt(5)
    v_smfmac_f32_16x16x64_bf16 v[72:75], v[40:43], v[88:95], v1
    ds_read_b128 v[88:91], v12 offset:24576
    ds_read_b128 v[92:95], v12 offset:25600
    v_smfmac_f32_16x16x64_bf16 v[68:71], v[40:43], a[80:87], v1
    buffer_load_dwordx4 v0, s[8:11], s63 offen sc1 lds
    s_waitcnt lgkmcnt(5)
    v_smfmac_f32_16x16x64_bf16 v[76:79], v[40:43], v[96:103], v1
    ds_read_b128 v[96:99], v8 offset:0
    ds_read_b128 v[100:103], v8 offset:1024
    v_smfmac_f32_16x16x64_bf16 v[64:67], v[44:47], a[24:31], v1
    ds_read_b128 v[36:39], v2 offset:1024
    v_add_u32 v13, s39, v0
    s_waitcnt lgkmcnt(6)
    v_smfmac_f32_16x16x64_bf16 v[72:75], v[44:47], v[52:59], v1
    ds_read_b128 v[52:55], v8 offset:8192
    ds_read_b128 v[56:59], v8 offset:9216
    v_smfmac_f32_16x16x64_bf16 v[68:71], v[44:47], a[88:95], v1
    buffer_load_dwordx4 v0, s[8:11], s63 offen offset:1024 sc1 lds
    s_add_u32 s62, s62, 262144
    s_waitcnt lgkmcnt(5)
    v_smfmac_f32_16x16x64_bf16 v[76:79], v[44:47], v[88:95], v1
    ds_read_b128 v[88:91], v8 offset:16384
    ds_read_b128 v[92:95], v8 offset:17408
    v_smfmac_f32_16x16x64_bf16 v[64:67], v[32:35], a[32:39], v1
    ds_read_b128 v[40:43], v13 offset:0
    v_add_u32 v12, s43, v0
    s_waitcnt lgkmcnt(6)
    v_smfmac_f32_16x16x64_bf16 v[72:75], v[32:35], v[96:103], v1
    ds_read_b128 v[96:99], v8 offset:24576
    ds_read_b128 v[100:103], v8 offset:25600
    v_smfmac_f32_16x16x64_bf16 v[68:71], v[32:35], a[96:103], v1
    s_waitcnt lgkmcnt(5)
    v_smfmac_f32_16x16x64_bf16 v[76:79], v[32:35], v[52:59], v1
    ds_read_b128 v[52:55], v12 offset:0
    ds_read_b128 v[56:59], v12 offset:1024
    v_smfmac_f32_16x16x64_bf16 v[64:67], v[36:39], a[40:47], v1
    ds_read_b128 v[44:47], v13 offset:1024
    s_waitcnt lgkmcnt(6)
    v_smfmac_f32_16x16x64_bf16 v[72:75], v[36:39], v[88:95], v1
    v_smfmac_f32_16x16x64_bf16 v[68:71], v[36:39], a[104:111], v1
    s_add_u32 s64, s65, 1048576
    buffer_store_dwordx4 v[48:51], v0, s[8:11], s64 offen sc1
    s_add_u32 s65, s65, 0x20000
    s_waitcnt lgkmcnt(3)
    v_smfmac_f32_16x16x64_bf16 v[76:79], v[36:39], v[96:103], v1
    ds_read_b128 v[88:91], v24 offset:0
    ds_read_b128 v[92:95], v24 offset:1024
    ds_read_b128 v[96:99], v25 offset:0
    ds_read_b128 v[100:103], v25 offset:1024
    v_smfmac_f32_16x16x64_bf16 v[64:67], v[40:43], a[48:55], v1
    v_add_u32 v13, s37, v0
    s_waitcnt lgkmcnt(5)
    v_smfmac_f32_16x16x64_bf16 v[72:75], v[40:43], v[52:59], v1
    v_smfmac_f32_16x16x64_bf16 v[68:71], v[40:43], a[112:119], v1
    v_smfmac_f32_16x16x64_bf16 v[76:79], v[40:43], v[104:111], v1
    s_waitcnt lgkmcnt(4)
    v_smfmac_f32_16x16x64_bf16 v[64:67], v[44:47], a[56:63], v1
    v_smfmac_f32_16x16x64_bf16 v[72:75], v[44:47], v[112:119], v1
    v_smfmac_f32_16x16x64_bf16 v[68:71], v[44:47], a[120:127], v1
    s_mov_b64 exec, 1
    buffer_store_dword v11, v17, s[8:11], s88 offen sc1
    s_mov_b64 exec, -1
    v_smfmac_f32_16x16x64_bf16 v[76:79], v[44:47], v[120:127], v1
R_go7_f:
    v_smfmac_f32_16x16x64_bf16 v[80:83], v[32:35], a[160:167], v1
    v_add_f32 v64, v64, v66
    v_add_f32 v65, v65, v67
    v_cvt_pk_bf16_f32 v66, v64, v65
    v_add_f32 v68, v68, v70
    v_add_f32 v69, v69, v71
    v_cvt_pk_bf16_f32 v67, v68, v69
    v_add_f32 v72, v72, v74
    v_add_f32 v73, v73, v75
    v_mfma_f32_16x16x16_bf16 v[52:55], v[66:67], v[16:17], 0
    v_cvt_pk_bf16_f32 v48, v72, v73
    v_add_f32 v76, v76, v78
    v_mfma_f32_16x16x16_bf16 v[56:59], v[66:67], v[18:19], 0
    v_add_f32 v77, v77, v79
    v_cvt_pk_bf16_f32 v49, v76, v77
    s_nop 1
    v_mfma_f32_16x16x16_bf16 v[60:63], v[48:49], v[16:17], 0
    v_cvt_pk_bf16_f32 v68, v52, v53
    v_cvt_pk_bf16_f32 v69, v54, v55
    v_mfma_f32_16x16x16_bf16 v[76:79], v[48:49], v[18:19], 0
    v_cvt_pk_bf16_f32 v70, v56, v57
    v_cvt_pk_bf16_f32 v71, v58, v59
    s_waitcnt lgkmcnt(0)
    v_smfmac_f32_16x16x64_bf16 v[84:87], v[32:35], a[224:231], v1
    ds_read_b128 v[32:35], v13 offset:0
    v_mfma_f32_16x16x32_bf16 v[52:55], v[88:91], v[68:71], 0
    v_cvt_pk_bf16_f32 v72, v60, v61
    v_cvt_pk_bf16_f32 v73, v62, v63
    v_mfma_f32_16x16x32_bf16 v[56:59], v[92:95], v[68:71], 0
    v_cvt_pk_bf16_f32 v74, v76, v77
    v_cvt_pk_bf16_f32 v75, v78, v79
    v_smfmac_f32_16x16x64_bf16 v[80:83], v[36:39], a[168:175], v1
    v_mfma_f32_16x16x32_bf16 v[64:67], v[72:75], v[68:71], 0
    v_cndmask_b32 v52, v52, v56, s[68:69]
    v_cndmask_b32 v53, v53, v57, s[68:69]
    v_cndmask_b32 v54, v54, v58, s[68:69]
    v_cndmask_b32 v55, v55, v59, s[68:69]
    ds_write_b128 v3, v[52:55]
    v_smfmac_f32_16x16x64_bf16 v[84:87], v[36:39], a[232:239], v1
    ds_read_b128 v[36:39], v13 offset:1024
    s_nop 0
    ds_write_b64 v3, v[64:65] offset:3072
    v_smfmac_f32_16x16x64_bf16 v[80:83], v[40:43], a[176:183], v1
    buffer_store_dwordx4 v[28:31], v6, s[8:11], s89 offen
    v_smfmac_f32_16x16x64_bf16 v[84:87], v[40:43], a[240:247], v1
    v_xor_b32 v76, 8192, v3
    v_smfmac_f32_16x16x64_bf16 v[80:83], v[44:47], a[184:191], v1
    v_xor_b32 v77, 12288, v3
    v_smfmac_f32_16x16x64_bf16 v[84:87], v[44:47], a[248:255], v1
    s_waitcnt lgkmcnt(0)
    s_barrier
    ds_read_b128 v[52:55], v0 offset:16384
    ds_read_b128 v[56:59], v0 offset:20480
    ds_read_b128 v[88:91], v0 offset:24576
    ds_read_b128 v[92:95], v0 offset:28672
    ds_read_b64 v[64:65], v0 offset:19456
    ds_read_b64 v[66:67], v0 offset:23552
    ds_read_b64 v[68:69], v0 offset:27648
    ds_read_b64 v[70:71], v0 offset:31744
    v_smfmac_f32_16x16x64_bf16 v[80:83], v[32:35], a[144:151], v1
    buffer_load_dword v12, v17, s[12:15], s46 offen sc1
    v_smfmac_f32_16x16x64_bf16 v[84:87], v[32:35], a[208:215], v1
    buffer_store_dword v28, v7, s[8:11], s101 offen
    v_smfmac_f32_16x16x64_bf16 v[80:83], v[36:39], a[152:159], v1
    v_smfmac_f32_16x16x64_bf16 v[84:87], v[36:39], a[216:223], v1
    s_waitcnt lgkmcnt(4)
    v_add_f32 v52, v52, v56
    v_add_f32 v53, v53, v57
    v_add_f32 v54, v54, v58
    v_add_f32 v55, v55, v59
    ds_read_b128 v[40:43], v17 offset:17408
    ds_read_b128 v[44:47], v17 offset:17408
    v_pk_add_f32 v[88:89], v[88:89], v[92:93]
    v_pk_add_f32 v[90:91], v[90:91], v[94:95]
    v_pk_add_f32 v[52:53], v[52:53], v[88:89]
    v_pk_add_f32 v[54:55], v[54:55], v[90:91]
    s_waitcnt lgkmcnt(2)
    v_pk_mul_f32 v[52:53], v[52:53], s[78:79]
    v_pk_mul_f32 v[54:55], v[54:55], s[78:79]
    v_pk_add_f32 v[64:65], v[64:65], v[66:67]
    v_exp_f32 v52, v52
    v_exp_f32 v53, v53
    v_pk_add_f32 v[68:69], v[68:69], v[70:71]
    v_exp_f32 v54, v54
    v_exp_f32 v55, v55
    v_pk_add_f32 v[64:65], v[64:65], v[68:69]
    v_cvt_pk_bf16_f32 v56, v52, v53
    v_cvt_pk_bf16_f32 v57, v54, v55
    v_pk_mul_f32 v[64:65], v[64:65], s[78:79]
    v_mov_b32_dpp v24, v56 quad_perm:[0,1,0,1] row_mask:0xf bank_mask:0xf
    v_mov_b32_dpp v26, v56 quad_perm:[2,3,2,3] row_mask:0xf bank_mask:0xf
    v_mov_b32_dpp v25, v57 quad_perm:[0,1,0,1] row_mask:0xf bank_mask:0xf
    v_mov_b32_dpp v27, v57 quad_perm:[2,3,2,3] row_mask:0xf bank_mask:0xf
    v_pk_add_f32 v[80:81], v[80:81], v[82:83]
    v_pk_add_f32 v[84:85], v[84:85], v[86:87]
    buffer_store_dwordx4 v[28:31], v6, s[8:11], s89 offen offset:1024
    v_mfma_f32_16x16x32_bf16 v[56:59], v[96:99], v[24:27], 0
    v_exp_f32 v64, v64
    ds_read_b128 v[32:35], v17 offset:17408
    v_mfma_f32_16x16x32_bf16 v[60:63], v[100:103], v[24:27], 0
    v_exp_f32 v65, v65
    ds_read_b128 v[36:39], v17 offset:17408
    v_mfma_f32_16x16x32_bf16 v[28:31], v[20:23], v[24:27], 0
    v_cvt_pk_bf16_f32 v50, v80, v81
    v_cvt_pk_bf16_f32 v14, v64, v65
    v_cvt_pk_bf16_f32 v82, v84, v85
    v_cvt_pk_bf16_f32 v83, v84, v85
    v_cvt_pk_bf16_f32 v51, v84, v85
    s_cmp_eq_u32 s54, 63
    s_cbranch_scc1 R_done_f
    s_nop 0
    v_mfma_f32_16x16x16_bf16 v[28:31], v[20:21], v[14:15], v[28:31]
    v_mfma_f32_16x16x16_bf16 v[56:59], v[50:51], v[14:15], v[56:59]
    v_mfma_f32_16x16x16_bf16 v[60:63], v[82:83], v[14:15], v[60:63]
    v_rcp_f32 v10, v28
    s_nop 0
    v_max_f32 v13, v28, v10
    v_mov_b32 v11, v10
    v_cmp_ngt_f32 vcc, s87, v13
    v_pk_mul_f32 v[56:57], v[56:57], v[10:11]
    v_pk_mul_f32 v[58:59], v[58:59], v[10:11]
    s_nop 0
    v_pk_mul_f32 v[60:61], v[60:61], v[10:11]
    v_pk_mul_f32 v[62:63], v[62:63], v[10:11]
    v_cvt_pk_bf16_f32 v84, v56, v57
    v_cvt_pk_bf16_f32 v85, v58, v59
    v_cvt_pk_bf16_f32 v86, v60, v61
    v_cvt_pk_bf16_f32 v87, v62, v63
    ds_write_b128 v3, v[84:87] offset:2048
    s_waitcnt lgkmcnt(1)
    v_smfmac_f32_16x16x64_bf16 v[40:43], v[84:87], v[128:135], v1
    v_smfmac_f32_16x16x64_bf16 v[44:47], v[84:87], v[160:167], v1
    v_smfmac_f32_16x16x64_bf16 v[32:35], v[84:87], v[192:199], v1
    s_cbranch_vccnz R_slow_f
R_noslow_f:
    s_waitcnt lgkmcnt(0)
    s_barrier
    v_smfmac_f32_16x16x64_bf16 v[36:39], v[84:87], v[224:231], v1
    ds_read_b128 v[52:55], v4 offset:2048
    ds_read_b128 v[56:59], v76 offset:2048
    ds_read_b128 v[60:63], v77 offset:2048
    s_add_u32 s58, s59, s67
    v_cndmask_b32 v24, 0, v9, s[70:71]
    v_cndmask_b32 v25, 0, v9, s[72:73]
    v_cndmask_b32 v26, 0, v9, s[74:75]
    v_cndmask_b32 v27, 0, v9, s[76:77]
    s_waitcnt lgkmcnt(2)
    v_smfmac_f32_16x16x64_bf16 v[40:43], v[52:55], v[136:143], v1
    s_waitcnt lgkmcnt(1)
    v_smfmac_f32_16x16x64_bf16 v[40:43], v[56:59], v[144:151], v1
    s_waitcnt lgkmcnt(0)
    v_smfmac_f32_16x16x64_bf16 v[40:43], v[60:63], v[152:159], v1
    v_smfmac_f32_16x16x64_bf16 v[44:47], v[52:55], v[168:175], v1
    v_smfmac_f32_16x16x64_bf16 v[44:47], v[56:59], v[176:183], v1
    v_cvt_pk_bf16_f32 v40, v40, v41
    v_smfmac_f32_16x16x64_bf16 v[44:47], v[60:63], v[184:191], v1
    v_cvt_pk_bf16_f32 v41, v42, v43
    buffer_store_dwordx2 v[40:41], v5, s[8:11], s2 offen
    v_smfmac_f32_16x16x64_bf16 v[32:35], v[52:55], v[200:207], v1
    v_smfmac_f32_16x16x64_bf16 v[32:35], v[56:59], v[208:215], v1
    v_cvt_pk_bf16_f32 v44, v44, v45
    v_smfmac_f32_16x16x64_bf16 v[32:35], v[60:63], v[216:223], v1
    v_cvt_pk_bf16_f32 v45, v46, v47
    buffer_store_dwordx2 v[44:45], v5, s[8:11], s3 offen
    v_smfmac_f32_16x16x64_bf16 v[36:39], v[52:55], v[232:239], v1
    v_smfmac_f32_16x16x64_bf16 v[36:39], v[56:59], v[240:247], v1
    v_cvt_pk_bf16_f32 v32, v32, v33
    v_smfmac_f32_16x16x64_bf16 v[36:39], v[60:63], v[248:255], v1
    v_cvt_pk_bf16_f32 v33, v34, v35
    buffer_store_dwordx2 v[32:33], v5, s[8:11], s4 offen
    s_nop 5
    v_cvt_pk_bf16_f32 v36, v36, v37
    v_cvt_pk_bf16_f32 v37, v38, v39
    buffer_store_dwordx2 v[36:37], v5, s[8:11], s5 offen
    v_pk_mov_b32 v[64:65], 0, 0
    v_pk_mov_b32 v[66:67], 0, 0
    v_pk_mov_b32 v[68:69], 0, 0
    v_pk_mov_b32 v[70:71], 0, 0
    v_pk_mov_b32 v[72:73], 0, 0
    v_pk_mov_b32 v[74:75], 0, 0
    v_pk_mov_b32 v[76:77], 0, 0
    v_pk_mov_b32 v[78:79], 0, 0
    v_pk_mov_b32 v[80:81], 0, 0
    v_pk_mov_b32 v[82:83], 0, 0
    v_pk_mov_b32 v[84:85], 0, 0
    v_pk_mov_b32 v[86:87], 0, 0
    v_add_u32 v10, s67, v0
    v_mov_b32 v11, s54
    s_mov_b32 s89, s57
    s_mov_b32 s101, s60
    s_xor_b32 s2, s2, 0x40000
    s_xor_b32 s3, s3, 0x40000
    s_xor_b32 s4, s4, 0x40000
    s_xor_b32 s5, s5, 0x40000
    buffer_load_dwordx4 v[32:35], v6, s[8:11], s57 offen sc1
    buffer_load_dwordx4 v[36:39], v6, s[8:11], s57 offen offset:1024 sc1
    s_nop 15
    buffer_load_dwordx4 v[88:91], v6, s[8:11], s57 offen sc1
    buffer_load_dwordx4 v[92:95], v6, s[8:11], s57 offen offset:1024 sc1
    s_nop 15
R_rp_f:
    buffer_load_dwordx4 v[40:43], v6, s[8:11], s57 offen sc1
    buffer_load_dwordx4 v[44:47], v6, s[8:11], s57 offen offset:1024 sc1
    s_waitcnt vmcnt(4)
    v_mfma_f32_16x16x32_bf16 v[28:31], v[32:35], v[24:27], 0
    v_max3_u32 v13, v32, v33, v34
    v_max3_u32 v13, v13, v35, v36
    v_mfma_f32_16x16x32_bf16 v[28:31], v[36:39], v[24:27], v[28:31]
    v_max3_u32 v13, v13, v37, v38
    v_max_u32 v13, v13, v39
    v_cmp_eq_u32 vcc, s86, v13
    s_nop 4
    v_permlane32_swap_b32 v28, v30
    v_permlane32_swap_b32 v29, v31
    s_cbranch_vccz R_rpok_f
    s_nop 7
    buffer_load_dwordx4 v[32:35], v6, s[8:11], s57 offen sc1
    buffer_load_dwordx4 v[36:39], v6, s[8:11], s57 offen offset:1024 sc1
    s_waitcnt vmcnt(4)
    v_mfma_f32_16x16x32_bf16 v[28:31], v[88:91], v[24:27], 0
    v_max3_u32 v13, v88, v89, v90
    v_max3_u32 v13, v13, v91, v92
    v_mfma_f32_16x16x32_bf16 v[28:31], v[92:95], v[24:27], v[28:31]
    v_max3_u32 v13, v13, v93, v94
    v_max_u32 v13, v13, v95
    v_cmp_eq_u32 vcc, s86, v13
    s_nop 4
    v_permlane32_swap_b32 v28, v30
    v_permlane32_swap_b32 v29, v31
    s_cbranch_vccz R_rpok_f
    s_nop 7
    buffer_load_dwordx4 v[88:91], v6, s[8:11], s57 offen sc1
    buffer_load_dwordx4 v[92:95], v6, s[8:11], s57 offen offset:1024 sc1
    s_waitcnt vmcnt(4)
    v_mfma_f32_16x16x32_bf16 v[28:31], v[40:43], v[24:27], 0
    v_max3_u32 v13, v40, v41, v42
    v_max3_u32 v13, v13, v43, v44
    v_mfma_f32_16x16x32_bf16 v[28:31], v[44:47], v[24:27], v[28:31]
    v_max3_u32 v13, v13, v45, v46
    v_max_u32 v13, v13, v47
    v_cmp_eq_u32 vcc, s86, v13
    s_nop 4
    v_permlane32_swap_b32 v28, v30
    v_permlane32_swap_b32 v29, v31
    s_cbranch_vccz R_rpok_f
    s_nop 7
    s_add_u32 s55, s55, 1
    s_cmp_gt_u32 s55, 0x200000
    s_cbranch_scc1 R_fail
    s_branch R_rp_f
R_rpok_f:
    v_add_f32 v28, v28, v30
    v_add_f32 v29, v29, v31
    s_nop 1
    v_permlane16_swap_b32 v28, v29
    v_add_f32 v28, v28, v29
    s_nop 1
    v_mov_b32_dpp v29, v28 quad_perm:[1,1,3,3] row_mask:0xf bank_mask:0xf
    v_cvt_pk_bf16_f32 v13, v28, v29
    buffer_store_dword v13, v7, s[8:11], s59 offen
R_post_f:
    s_cmp_ge_u32 s46, 256
    s_cbranch_scc1 R_nokv_53
    v_readfirstlane_b32 s64, v12
    s_nop 0
    s_lshr_b32 s64, s64, 16
    s_cmp_ge_u32 s64, 128
    s_cbranch_scc1 R_nokv_53
R_kvw_54:
    s_sleep 8
    buffer_load_dword v12, v17, s[12:15], s46 offen sc1
    s_waitcnt vmcnt(0)
    v_readfirstlane_b32 s64, v12
    s_add_u32 s55, s55, 1
    s_cmp_gt_u32 s55, 0x200000
    s_cbranch_scc1 R_fail
    s_lshr_b32 s64, s64, 16
    s_cmp_lt_u32 s64, 128
    s_cbranch_scc1 R_kvw_54
R_nokv_53:
    s_add_u32 s63, s54, 3
    s_lshr_b32 s46, s63, 1
    s_add_u32 s46, s46, 128
    s_and_b32 s64, s63, 0x47
    s_cmp_eq_u32 s64, 0
    s_cselect_b32 s46, s46, 0x1000
    v_add_u32 v24, s1, v0
    v_add_u32 v25, s6, v0
    s_mov_b32 s63, s1
    s_mov_b32 s1, s44
    s_mov_b32 s44, s63
    s_mov_b32 s63, s6
    s_mov_b32 s6, s45
    s_mov_b32 s45, s63
    v_add_u32 v8, s40, v0
    ds_read_b128 v[52:55], v8 offset:0
    ds_read_b128 v[56:59], v8 offset:1024
    ds_read_b128 v[96:99], v8 offset:16384
    ds_read_b128 v[100:103], v8 offset:17408
    v_mov_b32 v28, s86
    v_mov_b32 v29, s86
    v_mov_b32 v30, s86
    v_mov_b32 v31, s86
    s_add_u32 s54, s54, 1
    s_xor_b32 s57, s57, 0x40000
    s_mov_b32 s60, s59
    s_mov_b32 s59, s61
    s_mov_b32 s61, s101
    s_nop 15
    s_waitcnt vmcnt(1)
    ds_read_b128 v[88:91], v8 offset:8192
    ds_read_b128 v[92:95], v8 offset:9216
    s_branch R_loop_f
R_slow_f:
    s_waitcnt lgkmcnt(0)
    s_nop 7
    s_nop 3
    ds_read_b128 v[32:35], v0 offset:16384
    ds_read_b64 v[64:65], v0 offset:19456
    ds_read_b128 v[36:39], v0 offset:20480
    ds_read_b64 v[66:67], v0 offset:23552
    ds_read_b128 v[40:43], v0 offset:24576
    ds_read_b64 v[68:69], v0 offset:27648
    ds_read_b128 v[44:47], v0 offset:28672
    ds_read_b64 v[70:71], v0 offset:31744
    s_waitcnt lgkmcnt(0)
    v_pk_add_f32 v[32:33], v[32:33], v[36:37]
    v_pk_add_f32 v[34:35], v[34:35], v[38:39]
    v_pk_add_f32 v[40:41], v[40:41], v[44:45]
    v_pk_add_f32 v[42:43], v[42:43], v[46:47]
    v_pk_add_f32 v[32:33], v[32:33], v[40:41]
    v_pk_add_f32 v[34:35], v[34:35], v[42:43]
    v_pk_add_f32 v[64:65], v[64:65], v[66:67]
    v_pk_add_f32 v[68:69], v[68:69], v[70:71]
    v_pk_add_f32 v[64:65], v[64:65], v[68:69]
    v_max3_f32 v36, v32, v33, v34
    v_max3_f32 v36, v36, v35, v64
    v_max_f32 v36, v36, v65
    s_nop 1
    v_max_f32_dpp v36, v36, v36 quad_perm:[2,3,0,1] row_mask:0xf bank_mask:0xf
    v_mov_b32 v37, v36
    s_nop 1
    v_permlane32_swap_b32 v36, v37
    v_max_f32 v36, v36, v37
    v_mov_b32 v37, v36
    s_nop 1
    v_permlane16_swap_b32 v36, v37
    v_max_f32 v36, v36, v37
    v_sub_f32 v32, v32, v36
    v_mul_f32 v32, s78, v32
    v_exp_f32 v32, v32
    v_sub_f32 v33, v33, v36
    v_mul_f32 v33, s78, v33
    v_exp_f32 v33, v33
    v_sub_f32 v34, v34, v36
    v_mul_f32 v34, s78, v34
    v_exp_f32 v34, v34
    v_sub_f32 v35, v35, v36
    v_mul_f32 v35, s78, v35
    v_exp_f32 v35, v35
    v_sub_f32 v64, v64, v36
    v_mul_f32 v64, s78, v64
    v_exp_f32 v64, v64
    v_sub_f32 v65, v65, v36
    v_mul_f32 v65, s78, v65
    v_exp_f32 v65, v65
    v_cvt_pk_bf16_f32 v40, v32, v33
    v_cvt_pk_bf16_f32 v41, v34, v35
    v_cvt_pk_bf16_f32 v14, v64, v65
    v_mov_b32_dpp v24, v40 quad_perm:[0,1,0,1] row_mask:0xf bank_mask:0xf
    v_mov_b32_dpp v25, v41 quad_perm:[0,1,0,1] row_mask:0xf bank_mask:0xf
    v_mov_b32_dpp v26, v40 quad_perm:[2,3,2,3] row_mask:0xf bank_mask:0xf
    v_mov_b32_dpp v27, v41 quad_perm:[2,3,2,3] row_mask:0xf bank_mask:0xf
    s_nop 1
    v_mfma_f32_16x16x32_bf16 v[56:59], v[96:99], v[24:27], 0
    v_mfma_f32_16x16x32_bf16 v[60:63], v[100:103], v[24:27], 0
    v_mfma_f32_16x16x32_bf16 v[28:31], v[20:23], v[24:27], 0
    v_mfma_f32_16x16x16_bf16 v[56:59], v[50:51], v[14:15], v[56:59]
    v_mfma_f32_16x16x16_bf16 v[60:63], v[82:83], v[14:15], v[60:63]
    v_mfma_f32_16x16x16_bf16 v[28:31], v[20:21], v[14:15], v[28:31]
    s_nop 7
    v_rcp_f32 v10, v28
    s_nop 0
    v_mul_f32 v56, v56, v10
    v_mul_f32 v57, v57, v10
    v_mul_f32 v58, v58, v10
    v_mul_f32 v59, v59, v10
    v_mul_f32 v60, v60, v10
    v_mul_f32 v61, v61, v10
    v_mul_f32 v62, v62, v10
    v_mul_f32 v63, v63, v10
    ds_read_b128 v[40:43], v17 offset:17408
    ds_read_b128 v[44:47], v17 offset:17408
    ds_read_b128 v[32:35], v17 offset:17408
    ds_read_b128 v[36:39], v17 offset:17408
    s_nop 7
    s_nop 3
    v_xor_b32 v76, 8192, v3
    v_xor_b32 v77, 12288, v3
    v_cvt_pk_bf16_f32 v84, v56, v57
    v_cvt_pk_bf16_f32 v85, v58, v59
    v_cvt_pk_bf16_f32 v86, v60, v61
    v_cvt_pk_bf16_f32 v87, v62, v63
    ds_write_b128 v3, v[84:87] offset:2048
    s_waitcnt lgkmcnt(0)
    s_nop 7
    s_nop 3
    v_smfmac_f32_16x16x64_bf16 v[40:43], v[84:87], v[128:135], v1
    v_smfmac_f32_16x16x64_bf16 v[44:47], v[84:87], v[160:167], v1
    v_smfmac_f32_16x16x64_bf16 v[32:35], v[84:87], v[192:199], v1
    s_branch R_noslow_f
R_done_f:
    s_add_u32 s63, s65, 1048576
    buffer_store_dwordx4 v[48:51], v0, s[8:11], s63 offen sc1
    v_mov_b32 v10, 64
    s_waitcnt vmcnt(0)
    buffer_store_dword v10, v17, s[8:11], s88 offen sc1
    s_endpgm
R_safe_entry:
    s_mov_b32 s63, 0
    s_lshl_b32 s63, s63, 2
    s_add_u32 s63, s63, 128
    s_cmp_lg_u32 s53, 0
    s_cbranch_scc1 R_kvok_56
R_kvw_55:
    buffer_load_dword v52, v17, s[12:15], s63 offen sc1
    s_waitcnt vmcnt(0)
    v_readfirstlane_b32 s64, v52
    s_nop 0
    s_lshr_b32 s64, s64, 16
    s_cmp_ge_u32 s64, 128
    s_cbranch_scc1 R_kvok_56
    s_sleep 8
    s_add_u32 s55, s55, 1
    s_cmp_gt_u32 s55, 0x200000
    s_cbranch_scc1 R_fail
    s_branch R_kvw_55
R_kvok_56:
    s_barrier
    s_mov_b32 s46, 0x1000
    s_add_u32 s1, s43, 8192
    s_add_u32 s6, s43, 16384
    s_add_u32 s44, s43, 24576
    s_add_u32 s45, s67, 8192
    v_add_u32 v8, s40, v0
    s_add_u32 s63, s62, 16777216
    s_mov_b32 m0, s1
    s_nop 0
    buffer_load_dwordx4 v0, s[8:11], s63 offen sc1 lds
    buffer_load_dwordx4 v0, s[8:11], s63 offen offset:1024 sc1 lds
    s_add_u32 s63, s62, 33554432
    s_mov_b32 m0, s6
    s_nop 0
    buffer_load_dwordx4 v0, s[8:11], s63 offen sc1 lds
    buffer_load_dwordx4 v0, s[8:11], s63 offen offset:1024 sc1 lds
    s_add_u32 s62, s62, 262144
    s_waitcnt vmcnt(0)
    v_add_u32 v24, s1, v0
    v_add_u32 v25, s6, v0
    s_mov_b32 s63, s1
    s_mov_b32 s1, s44
    s_mov_b32 s44, s63
    s_mov_b32 s63, s6
    s_mov_b32 s6, s45
    s_mov_b32 s45, s63
    ds_read_b128 v[52:55], v8 offset:0
    ds_read_b128 v[56:59], v8 offset:1024
    ds_read_b128 v[88:91], v8 offset:8192
    ds_read_b128 v[92:95], v8 offset:9216
    ds_read_b128 v[96:99], v8 offset:16384
    ds_read_b128 v[100:103], v8 offset:17408
    s_lshl_b32 s63, s53, 11
    s_add_u32 s58, s60, s63
    s_mov_b32 m0, s67
    s_mov_b32 s101, s61
    v_add_u32 v10, s67, v0
    v_mov_b32 v11, 0
    v_pk_mov_b32 v[64:65], 0, 0
    v_pk_mov_b32 v[66:67], 0, 0
    v_pk_mov_b32 v[68:69], 0, 0
    v_pk_mov_b32 v[70:71], 0, 0
    v_pk_mov_b32 v[72:73], 0, 0
    v_pk_mov_b32 v[74:75], 0, 0
    v_pk_mov_b32 v[76:77], 0, 0
    v_pk_mov_b32 v[78:79], 0, 0
    v_pk_mov_b32 v[80:81], 0, 0
    v_pk_mov_b32 v[82:83], 0, 0
    v_pk_mov_b32 v[84:85], 0, 0
    v_pk_mov_b32 v[86:87], 0, 0
    v_mov_b32 v28, s86
    v_mov_b32 v29, s86
    v_mov_b32 v30, s86
    v_mov_b32 v31, s86
    s_waitcnt vmcnt(0) lgkmcnt(0)
.p2align 6
R_loop_s:
    buffer_load_dwordx4 v[32:35], v0, s[8:11], s58 offen sc1
    buffer_load_dwordx4 v[36:39], v0, s[8:11], s58 offen offset:1024 sc1
    s_nop 15
R_mp_s:
    buffer_load_dwordx4 v[40:43], v0, s[8:11], s58 offen sc1
    buffer_load_dwordx4 v[44:47], v0, s[8:11], s58 offen offset:1024 sc1
    s_waitcnt vmcnt(2)
    ds_write_b128 v10, v[32:35]
    v_max3_u32 v13, v32, v33, v34
    v_max3_u32 v13, v13, v35, v36
    v_max3_u32 v13, v13, v37, v38
    v_max_u32 v13, v13, v39
    v_cmp_eq_u32 vcc, s86, v13
    ds_write_b128 v10, v[36:39] offset:1024
    s_cbranch_vccz R_mok0_s
    buffer_load_dwordx4 v[32:35], v0, s[8:11], s58 offen sc1
    buffer_load_dwordx4 v[36:39], v0, s[8:11], s58 offen offset:1024 sc1
    s_waitcnt vmcnt(2)
    ds_write_b128 v10, v[40:43]
    v_max3_u32 v13, v40, v41, v42
    v_max3_u32 v13, v13, v43, v44
    v_max3_u32 v13, v13, v45, v46
    v_max_u32 v13, v13, v47
    v_cmp_eq_u32 vcc, s86, v13
    ds_write_b128 v10, v[44:47] offset:1024
    s_cbranch_vccz R_mok1_s
    s_add_u32 s55, s55, 1
    s_cmp_gt_u32 s55, 0x200000
    s_cbranch_scc1 R_fail
    s_branch R_mp_s
R_mok1_s:
    v_smfmac_f32_16x16x64_bf16 v[64:67], v[40:43], a[0:7], v1
    v_add_u32 v13, s37, v0
    v_smfmac_f32_16x16x64_bf16 v[68:71], v[40:43], a[64:71], v1
    v_smfmac_f32_16x16x64_bf16 v[64:67], v[44:47], a[8:15], v1
    v_smfmac_f32_16x16x64_bf16 v[68:71], v[44:47], a[72:79], v1
    s_waitcnt lgkmcnt(0)
    s_barrier
    v_smfmac_f32_16x16x64_bf16 v[72:75], v[40:43], v[52:59], v1
    s_waitcnt vmcnt(0)
    ds_read_b128 v[32:35], v13
    ds_read_b128 v[36:39], v13 offset:1024
    ds_read_b128 v[52:55], v8 offset:24576
    ds_read_b128 v[56:59], v8 offset:25600
    v_add_u32 v12, s41, v0
    v_smfmac_f32_16x16x64_bf16 v[76:79], v[40:43], v[88:95], v1
    s_add_u32 s63, s62, 16777216
    s_mov_b32 m0, s1
    ds_read_b128 v[88:91], v12 offset:0
    ds_read_b128 v[92:95], v12 offset:1024
    v_smfmac_f32_16x16x64_bf16 v[72:75], v[44:47], v[96:103], v1
    buffer_load_dwordx4 v0, s[8:11], s63 offen sc1 lds
    ds_read_b128 v[96:99], v12 offset:8192
    ds_read_b128 v[100:103], v12 offset:9216
    v_add_u32 v2, s38, v0
    v_smfmac_f32_16x16x64_bf16 v[80:83], v[40:43], a[128:135], v1
    buffer_load_dwordx4 v0, s[8:11], s63 offen offset:1024 sc1 lds
    s_add_u32 s63, s62, 33554432
    s_mov_b32 m0, s6
    v_smfmac_f32_16x16x64_bf16 v[84:87], v[40:43], a[192:199], v1
    v_smfmac_f32_16x16x64_bf16 v[80:83], v[44:47], a[136:143], v1
    v_smfmac_f32_16x16x64_bf16 v[84:87], v[44:47], a[200:207], v1
    s_waitcnt lgkmcnt(4)
    v_smfmac_f32_16x16x64_bf16 v[76:79], v[44:47], v[52:59], v1
    ds_read_b128 v[52:55], v12 offset:16384
    ds_read_b128 v[56:59], v12 offset:17408
    v_mov_b32 v40, v32
    v_mov_b32 v41, v33
    v_mov_b32 v42, v34
    v_mov_b32 v43, v35
    v_mov_b32 v44, v36
    v_mov_b32 v45, v37
    v_mov_b32 v46, v38
    v_mov_b32 v47, v39
    s_branch R_mok_s
R_mok0_s:
    v_smfmac_f32_16x16x64_bf16 v[64:67], v[32:35], a[0:7], v1
    v_add_u32 v13, s37, v0
    v_smfmac_f32_16x16x64_bf16 v[68:71], v[32:35], a[64:71], v1
    v_smfmac_f32_16x16x64_bf16 v[64:67], v[36:39], a[8:15], v1
    v_smfmac_f32_16x16x64_bf16 v[68:71], v[36:39], a[72:79], v1
    s_waitcnt lgkmcnt(0)
    s_barrier
    v_smfmac_f32_16x16x64_bf16 v[72:75], v[32:35], v[52:59], v1
    s_waitcnt vmcnt(0)
    ds_read_b128 v[40:43], v13
    ds_read_b128 v[44:47], v13 offset:1024
    ds_read_b128 v[52:55], v8 offset:24576
    ds_read_b128 v[56:59], v8 offset:25600
    v_add_u32 v12, s41, v0
    v_smfmac_f32_16x16x64_bf16 v[76:79], v[32:35], v[88:95], v1
    s_add_u32 s63, s62, 16777216
    s_mov_b32 m0, s1
    ds_read_b128 v[88:91], v12 offset:0
    ds_read_b128 v[92:95], v12 offset:1024
    v_smfmac_f32_16x16x64_bf16 v[72:75], v[36:39], v[96:103], v1
    buffer_load_dwordx4 v0, s[8:11], s63 offen sc1 lds
    ds_read_b128 v[96:99], v12 offset:8192
    ds_read_b128 v[100:103], v12 offset:9216
    v_add_u32 v2, s38, v0
    v_smfmac_f32_16x16x64_bf16 v[80:83], v[32:35], a[128:135], v1
    buffer_load_dwordx4 v0, s[8:11], s63 offen offset:1024 sc1 lds
    s_add_u32 s63, s62, 33554432
    s_mov_b32 m0, s6
    v_smfmac_f32_16x16x64_bf16 v[84:87], v[32:35], a[192:199], v1
    v_smfmac_f32_16x16x64_bf16 v[80:83], v[36:39], a[136:143], v1
    v_smfmac_f32_16x16x64_bf16 v[84:87], v[36:39], a[200:207], v1
    s_waitcnt lgkmcnt(4)
    v_smfmac_f32_16x16x64_bf16 v[76:79], v[36:39], v[52:59], v1
    ds_read_b128 v[52:55], v12 offset:16384
    ds_read_b128 v[56:59], v12 offset:17408
R_mok_s:
    v_smfmac_f32_16x16x64_bf16 v[64:67], v[40:43], a[16:23], v1
    ds_read_b128 v[32:35], v2 offset:0
    v_add_u32 v8, s42, v0
    s_waitcnt lgkmcnt(5)
    v_smfmac_f32_16x16x64_bf16 v[72:75], v[40:43], v[88:95], v1
    ds_read_b128 v[88:91], v12 offset:24576
    ds_read_b128 v[92:95], v12 offset:25600
    v_smfmac_f32_16x16x64_bf16 v[68:71], v[40:43], a[80:87], v1
    buffer_load_dwordx4 v0, s[8:11], s63 offen sc1 lds
    s_waitcnt lgkmcnt(5)
    v_smfmac_f32_16x16x64_bf16 v[76:79], v[40:43], v[96:103], v1
    ds_read_b128 v[96:99], v8 offset:0
    ds_read_b128 v[100:103], v8 offset:1024
    v_smfmac_f32_16x16x64_bf16 v[64:67], v[44:47], a[24:31], v1
    ds_read_b128 v[36:39], v2 offset:1024
    v_add_u32 v13, s39, v0
    s_waitcnt lgkmcnt(6)
    v_smfmac_f32_16x16x64_bf16 v[72:75], v[44:47], v[52:59], v1
    ds_read_b128 v[52:55], v8 offset:8192
    ds_read_b128 v[56:59], v8 offset:9216
    v_smfmac_f32_16x16x64_bf16 v[68:71], v[44:47], a[88:95], v1
    buffer_load_dwordx4 v0, s[8:11], s63 offen offset:1024 sc1 lds
    s_add_u32 s62, s62, 262144
    s_waitcnt lgkmcnt(5)
    v_smfmac_f32_16x16x64_bf16 v[76:79], v[44:47], v[88:95], v1
    ds_read_b128 v[88:91], v8 offset:16384
    ds_read_b128 v[92:95], v8 offset:17408
    v_smfmac_f32_16x16x64_bf16 v[64:67], v[32:35], a[32:39], v1
    ds_read_b128 v[40:43], v13 offset:0
    v_add_u32 v12, s43, v0
    s_waitcnt lgkmcnt(6)
    v_smfmac_f32_16x16x64_bf16 v[72:75], v[32:35], v[96:103], v1
    ds_read_b128 v[96:99], v8 offset:24576
    ds_read_b128 v[100:103], v8 offset:25600
    v_smfmac_f32_16x16x64_bf16 v[68:71], v[32:35], a[96:103], v1
    s_waitcnt lgkmcnt(5)
    v_smfmac_f32_16x16x64_bf16 v[76:79], v[32:35], v[52:59], v1
    ds_read_b128 v[52:55], v12 offset:0
    ds_read_b128 v[56:59], v12 offset:1024
    v_smfmac_f32_16x16x64_bf16 v[64:67], v[36:39], a[40:47], v1
    ds_read_b128 v[44:47], v13 offset:1024
    s_waitcnt lgkmcnt(6)
    v_smfmac_f32_16x16x64_bf16 v[72:75], v[36:39], v[88:95], v1
    v_smfmac_f32_16x16x64_bf16 v[68:71], v[36:39], a[104:111], v1
    s_add_u32 s64, s65, 1048576
    buffer_store_dwordx4 v[48:51], v0, s[8:11], s64 offen sc1
    s_add_u32 s65, s65, 0x20000
    s_waitcnt lgkmcnt(3)
    v_smfmac_f32_16x16x64_bf16 v[76:79], v[36:39], v[96:103], v1
    ds_read_b128 v[88:91], v24 offset:0
    ds_read_b128 v[92:95], v24 offset:1024
    ds_read_b128 v[96:99], v25 offset:0
    ds_read_b128 v[100:103], v25 offset:1024
    v_smfmac_f32_16x16x64_bf16 v[64:67], v[40:43], a[48:55], v1
    v_add_u32 v13, s37, v0
    s_waitcnt lgkmcnt(5)
    v_smfmac_f32_16x16x64_bf16 v[72:75], v[40:43], v[52:59], v1
    v_smfmac_f32_16x16x64_bf16 v[68:71], v[40:43], a[112:119], v1
    v_smfmac_f32_16x16x64_bf16 v[76:79], v[40:43], v[104:111], v1
    s_waitcnt lgkmcnt(4)
    v_smfmac_f32_16x16x64_bf16 v[64:67], v[44:47], a[56:63], v1
    v_smfmac_f32_16x16x64_bf16 v[72:75], v[44:47], v[112:119], v1
    v_smfmac_f32_16x16x64_bf16 v[68:71], v[44:47], a[120:127], v1
    s_mov_b64 exec, 1
    buffer_store_dword v11, v17, s[8:11], s88 offen sc1
    s_mov_b64 exec, -1
    v_smfmac_f32_16x16x64_bf16 v[76:79], v[44:47], v[120:127], v1
R_go7_s:
    v_smfmac_f32_16x16x64_bf16 v[80:83], v[32:35], a[160:167], v1
    v_add_f32 v64, v64, v66
    v_add_f32 v65, v65, v67
    v_cvt_pk_bf16_f32 v66, v64, v65
    v_add_f32 v68, v68, v70
    v_add_f32 v69, v69, v71
    v_cvt_pk_bf16_f32 v67, v68, v69
    v_add_f32 v72, v72, v74
    v_add_f32 v73, v73, v75
    v_mfma_f32_16x16x16_bf16 v[52:55], v[66:67], v[16:17], 0
    v_cvt_pk_bf16_f32 v48, v72, v73
    v_add_f32 v76, v76, v78
    v_mfma_f32_16x16x16_bf16 v[56:59], v[66:67], v[18:19], 0
    v_add_f32 v77, v77, v79
    v_cvt_pk_bf16_f32 v49, v76, v77
    s_nop 1
    v_mfma_f32_16x16x16_bf16 v[60:63], v[48:49], v[16:17], 0
    v_cvt_pk_bf16_f32 v68, v52, v53
    v_cvt_pk_bf16_f32 v69, v54, v55
    v_mfma_f32_16x16x16_bf16 v[76:79], v[48:49], v[18:19], 0
    v_cvt_pk_bf16_f32 v70, v56, v57
    v_cvt_pk_bf16_f32 v71, v58, v59
    s_waitcnt lgkmcnt(0)
    v_smfmac_f32_16x16x64_bf16 v[84:87], v[32:35], a[224:231], v1
    ds_read_b128 v[32:35], v13 offset:0
    v_mfma_f32_16x16x32_bf16 v[52:55], v[88:91], v[68:71], 0
    v_cvt_pk_bf16_f32 v72, v60, v61
    v_cvt_pk_bf16_f32 v73, v62, v63
    v_mfma_f32_16x16x32_bf16 v[56:59], v[92:95], v[68:71], 0
    v_cvt_pk_bf16_f32 v74, v76, v77
    v_cvt_pk_bf16_f32 v75, v78, v79
    v_smfmac_f32_16x16x64_bf16 v[80:83], v[36:39], a[168:175], v1
    v_mfma_f32_16x16x32_bf16 v[64:67], v[72:75], v[68:71], 0
    v_cndmask_b32 v52, v52, v56, s[68:69]
    v_cndmask_b32 v53, v53, v57, s[68:69]
    v_cndmask_b32 v54, v54, v58, s[68:69]
    v_cndmask_b32 v55, v55, v59, s[68:69]
    ds_write_b128 v3, v[52:55]
    v_smfmac_f32_16x16x64_bf16 v[84:87], v[36:39], a[232:239], v1
    ds_read_b128 v[36:39], v13 offset:1024
    s_nop 0
    ds_write_b64 v3, v[64:65] offset:3072
    v_smfmac_f32_16x16x64_bf16 v[80:83], v[40:43], a[176:183], v1
    buffer_store_dwordx4 v[28:31], v6, s[8:11], s89 offen sc1
    v_smfmac_f32_16x16x64_bf16 v[84:87], v[40:43], a[240:247], v1
    v_xor_b32 v76, 8192, v3
    v_smfmac_f32_16x16x64_bf16 v[80:83], v[44:47], a[184:191], v1
    v_xor_b32 v77, 12288, v3
    v_smfmac_f32_16x16x64_bf16 v[84:87], v[44:47], a[248:255], v1
    s_waitcnt lgkmcnt(0)
    s_barrier
    ds_read_b128 v[52:55], v0 offset:16384
    ds_read_b128 v[56:59], v0 offset:20480
    ds_read_b128 v[88:91], v0 offset:24576
    ds_read_b128 v[92:95], v0 offset:28672
    ds_read_b64 v[64:65], v0 offset:19456
    ds_read_b64 v[66:67], v0 offset:23552
    ds_read_b64 v[68:69], v0 offset:27648
    ds_read_b64 v[70:71], v0 offset:31744
    v_smfmac_f32_16x16x64_bf16 v[80:83], v[32:35], a[144:151], v1
    buffer_load_dword v12, v17, s[12:15], s46 offen sc1
    v_smfmac_f32_16x16x64_bf16 v[84:87], v[32:35], a[208:215], v1
    buffer_store_dword v28, v7, s[8:11], s101 offen sc1
    v_smfmac_f32_16x16x64_bf16 v[80:83], v[36:39], a[152:159], v1
    v_smfmac_f32_16x16x64_bf16 v[84:87], v[36:39], a[216:223], v1
    s_waitcnt lgkmcnt(4)
    v_add_f32 v52, v52, v56
    v_add_f32 v53, v53, v57
    v_add_f32 v54, v54, v58
    v_add_f32 v55, v55, v59
    ds_read_b128 v[40:43], v17 offset:17408
    ds_read_b128 v[44:47], v17 offset:17408
    v_pk_add_f32 v[88:89], v[88:89], v[92:93]
    v_pk_add_f32 v[90:91], v[90:91], v[94:95]
    v_pk_add_f32 v[52:53], v[52:53], v[88:89]
    v_pk_add_f32 v[54:55], v[54:55], v[90:91]
    s_waitcnt lgkmcnt(2)
    v_pk_mul_f32 v[52:53], v[52:53], s[78:79]
    v_pk_mul_f32 v[54:55], v[54:55], s[78:79]
    v_pk_add_f32 v[64:65], v[64:65], v[66:67]
    v_exp_f32 v52, v52
    v_exp_f32 v53, v53
    v_pk_add_f32 v[68:69], v[68:69], v[70:71]
    v_exp_f32 v54, v54
    v_exp_f32 v55, v55
    v_pk_add_f32 v[64:65], v[64:65], v[68:69]
    v_cvt_pk_bf16_f32 v56, v52, v53
    v_cvt_pk_bf16_f32 v57, v54, v55
    v_pk_mul_f32 v[64:65], v[64:65], s[78:79]
    v_mov_b32_dpp v24, v56 quad_perm:[0,1,0,1] row_mask:0xf bank_mask:0xf
    v_mov_b32_dpp v26, v56 quad_perm:[2,3,2,3] row_mask:0xf bank_mask:0xf
    v_mov_b32_dpp v25, v57 quad_perm:[0,1,0,1] row_mask:0xf bank_mask:0xf
    v_mov_b32_dpp v27, v57 quad_perm:[2,3,2,3] row_mask:0xf bank_mask:0xf
    v_pk_add_f32 v[80:81], v[80:81], v[82:83]
    v_pk_add_f32 v[84:85], v[84:85], v[86:87]
    buffer_store_dwordx4 v[28:31], v6, s[8:11], s89 offen offset:1024 sc1
    v_mfma_f32_16x16x32_bf16 v[56:59], v[96:99], v[24:27], 0
    v_exp_f32 v64, v64
    ds_read_b128 v[32:35], v17 offset:17408
    v_mfma_f32_16x16x32_bf16 v[60:63], v[100:103], v[24:27], 0
    v_exp_f32 v65, v65
    ds_read_b128 v[36:39], v17 offset:17408
    v_mfma_f32_16x16x32_bf16 v[28:31], v[20:23], v[24:27], 0
    v_cvt_pk_bf16_f32 v50, v80, v81
    v_cvt_pk_bf16_f32 v14, v64, v65
    v_cvt_pk_bf16_f32 v82, v84, v85
    v_cvt_pk_bf16_f32 v83, v84, v85
    v_cvt_pk_bf16_f32 v51, v84, v85
    s_cmp_eq_u32 s54, 63
    s_cbranch_scc1 R_done_s
    s_nop 0
    v_mfma_f32_16x16x16_bf16 v[28:31], v[20:21], v[14:15], v[28:31]
    v_mfma_f32_16x16x16_bf16 v[56:59], v[50:51], v[14:15], v[56:59]
    v_mfma_f32_16x16x16_bf16 v[60:63], v[82:83], v[14:15], v[60:63]
    v_rcp_f32 v10, v28
    s_nop 0
    v_max_f32 v13, v28, v10
    v_mov_b32 v11, v10
    v_cmp_ngt_f32 vcc, s87, v13
    v_pk_mul_f32 v[56:57], v[56:57], v[10:11]
    v_pk_mul_f32 v[58:59], v[58:59], v[10:11]
    s_nop 0
    v_pk_mul_f32 v[60:61], v[60:61], v[10:11]
    v_pk_mul_f32 v[62:63], v[62:63], v[10:11]
    v_cvt_pk_bf16_f32 v84, v56, v57
    v_cvt_pk_bf16_f32 v85, v58, v59
    v_cvt_pk_bf16_f32 v86, v60, v61
    v_cvt_pk_bf16_f32 v87, v62, v63
    ds_write_b128 v3, v[84:87] offset:2048
    s_waitcnt lgkmcnt(1)
    v_smfmac_f32_16x16x64_bf16 v[40:43], v[84:87], v[128:135], v1
    v_smfmac_f32_16x16x64_bf16 v[44:47], v[84:87], v[160:167], v1
    v_smfmac_f32_16x16x64_bf16 v[32:35], v[84:87], v[192:199], v1
    s_cbranch_vccnz R_slow_s
R_noslow_s:
    s_waitcnt lgkmcnt(0)
    s_barrier
    v_smfmac_f32_16x16x64_bf16 v[36:39], v[84:87], v[224:231], v1
    ds_read_b128 v[52:55], v4 offset:2048
    ds_read_b128 v[56:59], v76 offset:2048
    ds_read_b128 v[60:63], v77 offset:2048
    s_add_u32 s58, s59, s67
    v_cndmask_b32 v24, 0, v9, s[70:71]
    v_cndmask_b32 v25, 0, v9, s[72:73]
    v_cndmask_b32 v26, 0, v9, s[74:75]
    v_cndmask_b32 v27, 0, v9, s[76:77]
    s_waitcnt lgkmcnt(2)
    v_smfmac_f32_16x16x64_bf16 v[40:43], v[52:55], v[136:143], v1
    s_waitcnt lgkmcnt(1)
    v_smfmac_f32_16x16x64_bf16 v[40:43], v[56:59], v[144:151], v1
    s_waitcnt lgkmcnt(0)
    v_smfmac_f32_16x16x64_bf16 v[40:43], v[60:63], v[152:159], v1
    v_smfmac_f32_16x16x64_bf16 v[44:47], v[52:55], v[168:175], v1
    v_smfmac_f32_16x16x64_bf16 v[44:47], v[56:59], v[176:183], v1
    v_cvt_pk_bf16_f32 v40, v40, v41
    v_smfmac_f32_16x16x64_bf16 v[44:47], v[60:63], v[184:191], v1
    v_cvt_pk_bf16_f32 v41, v42, v43
    buffer_store_dwordx2 v[40:41], v5, s[8:11], s2 offen sc1
    v_smfmac_f32_16x16x64_bf16 v[32:35], v[52:55], v[200:207], v1
    v_smfmac_f32_16x16x64_bf16 v[32:35], v[56:59], v[208:215], v1
    v_cvt_pk_bf16_f32 v44, v44, v45
    v_smfmac_f32_16x16x64_bf16 v[32:35], v[60:63], v[216:223], v1
    v_cvt_pk_bf16_f32 v45, v46, v47
    buffer_store_dwordx2 v[44:45], v5, s[8:11], s3 offen sc1
    v_smfmac_f32_16x16x64_bf16 v[36:39], v[52:55], v[232:239], v1
    v_smfmac_f32_16x16x64_bf16 v[36:39], v[56:59], v[240:247], v1
    v_cvt_pk_bf16_f32 v32, v32, v33
    v_smfmac_f32_16x16x64_bf16 v[36:39], v[60:63], v[248:255], v1
    v_cvt_pk_bf16_f32 v33, v34, v35
    buffer_store_dwordx2 v[32:33], v5, s[8:11], s4 offen sc1
    s_nop 5
    v_cvt_pk_bf16_f32 v36, v36, v37
    v_cvt_pk_bf16_f32 v37, v38, v39
    buffer_store_dwordx2 v[36:37], v5, s[8:11], s5 offen sc1
    v_pk_mov_b32 v[64:65], 0, 0
    v_pk_mov_b32 v[66:67], 0, 0
    v_pk_mov_b32 v[68:69], 0, 0
    v_pk_mov_b32 v[70:71], 0, 0
    v_pk_mov_b32 v[72:73], 0, 0
    v_pk_mov_b32 v[74:75], 0, 0
    v_pk_mov_b32 v[76:77], 0, 0
    v_pk_mov_b32 v[78:79], 0, 0
    v_pk_mov_b32 v[80:81], 0, 0
    v_pk_mov_b32 v[82:83], 0, 0
    v_pk_mov_b32 v[84:85], 0, 0
    v_pk_mov_b32 v[86:87], 0, 0
    v_add_u32 v10, s67, v0
    v_mov_b32 v11, s54
    s_mov_b32 s89, s57
    s_mov_b32 s101, s60
    s_xor_b32 s2, s2, 0x40000
    s_xor_b32 s3, s3, 0x40000
    s_xor_b32 s4, s4, 0x40000
    s_xor_b32 s5, s5, 0x40000
    buffer_load_dwordx4 v[32:35], v6, s[8:11], s57 offen sc1
    buffer_load_dwordx4 v[36:39], v6, s[8:11], s57 offen offset:1024 sc1
    s_nop 15
    buffer_load_dwordx4 v[88:91], v6, s[8:11], s57 offen sc1
    buffer_load_dwordx4 v[92:95], v6, s[8:11], s57 offen offset:1024 sc1
    s_nop 15
R_rp_s:
    buffer_load_dwordx4 v[40:43], v6, s[8:11], s57 offen sc1
    buffer_load_dwordx4 v[44:47], v6, s[8:11], s57 offen offset:1024 sc1
    s_waitcnt vmcnt(4)
    v_mfma_f32_16x16x32_bf16 v[28:31], v[32:35], v[24:27], 0
    v_max3_u32 v13, v32, v33, v34
    v_max3_u32 v13, v13, v35, v36
    v_mfma_f32_16x16x32_bf16 v[28:31], v[36:39], v[24:27], v[28:31]
    v_max3_u32 v13, v13, v37, v38
    v_max_u32 v13, v13, v39
    v_cmp_eq_u32 vcc, s86, v13
    s_nop 4
    v_permlane32_swap_b32 v28, v30
    v_permlane32_swap_b32 v29, v31
    s_cbranch_vccz R_rpok_s
    s_nop 7
    buffer_load_dwordx4 v[32:35], v6, s[8:11], s57 offen sc1
    buffer_load_dwordx4 v[36:39], v6, s[8:11], s57 offen offset:1024 sc1
    s_waitcnt vmcnt(4)
    v_mfma_f32_16x16x32_bf16 v[28:31], v[88:91], v[24:27], 0
    v_max3_u32 v13, v88, v89, v90
    v_max3_u32 v13, v13, v91, v92
    v_mfma_f32_16x16x32_bf16 v[28:31], v[92:95], v[24:27], v[28:31]
    v_max3_u32 v13, v13, v93, v94
    v_max_u32 v13, v13, v95
    v_cmp_eq_u32 vcc, s86, v13
    s_nop 4
    v_permlane32_swap_b32 v28, v30
    v_permlane32_swap_b32 v29, v31
    s_cbranch_vccz R_rpok_s
    s_nop 7
    buffer_load_dwordx4 v[88:91], v6, s[8:11], s57 offen sc1
    buffer_load_dwordx4 v[92:95], v6, s[8:11], s57 offen offset:1024 sc1
    s_waitcnt vmcnt(4)
    v_mfma_f32_16x16x32_bf16 v[28:31], v[40:43], v[24:27], 0
    v_max3_u32 v13, v40, v41, v42
    v_max3_u32 v13, v13, v43, v44
    v_mfma_f32_16x16x32_bf16 v[28:31], v[44:47], v[24:27], v[28:31]
    v_max3_u32 v13, v13, v45, v46
    v_max_u32 v13, v13, v47
    v_cmp_eq_u32 vcc, s86, v13
    s_nop 4
    v_permlane32_swap_b32 v28, v30
    v_permlane32_swap_b32 v29, v31
    s_cbranch_vccz R_rpok_s
    s_nop 7
    s_add_u32 s55, s55, 1
    s_cmp_gt_u32 s55, 0x200000
    s_cbranch_scc1 R_fail
    s_branch R_rp_s
R_rpok_s:
    v_add_f32 v28, v28, v30
    v_add_f32 v29, v29, v31
    s_nop 1
    v_permlane16_swap_b32 v28, v29
    v_add_f32 v28, v28, v29
    s_nop 1
    v_mov_b32_dpp v29, v28 quad_perm:[1,1,3,3] row_mask:0xf bank_mask:0xf
    v_cvt_pk_bf16_f32 v13, v28, v29
    buffer_store_dword v13, v7, s[8:11], s59 offen sc1
R_post_s:
    s_cmp_ge_u32 s46, 256
    s_cbranch_scc1 R_nokv_57
    v_readfirstlane_b32 s64, v12
    s_nop 0
    s_lshr_b32 s64, s64, 16
    s_cmp_ge_u32 s64, 128
    s_cbranch_scc1 R_nokv_57
R_kvw_58:
    s_sleep 8
    buffer_load_dword v12, v17, s[12:15], s46 offen sc1
    s_waitcnt vmcnt(0)
    v_readfirstlane_b32 s64, v12
    s_add_u32 s55, s55, 1
    s_cmp_gt_u32 s55, 0x200000
    s_cbranch_scc1 R_fail
    s_lshr_b32 s64, s64, 16
    s_cmp_lt_u32 s64, 128
    s_cbranch_scc1 R_kvw_58
R_nokv_57:
    s_add_u32 s63, s54, 3
    s_lshr_b32 s46, s63, 1
    s_add_u32 s46, s46, 128
    s_and_b32 s64, s63, 0x47
    s_cmp_eq_u32 s64, 0
    s_cselect_b32 s46, s46, 0x1000
    v_add_u32 v24, s1, v0
    v_add_u32 v25, s6, v0
    s_mov_b32 s63, s1
    s_mov_b32 s1, s44
    s_mov_b32 s44, s63
    s_mov_b32 s63, s6
    s_mov_b32 s6, s45
    s_mov_b32 s45, s63
    v_add_u32 v8, s40, v0
    ds_read_b128 v[52:55], v8 offset:0
    ds_read_b128 v[56:59], v8 offset:1024
    ds_read_b128 v[96:99], v8 offset:16384
    ds_read_b128 v[100:103], v8 offset:17408
    v_mov_b32 v28, s86
    v_mov_b32 v29, s86
    v_mov_b32 v30, s86
    v_mov_b32 v31, s86
    s_add_u32 s54, s54, 1
    s_xor_b32 s57, s57, 0x40000
    s_mov_b32 s60, s59
    s_mov_b32 s59, s61
    s_mov_b32 s61, s101
    s_nop 15
    s_waitcnt vmcnt(1)
    ds_read_b128 v[88:91], v8 offset:8192
    ds_read_b128 v[92:95], v8 offset:9216
    s_branch R_loop_s
R_slow_s:
    s_waitcnt lgkmcnt(0)
    s_nop 7
    s_nop 3
    ds_read_b128 v[32:35], v0 offset:16384
    ds_read_b64 v[64:65], v0 offset:19456
    ds_read_b128 v[36:39], v0 offset:20480
    ds_read_b64 v[66:67], v0 offset:23552
    ds_read_b128 v[40:43], v0 offset:24576
    ds_read_b64 v[68:69], v0 offset:27648
    ds_read_b128 v[44:47], v0 offset:28672
    ds_read_b64 v[70:71], v0 offset:31744
    s_waitcnt lgkmcnt(0)
    v_pk_add_f32 v[32:33], v[32:33], v[36:37]
    v_pk_add_f32 v[34:35], v[34:35], v[38:39]
    v_pk_add_f32 v[40:41], v[40:41], v[44:45]
    v_pk_add_f32 v[42:43], v[42:43], v[46:47]
    v_pk_add_f32 v[32:33], v[32:33], v[40:41]
    v_pk_add_f32 v[34:35], v[34:35], v[42:43]
    v_pk_add_f32 v[64:65], v[64:65], v[66:67]
    v_pk_add_f32 v[68:69], v[68:69], v[70:71]
    v_pk_add_f32 v[64:65], v[64:65], v[68:69]
    v_max3_f32 v36, v32, v33, v34
    v_max3_f32 v36, v36, v35, v64
    v_max_f32 v36, v36, v65
    s_nop 1
    v_max_f32_dpp v36, v36, v36 quad_perm:[2,3,0,1] row_mask:0xf bank_mask:0xf
    v_mov_b32 v37, v36
    s_nop 1
    v_permlane32_swap_b32 v36, v37
    v_max_f32 v36, v36, v37
    v_mov_b32 v37, v36
    s_nop 1
    v_permlane16_swap_b32 v36, v37
    v_max_f32 v36, v36, v37
    v_sub_f32 v32, v32, v36
    v_mul_f32 v32, s78, v32
    v_exp_f32 v32, v32
    v_sub_f32 v33, v33, v36
    v_mul_f32 v33, s78, v33
    v_exp_f32 v33, v33
    v_sub_f32 v34, v34, v36
    v_mul_f32 v34, s78, v34
    v_exp_f32 v34, v34
    v_sub_f32 v35, v35, v36
    v_mul_f32 v35, s78, v35
    v_exp_f32 v35, v35
    v_sub_f32 v64, v64, v36
    v_mul_f32 v64, s78, v64
    v_exp_f32 v64, v64
    v_sub_f32 v65, v65, v36
    v_mul_f32 v65, s78, v65
    v_exp_f32 v65, v65
    v_cvt_pk_bf16_f32 v40, v32, v33
    v_cvt_pk_bf16_f32 v41, v34, v35
    v_cvt_pk_bf16_f32 v14, v64, v65
    v_mov_b32_dpp v24, v40 quad_perm:[0,1,0,1] row_mask:0xf bank_mask:0xf
    v_mov_b32_dpp v25, v41 quad_perm:[0,1,0,1] row_mask:0xf bank_mask:0xf
    v_mov_b32_dpp v26, v40 quad_perm:[2,3,2,3] row_mask:0xf bank_mask:0xf
    v_mov_b32_dpp v27, v41 quad_perm:[2,3,2,3] row_mask:0xf bank_mask:0xf
    s_nop 1
    v_mfma_f32_16x16x32_bf16 v[56:59], v[96:99], v[24:27], 0
    v_mfma_f32_16x16x32_bf16 v[60:63], v[100:103], v[24:27], 0
    v_mfma_f32_16x16x32_bf16 v[28:31], v[20:23], v[24:27], 0
    v_mfma_f32_16x16x16_bf16 v[56:59], v[50:51], v[14:15], v[56:59]
    v_mfma_f32_16x16x16_bf16 v[60:63], v[82:83], v[14:15], v[60:63]
    v_mfma_f32_16x16x16_bf16 v[28:31], v[20:21], v[14:15], v[28:31]
    s_nop 7
    v_rcp_f32 v10, v28
    s_nop 0
    v_mul_f32 v56, v56, v10
    v_mul_f32 v57, v57, v10
    v_mul_f32 v58, v58, v10
    v_mul_f32 v59, v59, v10
    v_mul_f32 v60, v60, v10
    v_mul_f32 v61, v61, v10
    v_mul_f32 v62, v62, v10
    v_mul_f32 v63, v63, v10
    ds_read_b128 v[40:43], v17 offset:17408
    ds_read_b128 v[44:47], v17 offset:17408
    ds_read_b128 v[32:35], v17 offset:17408
    ds_read_b128 v[36:39], v17 offset:17408
    s_nop 7
    s_nop 3
    v_xor_b32 v76, 8192, v3
    v_xor_b32 v77, 12288, v3
    v_cvt_pk_bf16_f32 v84, v56, v57
    v_cvt_pk_bf16_f32 v85, v58, v59
    v_cvt_pk_bf16_f32 v86, v60, v61
    v_cvt_pk_bf16_f32 v87, v62, v63
    ds_write_b128 v3, v[84:87] offset:2048
    s_waitcnt lgkmcnt(0)
    s_nop 7
    s_nop 3
    v_smfmac_f32_16x16x64_bf16 v[40:43], v[84:87], v[128:135], v1
    v_smfmac_f32_16x16x64_bf16 v[44:47], v[84:87], v[160:167], v1
    v_smfmac_f32_16x16x64_bf16 v[32:35], v[84:87], v[192:199], v1
    s_branch R_noslow_s
R_done_s:
    s_add_u32 s63, s65, 1048576
    buffer_store_dwordx4 v[48:51], v0, s[8:11], s63 offen sc1
    v_mov_b32 v10, 64
    s_waitcnt vmcnt(0)
    buffer_store_dword v10, v17, s[8:11], s88 offen sc1
    s_endpgm
R_fail:
    v_mov_b32 v13, 36
    v_mov_b32 v10, 1
    s_mov_b64 exec, 1
    buffer_atomic_add v10, v13, s[12:15], 0 offen
    s_waitcnt vmcnt(0)
    s_endpgm
L_worker:
    s_sub_u32 s52, s90, 1
    s_mov_b32 s53, s91
    s_mov_b32 s61, 0
    v_lshrrev_b32 v10, 6, v0
    s_nop 0
    v_readfirstlane_b32 s54, v10
    v_and_b32 v2, 15, v0
    v_bfe_u32 v3, v0, 4, 2
    v_and_b32 v10, 63, v0
    v_lshlrev_b32 v0, 4, v10
    v_add_u32 v4, 0x10000, v0
    v_mov_b32 v1, 0
    s_lshl_b32 s58, s52, 5
    s_add_u32 s58, s58, s53
    s_lshr_b32 s55, s58, 1
    s_and_b32 s56, s58, 1
    s_lshl_b32 s77, s58, 7
    s_add_u32 s77, s77, 786432
    buffer_store_dword v1, v1, s[8:11], s77 offen sc1
    s_cmp_ge_u32 s55, 110
    s_cbranch_scc1 W_relayout
    s_lshl_b32 s58, s52, 5
    s_add_u32 s58, s58, s53
    s_cmp_ge_u32 s58, 128
    s_cbranch_scc1 W_noln
    s_lshl_b32 s59, s58, 14
    s_lshl_b32 s60, s54, 12
    s_add_u32 s60, s59, s60
    v_lshlrev_b32 v10, 10, v3
    v_lshl_add_u32 v10, v2, 4, v10
    buffer_load_dwordx4 v[32:35], v10, s[36:39], s60 offen offset:0
    buffer_load_dwordx4 v[36:39], v10, s[36:39], s60 offen offset:256
    buffer_load_dwordx4 v[40:43], v10, s[36:39], s60 offen offset:512
    buffer_load_dwordx4 v[44:47], v10, s[36:39], s60 offen offset:768
    v_lshrrev_b32 v15, 2, v2
    v_lshlrev_b32 v15, 10, v15
    v_and_b32 v16, 3, v2
    v_lshl_add_u32 v15, v16, 8, v15
    v_lshl_add_u32 v15, v3, 4, v15
    s_lshl_b32 s60, s54, 6
    s_add_u32 s59, s59, s60
    s_add_u32 s59, s59, 10485760
    s_waitcnt vmcnt(0)
    v_lshlrev_b32 v64, 16, v32
    v_and_b32 v65, 0xffff0000, v32
    v_lshlrev_b32 v66, 16, v33
    v_and_b32 v67, 0xffff0000, v33
    v_lshlrev_b32 v68, 16, v34
    v_and_b32 v69, 0xffff0000, v34
    v_lshlrev_b32 v70, 16, v35
    v_and_b32 v71, 0xffff0000, v35
    v_lshlrev_b32 v72, 16, v36
    v_and_b32 v73, 0xffff0000, v36
    v_lshlrev_b32 v74, 16, v37
    v_and_b32 v75, 0xffff0000, v37
    v_lshlrev_b32 v76, 16, v38
    v_and_b32 v77, 0xffff0000, v38
    v_lshlrev_b32 v78, 16, v39
    v_and_b32 v79, 0xffff0000, v39
    v_lshlrev_b32 v80, 16, v40
    v_and_b32 v81, 0xffff0000, v40
    v_lshlrev_b32 v82, 16, v41
    v_and_b32 v83, 0xffff0000, v41
    v_lshlrev_b32 v84, 16, v42
    v_and_b32 v85, 0xffff0000, v42
    v_lshlrev_b32 v86, 16, v43
    v_and_b32 v87, 0xffff0000, v43
    v_lshlrev_b32 v88, 16, v44
    v_and_b32 v89, 0xffff0000, v44
    v_lshlrev_b32 v90, 16, v45
    v_and_b32 v91, 0xffff0000, v45
    v_lshlrev_b32 v92, 16, v46
    v_and_b32 v93, 0xffff0000, v46
    v_lshlrev_b32 v94, 16, v47
    v_and_b32 v95, 0xffff0000, v47
    v_add_f32 v11, v64, v65
    v_add_f32 v11, v11, v66
    v_add_f32 v11, v11, v67
    v_add_f32 v11, v11, v68
    v_add_f32 v11, v11, v69
    v_add_f32 v11, v11, v70
    v_add_f32 v11, v11, v71
    v_add_f32 v11, v11, v72
    v_add_f32 v11, v11, v73
    v_add_f32 v11, v11, v74
    v_add_f32 v11, v11, v75
    v_add_f32 v11, v11, v76
    v_add_f32 v11, v11, v77
    v_add_f32 v11, v11, v78
    v_add_f32 v11, v11, v79
    v_add_f32 v11, v11, v80
    v_add_f32 v11, v11, v81
    v_add_f32 v11, v11, v82
    v_add_f32 v11, v11, v83
    v_add_f32 v11, v11, v84
    v_add_f32 v11, v11, v85
    v_add_f32 v11, v11, v86
    v_add_f32 v11, v11, v87
    v_add_f32 v11, v11, v88
    v_add_f32 v11, v11, v89
    v_add_f32 v11, v11, v90
    v_add_f32 v11, v11, v91
    v_add_f32 v11, v11, v92
    v_add_f32 v11, v11, v93
    v_add_f32 v11, v11, v94
    v_add_f32 v11, v11, v95
    s_nop 1
    v_add_f32_dpp v11, v11, v11 row_ror:1 row_mask:0xf bank_mask:0xf
    s_nop 1
    v_add_f32_dpp v11, v11, v11 row_ror:2 row_mask:0xf bank_mask:0xf
    s_nop 1
    v_add_f32_dpp v11, v11, v11 row_ror:4 row_mask:0xf bank_mask:0xf
    s_nop 1
    v_add_f32_dpp v11, v11, v11 row_ror:8 row_mask:0xf bank_mask:0xf
    v_mul_f32 v11, 0x3b000000, v11
    v_sub_f32 v13, v64, v11
    v_mul_f32 v12, v13, v13
    v_sub_f32 v13, v65, v11
    v_fmac_f32 v12, v13, v13
    v_sub_f32 v13, v66, v11
    v_fmac_f32 v12, v13, v13
    v_sub_f32 v13, v67, v11
    v_fmac_f32 v12, v13, v13
    v_sub_f32 v13, v68, v11
    v_fmac_f32 v12, v13, v13
    v_sub_f32 v13, v69, v11
    v_fmac_f32 v12, v13, v13
    v_sub_f32 v13, v70, v11
    v_fmac_f32 v12, v13, v13
    v_sub_f32 v13, v71, v11
    v_fmac_f32 v12, v13, v13
    v_sub_f32 v13, v72, v11
    v_fmac_f32 v12, v13, v13
    v_sub_f32 v13, v73, v11
    v_fmac_f32 v12, v13, v13
    v_sub_f32 v13, v74, v11
    v_fmac_f32 v12, v13, v13
    v_sub_f32 v13, v75, v11
    v_fmac_f32 v12, v13, v13
    v_sub_f32 v13, v76, v11
    v_fmac_f32 v12, v13, v13
    v_sub_f32 v13, v77, v11
    v_fmac_f32 v12, v13, v13
    v_sub_f32 v13, v78, v11
    v_fmac_f32 v12, v13, v13
    v_sub_f32 v13, v79, v11
    v_fmac_f32 v12, v13, v13
    v_sub_f32 v13, v80, v11
    v_fmac_f32 v12, v13, v13
    v_sub_f32 v13, v81, v11
    v_fmac_f32 v12, v13, v13
    v_sub_f32 v13, v82, v11
    v_fmac_f32 v12, v13, v13
    v_sub_f32 v13, v83, v11
    v_fmac_f32 v12, v13, v13
    v_sub_f32 v13, v84, v11
    v_fmac_f32 v12, v13, v13
    v_sub_f32 v13, v85, v11
    v_fmac_f32 v12, v13, v13
    v_sub_f32 v13, v86, v11
    v_fmac_f32 v12, v13, v13
    v_sub_f32 v13, v87, v11
    v_fmac_f32 v12, v13, v13
    v_sub_f32 v13, v88, v11
    v_fmac_f32 v12, v13, v13
    v_sub_f32 v13, v89, v11
    v_fmac_f32 v12, v13, v13
    v_sub_f32 v13, v90, v11
    v_fmac_f32 v12, v13, v13
    v_sub_f32 v13, v91, v11
    v_fmac_f32 v12, v13, v13
    v_sub_f32 v13, v92, v11
    v_fmac_f32 v12, v13, v13
    v_sub_f32 v13, v93, v11
    v_fmac_f32 v12, v13, v13
    v_sub_f32 v13, v94, v11
    v_fmac_f32 v12, v13, v13
    v_sub_f32 v13, v95, v11
    v_fmac_f32 v12, v13, v13
    s_nop 1
    v_add_f32_dpp v12, v12, v12 row_ror:1 row_mask:0xf bank_mask:0xf
    s_nop 1
    v_add_f32_dpp v12, v12, v12 row_ror:2 row_mask:0xf bank_mask:0xf
    s_nop 1
    v_add_f32_dpp v12, v12, v12 row_ror:4 row_mask:0xf bank_mask:0xf
    s_nop 1
    v_add_f32_dpp v12, v12, v12 row_ror:8 row_mask:0xf bank_mask:0xf
    v_mul_f32 v12, 0x3b000000, v12
    v_cvt_pk_bf16_f32 v11, v11, v11
    v_lshlrev_b32 v11, 16, v11
    v_cvt_pk_bf16_f32 v12, v12, v12
    v_lshlrev_b32 v12, 16, v12
    v_add_f32 v12, 0x3727c5ac, v12
    v_cvt_pk_bf16_f32 v12, v12, v12
    v_lshlrev_b32 v12, 16, v12
    v_sqrt_f32 v12, v12
    s_nop 0
    v_cvt_pk_bf16_f32 v12, v12, v12
    v_lshlrev_b32 v12, 16, v12
    v_rcp_f32 v13, v12
    s_nop 0
    v_fma_f32 v14, -v12, v13, 1.0
    v_fma_f32 v13, v14, v13, v13
    v_sub_f32 v64, v64, v11
    v_sub_f32 v65, v65, v11
    v_cvt_pk_bf16_f32 v32, v64, v65
    v_lshlrev_b32 v64, 16, v32
    v_and_b32 v65, 0xffff0000, v32
    v_mul_f32 v64, v64, v13
    v_mul_f32 v65, v65, v13
    v_cvt_pk_bf16_f32 v32, v64, v65
    v_sub_f32 v66, v66, v11
    v_sub_f32 v67, v67, v11
    v_cvt_pk_bf16_f32 v33, v66, v67
    v_lshlrev_b32 v66, 16, v33
    v_and_b32 v67, 0xffff0000, v33
    v_mul_f32 v66, v66, v13
    v_mul_f32 v67, v67, v13
    v_cvt_pk_bf16_f32 v33, v66, v67
    v_sub_f32 v68, v68, v11
    v_sub_f32 v69, v69, v11
    v_cvt_pk_bf16_f32 v34, v68, v69
    v_lshlrev_b32 v68, 16, v34
    v_and_b32 v69, 0xffff0000, v34
    v_mul_f32 v68, v68, v13
    v_mul_f32 v69, v69, v13
    v_cvt_pk_bf16_f32 v34, v68, v69
    v_sub_f32 v70, v70, v11
    v_sub_f32 v71, v71, v11
    v_cvt_pk_bf16_f32 v35, v70, v71
    v_lshlrev_b32 v70, 16, v35
    v_and_b32 v71, 0xffff0000, v35
    v_mul_f32 v70, v70, v13
    v_mul_f32 v71, v71, v13
    v_cvt_pk_bf16_f32 v35, v70, v71
    v_sub_f32 v72, v72, v11
    v_sub_f32 v73, v73, v11
    v_cvt_pk_bf16_f32 v36, v72, v73
    v_lshlrev_b32 v72, 16, v36
    v_and_b32 v73, 0xffff0000, v36
    v_mul_f32 v72, v72, v13
    v_mul_f32 v73, v73, v13
    v_cvt_pk_bf16_f32 v36, v72, v73
    v_sub_f32 v74, v74, v11
    v_sub_f32 v75, v75, v11
    v_cvt_pk_bf16_f32 v37, v74, v75
    v_lshlrev_b32 v74, 16, v37
    v_and_b32 v75, 0xffff0000, v37
    v_mul_f32 v74, v74, v13
    v_mul_f32 v75, v75, v13
    v_cvt_pk_bf16_f32 v37, v74, v75
    v_sub_f32 v76, v76, v11
    v_sub_f32 v77, v77, v11
    v_cvt_pk_bf16_f32 v38, v76, v77
    v_lshlrev_b32 v76, 16, v38
    v_and_b32 v77, 0xffff0000, v38
    v_mul_f32 v76, v76, v13
    v_mul_f32 v77, v77, v13
    v_cvt_pk_bf16_f32 v38, v76, v77
    v_sub_f32 v78, v78, v11
    v_sub_f32 v79, v79, v11
    v_cvt_pk_bf16_f32 v39, v78, v79
    v_lshlrev_b32 v78, 16, v39
    v_and_b32 v79, 0xffff0000, v39
    v_mul_f32 v78, v78, v13
    v_mul_f32 v79, v79, v13
    v_cvt_pk_bf16_f32 v39, v78, v79
    v_sub_f32 v80, v80, v11
    v_sub_f32 v81, v81, v11
    v_cvt_pk_bf16_f32 v40, v80, v81
    v_lshlrev_b32 v80, 16, v40
    v_and_b32 v81, 0xffff0000, v40
    v_mul_f32 v80, v80, v13
    v_mul_f32 v81, v81, v13
    v_cvt_pk_bf16_f32 v40, v80, v81
    v_sub_f32 v82, v82, v11
    v_sub_f32 v83, v83, v11
    v_cvt_pk_bf16_f32 v41, v82, v83
    v_lshlrev_b32 v82, 16, v41
    v_and_b32 v83, 0xffff0000, v41
    v_mul_f32 v82, v82, v13
    v_mul_f32 v83, v83, v13
    v_cvt_pk_bf16_f32 v41, v82, v83
    v_sub_f32 v84, v84, v11
    v_sub_f32 v85, v85, v11
    v_cvt_pk_bf16_f32 v42, v84, v85
    v_lshlrev_b32 v84, 16, v42
    v_and_b32 v85, 0xffff0000, v42
    v_mul_f32 v84, v84, v13
    v_mul_f32 v85, v85, v13
    v_cvt_pk_bf16_f32 v42, v84, v85
    v_sub_f32 v86, v86, v11
    v_sub_f32 v87, v87, v11
    v_cvt_pk_bf16_f32 v43, v86, v87
    v_lshlrev_b32 v86, 16, v43
    v_and_b32 v87, 0xffff0000, v43
    v_mul_f32 v86, v86, v13
    v_mul_f32 v87, v87, v13
    v_cvt_pk_bf16_f32 v43, v86, v87
    v_sub_f32 v88, v88, v11
    v_sub_f32 v89, v89, v11
    v_cvt_pk_bf16_f32 v44, v88, v89
    v_lshlrev_b32 v88, 16, v44
    v_and_b32 v89, 0xffff0000, v44
    v_mul_f32 v88, v88, v13
    v_mul_f32 v89, v89, v13
    v_cvt_pk_bf16_f32 v44, v88, v89
    v_sub_f32 v90, v90, v11
    v_sub_f32 v91, v91, v11
    v_cvt_pk_bf16_f32 v45, v90, v91
    v_lshlrev_b32 v90, 16, v45
    v_and_b32 v91, 0xffff0000, v45
    v_mul_f32 v90, v90, v13
    v_mul_f32 v91, v91, v13
    v_cvt_pk_bf16_f32 v45, v90, v91
    v_sub_f32 v92, v92, v11
    v_sub_f32 v93, v93, v11
    v_cvt_pk_bf16_f32 v46, v92, v93
    v_lshlrev_b32 v92, 16, v46
    v_and_b32 v93, 0xffff0000, v46
    v_mul_f32 v92, v92, v13
    v_mul_f32 v93, v93, v13
    v_cvt_pk_bf16_f32 v46, v92, v93
    v_sub_f32 v94, v94, v11
    v_sub_f32 v95, v95, v11
    v_cvt_pk_bf16_f32 v47, v94, v95
    v_lshlrev_b32 v94, 16, v47
    v_and_b32 v95, 0xffff0000, v47
    v_mul_f32 v94, v94, v13
    v_mul_f32 v95, v95, v13
    v_cvt_pk_bf16_f32 v47, v94, v95
    buffer_store_dwordx4 v[32:35], v15, s[8:11], s59 offen sc1
    s_add_u32 s59, s59, 4096
    buffer_store_dwordx4 v[36:39], v15, s[8:11], s59 offen sc1
    s_add_u32 s59, s59, 4096
    buffer_store_dwordx4 v[40:43], v15, s[8:11], s59 offen sc1
    s_add_u32 s59, s59, 4096
    buffer_store_dwordx4 v[44:47], v15, s[8:11], s59 offen sc1
W_noln:
    s_lshl_b32 s58, s52, 5
    s_add_u32 s58, s58, s53
    s_cmp_ge_u32 s58, 128
    s_cbranch_scc1 W_sig_59
    s_lshr_b32 s58, s58, 4
    s_lshr_b32 s59, s58, 2
    s_lshl_b32 s59, s59, 2
    s_add_u32 s59, s59, 40
    s_and_b32 s58, s58, 3
    s_lshl_b32 s58, s58, 3
    s_lshl_b32 s58, 1, s58
    s_waitcnt vmcnt(0)
    s_barrier
    s_cmp_lg_u32 s54, 0
    s_cbranch_scc1 W_sig_59
    v_mov_b32 v10, s58
    s_mov_b64 exec, 1
    buffer_atomic_add v10, v1, s[12:15], s59 offen
    s_mov_b64 exec, -1
W_sig_59:
    s_cmp_lt_u32 s55, 64
    s_cbranch_scc1 W_noq
    s_mov_b32 s58, 40
    s_cmp_lg_u32 s54, 0
    s_cbranch_scc1 W_pok_61
W_poll_60:
    buffer_load_dwordx2 v[10:11], v1, s[12:15], s58 offen sc1
    s_waitcnt vmcnt(0)
    v_readfirstlane_b32 s59, v10
    v_readfirstlane_b32 s60, v11
    s_nop 0
    s_and_b32 s59, s59, s60
    s_cmp_eq_u32 s59, 0x10101010
    s_cbranch_scc1 W_pok_61
    s_add_u32 s61, s61, 1
    s_cmp_gt_u32 s61, 0x400000
    s_cbranch_scc1 W_fail
    s_sleep 16
    s_branch W_poll_60
W_pok_61:
    s_barrier
    s_sub_u32 s57, s55, 64
    s_lshl_b32 s57, s57, 1
    s_add_u32 s57, s57, s56
    s_lshl_b32 s72, s54, 13
    v_lshrrev_b32 v10, 2, v2
    v_lshl_add_u32 v10, v3, 2, v10
    v_lshlrev_b32 v10, 10, v10
    v_and_b32 v11, 3, v2
    v_lshl_add_u32 v10, v11, 3, v10
    s_lshl_b32 s58, s54, 8
    v_add_u32 v10, s58, v10
    s_lshl_b32 s73, s57, 11
    s_add_u32 s73, s73, 100663296
    s_mul_i32 s58, s54, 1507328
    s_add_u32 s73, s73, s58
    s_cmp_ge_u32 s57, 64
    s_cbranch_scc1 W_rl_62
    s_lshl_b32 s62, s57, 16
    s_mov_b32 s64, s28
    s_mov_b32 s65, s29
    s_mov_b32 s66, s30
    s_mov_b32 s67, s31
    s_branch W_rl_63
W_rl_62:
    s_sub_u32 s62, s57, 64
    s_lshl_b32 s62, s62, 16
    s_mov_b32 s64, s44
    s_mov_b32 s65, s45
    s_mov_b32 s66, s46
    s_mov_b32 s67, s47
W_rl_63:
    s_add_u32 s62, s62, s72
    s_add_u32 m0, s72, 0
    s_add_u32 s58, s62, 0
    buffer_load_dwordx4 v0, s[64:67], s58 offen offset:0 lds
    buffer_load_dwordx4 v0, s[64:67], s58 offen offset:1024 lds
    buffer_load_dwordx4 v0, s[64:67], s58 offen offset:2048 lds
    buffer_load_dwordx4 v0, s[64:67], s58 offen offset:3072 lds
    s_add_u32 m0, s72, 4096
    s_add_u32 s58, s62, 4096
    buffer_load_dwordx4 v0, s[64:67], s58 offen offset:0 lds
    buffer_load_dwordx4 v0, s[64:67], s58 offen offset:1024 lds
    buffer_load_dwordx4 v0, s[64:67], s58 offen offset:2048 lds
    buffer_load_dwordx4 v0, s[64:67], s58 offen offset:3072 lds
    s_add_u32 m0, s72, 32768
    s_add_u32 s58, s62, 32768
    buffer_load_dwordx4 v0, s[64:67], s58 offen offset:0 lds
    buffer_load_dwordx4 v0, s[64:67], s58 offen offset:1024 lds
    buffer_load_dwordx4 v0, s[64:67], s58 offen offset:2048 lds
    buffer_load_dwordx4 v0, s[64:67], s58 offen offset:3072 lds
    s_add_u32 m0, s72, 36864
    s_add_u32 s58, s62, 36864
    buffer_load_dwordx4 v0, s[64:67], s58 offen offset:0 lds
    buffer_load_dwordx4 v0, s[64:67], s58 offen offset:1024 lds
    buffer_load_dwordx4 v0, s[64:67], s58 offen offset:2048 lds
    buffer_load_dwordx4 v0, s[64:67], s58 offen offset:3072 lds
    s_waitcnt vmcnt(0)
    s_barrier
    ds_read_b64_tr_b16 v[128:129], v10 offset:0
    ds_read_b64_tr_b16 v[130:131], v10 offset:16384
    ds_read_b64_tr_b16 v[132:133], v10 offset:32
    ds_read_b64_tr_b16 v[134:135], v10 offset:16416
    ds_read_b64_tr_b16 v[136:137], v10 offset:64
    ds_read_b64_tr_b16 v[138:139], v10 offset:16448
    ds_read_b64_tr_b16 v[140:141], v10 offset:96
    ds_read_b64_tr_b16 v[142:143], v10 offset:16480
    ds_read_b64_tr_b16 v[144:145], v10 offset:128
    ds_read_b64_tr_b16 v[146:147], v10 offset:16512
    ds_read_b64_tr_b16 v[148:149], v10 offset:160
    ds_read_b64_tr_b16 v[150:151], v10 offset:16544
    ds_read_b64_tr_b16 v[152:153], v10 offset:192
    ds_read_b64_tr_b16 v[154:155], v10 offset:16576
    ds_read_b64_tr_b16 v[156:157], v10 offset:224
    ds_read_b64_tr_b16 v[158:159], v10 offset:16608
    ds_read_b64_tr_b16 v[160:161], v10 offset:32768
    ds_read_b64_tr_b16 v[162:163], v10 offset:49152
    ds_read_b64_tr_b16 v[164:165], v10 offset:32800
    ds_read_b64_tr_b16 v[166:167], v10 offset:49184
    ds_read_b64_tr_b16 v[168:169], v10 offset:32832
    ds_read_b64_tr_b16 v[170:171], v10 offset:49216
    ds_read_b64_tr_b16 v[172:173], v10 offset:32864
    ds_read_b64_tr_b16 v[174:175], v10 offset:49248
    ds_read_b64_tr_b16 v[176:177], v10 offset:32896
    ds_read_b64_tr_b16 v[178:179], v10 offset:49280
    ds_read_b64_tr_b16 v[180:181], v10 offset:32928
    ds_read_b64_tr_b16 v[182:183], v10 offset:49312
    ds_read_b64_tr_b16 v[184:185], v10 offset:32960
    ds_read_b64_tr_b16 v[186:187], v10 offset:49344
    ds_read_b64_tr_b16 v[188:189], v10 offset:32992
    ds_read_b64_tr_b16 v[190:191], v10 offset:49376
    s_waitcnt lgkmcnt(0)
    s_barrier
    buffer_store_dwordx4 v[128:131], v0, s[8:11], s73 offen offset:0 sc1
    buffer_store_dwordx4 v[160:163], v0, s[8:11], s73 offen offset:1024 sc1
    s_add_u32 s73, s73, 188416
    buffer_store_dwordx4 v[132:135], v0, s[8:11], s73 offen offset:0 sc1
    buffer_store_dwordx4 v[164:167], v0, s[8:11], s73 offen offset:1024 sc1
    s_add_u32 s73, s73, 188416
    buffer_store_dwordx4 v[136:139], v0, s[8:11], s73 offen offset:0 sc1
    buffer_store_dwordx4 v[168:171], v0, s[8:11], s73 offen offset:1024 sc1
    s_add_u32 s73, s73, 188416
    buffer_store_dwordx4 v[140:143], v0, s[8:11], s73 offen offset:0 sc1
    buffer_store_dwordx4 v[172:175], v0, s[8:11], s73 offen offset:1024 sc1
    s_add_u32 s73, s73, 188416
    buffer_store_dwordx4 v[144:147], v0, s[8:11], s73 offen offset:0 sc1
    buffer_store_dwordx4 v[176:179], v0, s[8:11], s73 offen offset:1024 sc1
    s_add_u32 s73, s73, 188416
    buffer_store_dwordx4 v[148:151], v0, s[8:11], s73 offen offset:0 sc1
    buffer_store_dwordx4 v[180:183], v0, s[8:11], s73 offen offset:1024 sc1
    s_add_u32 s73, s73, 188416
    buffer_store_dwordx4 v[152:155], v0, s[8:11], s73 offen offset:0 sc1
    buffer_store_dwordx4 v[184:187], v0, s[8:11], s73 offen offset:1024 sc1
    s_add_u32 s73, s73, 188416
    buffer_store_dwordx4 v[156:159], v0, s[8:11], s73 offen offset:0 sc1
    buffer_store_dwordx4 v[188:191], v0, s[8:11], s73 offen offset:1024 sc1
    s_add_u32 s73, s73, 188416
W_noq:
    s_lshr_b32 s58, s54, 1
    s_lshl_b32 s58, s58, 2
    v_or_b32 v10, s58, v3
    v_lshlrev_b32 v10, 1, v10
    v_xor_b32 v10, v10, v2
    v_lshlrev_b32 v10, 4, v10
    s_lshl_b32 s58, s54, 2
    v_add_u32 v11, s58, v3
    s_lshl_b32 s72, s54, 10
    s_lshl_b32 s60, s54, 11
    s_cmp_ge_u32 s55, 96
    s_cbranch_scc1 W_nb_66
    s_and_b32 s68, s55, 31
    s_lshl_b32 s73, s68, 13
    s_add_u32 s73, s73, s60
    s_lshl_b32 s60, s56, 18
    s_add_u32 s73, s73, s60
    s_mov_b32 s74, 0x80000
    s_lshl_b32 s68, s68, 8
    s_mov_b32 s69, 131072
    v_lshl_add_u32 v18, v11, 13, v10
    s_cmp_ge_u32 s55, 64
    s_cbranch_scc1 W_nb_65
    s_cmp_ge_u32 s55, 32
    s_cbranch_scc1 W_nb_64
    s_add_u32 s73, s73, 16777216
    s_mov_b32 s75, 0
    s_mov_b32 s64, s20
    s_mov_b32 s65, s21
    s_mov_b32 s66, s22
    s_mov_b32 s67, s23
    s_branch W_nb_67
W_nb_64:
    s_add_u32 s73, s73, 33554432
    s_mov_b32 s75, 1
    s_mov_b32 s64, s24
    s_mov_b32 s65, s25
    s_mov_b32 s66, s26
    s_mov_b32 s67, s27
    s_branch W_nb_67
W_nb_65:
    s_add_u32 s73, s73, 50331648
    s_mov_b32 s75, 0
    s_mov_b32 s64, s16
    s_mov_b32 s65, s17
    s_mov_b32 s66, s18
    s_mov_b32 s67, s19
    s_branch W_nb_67
W_nb_66:
    s_sub_u32 s73, s55, 64
    s_lshl_b32 s73, s73, 13
    s_add_u32 s73, s73, s60
    s_mul_i32 s60, s56, 376832
    s_add_u32 s73, s73, s60
    s_add_u32 s73, s73, 67108864
    s_mov_b32 s74, 753664
    s_sub_u32 s68, s55, 96
    s_lshl_b32 s68, s68, 8
    s_mov_b32 s69, 57344
    v_mul_u32_u24 v18, 3584, v11
    v_add_u32 v18, v18, v10
    s_mov_b32 s75, 2
    s_mov_b32 s64, s40
    s_mov_b32 s65, s41
    s_mov_b32 s66, s42
    s_mov_b32 s67, s43
W_nb_67:
    s_add_u32 m0, s72, 0
    s_nop 0
    buffer_load_dwordx4 v18, s[64:67], s68 offen lds
    s_add_u32 s68, s68, s69
    s_add_u32 m0, s72, 4096
    s_nop 0
    buffer_load_dwordx4 v18, s[64:67], s68 offen lds
    s_add_u32 s68, s68, s69
    s_add_u32 m0, s72, 8192
    s_nop 0
    buffer_load_dwordx4 v18, s[64:67], s68 offen lds
    s_add_u32 s68, s68, s69
    s_add_u32 m0, s72, 12288
    s_nop 0
    buffer_load_dwordx4 v18, s[64:67], s68 offen lds
    s_add_u32 s68, s68, s69
    s_add_u32 m0, s72, 16384
    s_nop 0
    buffer_load_dwordx4 v18, s[64:67], s68 offen lds
    s_add_u32 s68, s68, s69
    s_add_u32 m0, s72, 20480
    s_nop 0
    buffer_load_dwordx4 v18, s[64:67], s68 offen lds
    s_add_u32 s68, s68, s69
    s_add_u32 m0, s72, 24576
    s_nop 0
    buffer_load_dwordx4 v18, s[64:67], s68 offen lds
    s_add_u32 s68, s68, s69
    s_add_u32 m0, s72, 28672
    s_nop 0
    buffer_load_dwordx4 v18, s[64:67], s68 offen lds
    s_add_u32 s68, s68, s69
    s_add_u32 m0, s72, 32768
    s_nop 0
    buffer_load_dwordx4 v18, s[64:67], s68 offen lds
    s_add_u32 s68, s68, s69
    s_add_u32 m0, s72, 36864
    s_nop 0
    buffer_load_dwordx4 v18, s[64:67], s68 offen lds
    s_add_u32 s68, s68, s69
    s_add_u32 m0, s72, 40960
    s_nop 0
    buffer_load_dwordx4 v18, s[64:67], s68 offen lds
    s_add_u32 s68, s68, s69
    s_add_u32 m0, s72, 45056
    s_nop 0
    buffer_load_dwordx4 v18, s[64:67], s68 offen lds
    s_add_u32 s68, s68, s69
    s_add_u32 m0, s72, 49152
    s_nop 0
    buffer_load_dwordx4 v18, s[64:67], s68 offen lds
    s_add_u32 s68, s68, s69
    s_add_u32 m0, s72, 53248
    s_nop 0
    buffer_load_dwordx4 v18, s[64:67], s68 offen lds
    s_add_u32 s68, s68, s69
    s_add_u32 m0, s72, 57344
    s_nop 0
    buffer_load_dwordx4 v18, s[64:67], s68 offen lds
    s_add_u32 s68, s68, s69
    s_add_u32 m0, s72, 61440
    s_nop 0
    buffer_load_dwordx4 v18, s[64:67], s68 offen lds
    s_add_u32 s68, s68, s69
    s_add_u32 m0, s72, 65536
    s_nop 0
    buffer_load_dwordx4 v18, s[64:67], s68 offen lds
    s_add_u32 s68, s68, s69
    s_add_u32 m0, s72, 69632
    s_nop 0
    buffer_load_dwordx4 v18, s[64:67], s68 offen lds
    s_add_u32 s68, s68, s69
    s_add_u32 m0, s72, 73728
    s_nop 0
    buffer_load_dwordx4 v18, s[64:67], s68 offen lds
    s_add_u32 s68, s68, s69
    s_add_u32 m0, s72, 77824
    s_nop 0
    buffer_load_dwordx4 v18, s[64:67], s68 offen lds
    s_add_u32 s68, s68, s69
    s_add_u32 m0, s72, 81920
    s_nop 0
    buffer_load_dwordx4 v18, s[64:67], s68 offen lds
    s_add_u32 s68, s68, s69
    s_add_u32 m0, s72, 86016
    s_nop 0
    buffer_load_dwordx4 v18, s[64:67], s68 offen lds
    s_add_u32 s68, s68, s69
    s_add_u32 m0, s72, 90112
    s_nop 0
    buffer_load_dwordx4 v18, s[64:67], s68 offen lds
    s_add_u32 s68, s68, s69
    s_add_u32 m0, s72, 94208
    s_nop 0
    buffer_load_dwordx4 v18, s[64:67], s68 offen lds
    s_add_u32 s68, s68, s69
    s_add_u32 m0, s72, 98304
    s_nop 0
    buffer_load_dwordx4 v18, s[64:67], s68 offen lds
    s_add_u32 s68, s68, s69
    s_add_u32 m0, s72, 102400
    s_nop 0
    buffer_load_dwordx4 v18, s[64:67], s68 offen lds
    s_add_u32 s68, s68, s69
    s_add_u32 m0, s72, 106496
    s_nop 0
    buffer_load_dwordx4 v18, s[64:67], s68 offen lds
    s_add_u32 s68, s68, s69
    s_add_u32 m0, s72, 110592
    s_nop 0
    buffer_load_dwordx4 v18, s[64:67], s68 offen lds
    s_add_u32 s68, s68, s69
    s_add_u32 m0, s72, 114688
    s_nop 0
    buffer_load_dwordx4 v18, s[64:67], s68 offen lds
    s_add_u32 s68, s68, s69
    s_add_u32 m0, s72, 118784
    s_nop 0
    buffer_load_dwordx4 v18, s[64:67], s68 offen lds
    s_add_u32 s68, s68, s69
    s_add_u32 m0, s72, 122880
    s_nop 0
    buffer_load_dwordx4 v18, s[64:67], s68 offen lds
    s_add_u32 s68, s68, s69
    s_add_u32 m0, s72, 126976
    s_nop 0
    buffer_load_dwordx4 v18, s[64:67], s68 offen lds
    s_add_u32 s68, s68, s69
    v_lshrrev_b32 v10, 2, v2
    v_and_b32 v11, 1, v3
    v_lshl_add_u32 v12, v11, 2, v10
    v_lshl_add_u32 v10, v3, 3, v10
    v_lshlrev_b32 v10, 8, v10
    v_and_b32 v11, 3, v2
    v_lshl_add_u32 v10, v11, 3, v10
    s_lshl_b32 s58, s54, 1
    v_xor_b32 v11, s58, v12
    v_lshl_add_u32 v14, v11, 5, v10
    v_add_u32 v15, 0x10000, v14
    v_xor_b32 v16, 32, v14
    v_add_u32 v17, 0x10000, v16
    s_waitcnt vmcnt(0)
    s_barrier
    ds_read_b64_tr_b16 v[128:129], v14 offset:0
    ds_read_b64_tr_b16 v[130:131], v14 offset:1024
    ds_read_b64_tr_b16 v[132:133], v14 offset:8192
    ds_read_b64_tr_b16 v[134:135], v14 offset:9216
    ds_read_b64_tr_b16 v[136:137], v14 offset:16384
    ds_read_b64_tr_b16 v[138:139], v14 offset:17408
    ds_read_b64_tr_b16 v[140:141], v14 offset:24576
    ds_read_b64_tr_b16 v[142:143], v14 offset:25600
    ds_read_b64_tr_b16 v[144:145], v14 offset:32768
    ds_read_b64_tr_b16 v[146:147], v14 offset:33792
    ds_read_b64_tr_b16 v[148:149], v14 offset:40960
    ds_read_b64_tr_b16 v[150:151], v14 offset:41984
    ds_read_b64_tr_b16 v[152:153], v14 offset:49152
    ds_read_b64_tr_b16 v[154:155], v14 offset:50176
    ds_read_b64_tr_b16 v[156:157], v14 offset:57344
    ds_read_b64_tr_b16 v[158:159], v14 offset:58368
    ds_read_b64_tr_b16 v[160:161], v15 offset:0
    ds_read_b64_tr_b16 v[162:163], v15 offset:1024
    ds_read_b64_tr_b16 v[164:165], v15 offset:8192
    ds_read_b64_tr_b16 v[166:167], v15 offset:9216
    ds_read_b64_tr_b16 v[168:169], v15 offset:16384
    ds_read_b64_tr_b16 v[170:171], v15 offset:17408
    ds_read_b64_tr_b16 v[172:173], v15 offset:24576
    ds_read_b64_tr_b16 v[174:175], v15 offset:25600
    ds_read_b64_tr_b16 v[176:177], v15 offset:32768
    ds_read_b64_tr_b16 v[178:179], v15 offset:33792
    ds_read_b64_tr_b16 v[180:181], v15 offset:40960
    ds_read_b64_tr_b16 v[182:183], v15 offset:41984
    ds_read_b64_tr_b16 v[184:185], v15 offset:49152
    ds_read_b64_tr_b16 v[186:187], v15 offset:50176
    ds_read_b64_tr_b16 v[188:189], v15 offset:57344
    ds_read_b64_tr_b16 v[190:191], v15 offset:58368
    ds_read_b64_tr_b16 v[192:193], v16 offset:0
    ds_read_b64_tr_b16 v[194:195], v16 offset:1024
    ds_read_b64_tr_b16 v[196:197], v16 offset:8192
    ds_read_b64_tr_b16 v[198:199], v16 offset:9216
    ds_read_b64_tr_b16 v[200:201], v16 offset:16384
    ds_read_b64_tr_b16 v[202:203], v16 offset:17408
    ds_read_b64_tr_b16 v[204:205], v16 offset:24576
    ds_read_b64_tr_b16 v[206:207], v16 offset:25600
    ds_read_b64_tr_b16 v[208:209], v16 offset:32768
    ds_read_b64_tr_b16 v[210:211], v16 offset:33792
    ds_read_b64_tr_b16 v[212:213], v16 offset:40960
    ds_read_b64_tr_b16 v[214:215], v16 offset:41984
    ds_read_b64_tr_b16 v[216:217], v16 offset:49152
    ds_read_b64_tr_b16 v[218:219], v16 offset:50176
    ds_read_b64_tr_b16 v[220:221], v16 offset:57344
    ds_read_b64_tr_b16 v[222:223], v16 offset:58368
    ds_read_b64_tr_b16 v[224:225], v17 offset:0
    ds_read_b64_tr_b16 v[226:227], v17 offset:1024
    ds_read_b64_tr_b16 v[228:229], v17 offset:8192
    ds_read_b64_tr_b16 v[230:231], v17 offset:9216
    ds_read_b64_tr_b16 v[232:233], v17 offset:16384
    ds_read_b64_tr_b16 v[234:235], v17 offset:17408
    ds_read_b64_tr_b16 v[236:237], v17 offset:24576
    ds_read_b64_tr_b16 v[238:239], v17 offset:25600
    ds_read_b64_tr_b16 v[240:241], v17 offset:32768
    ds_read_b64_tr_b16 v[242:243], v17 offset:33792
    ds_read_b64_tr_b16 v[244:245], v17 offset:40960
    ds_read_b64_tr_b16 v[246:247], v17 offset:41984
    ds_read_b64_tr_b16 v[248:249], v17 offset:49152
    ds_read_b64_tr_b16 v[250:251], v17 offset:50176
    ds_read_b64_tr_b16 v[252:253], v17 offset:57344
    ds_read_b64_tr_b16 v[254:255], v17 offset:58368
    s_waitcnt lgkmcnt(0)
    s_barrier
    s_mov_b32 s57, 0
    s_lshl_b32 s72, s54, 13
    s_lshl_b32 s62, s56, 15
    s_add_u32 s62, s62, s72
    s_add_u32 s62, s62, 10485760
    s_mov_b32 s76, s73
    s_mov_b32 s73, 0x7FFF0000
    s_mov_b32 s58, 40
    s_cmp_lg_u32 s54, 0
    s_cbranch_scc1 W_pok_69
W_poll_68:
    buffer_load_dwordx2 v[10:11], v1, s[12:15], s58 offen sc1
    s_waitcnt vmcnt(0)
    v_readfirstlane_b32 s59, v10
    v_readfirstlane_b32 s60, v11
    s_nop 0
    s_and_b32 s59, s59, s60
    s_cmp_eq_u32 s59, 0x10101010
    s_cbranch_scc1 W_pok_69
    s_add_u32 s61, s61, 1
    s_cmp_gt_u32 s61, 0x400000
    s_cbranch_scc1 W_fail
    s_sleep 16
    s_branch W_poll_68
W_pok_69:
    s_barrier
    s_add_u32 m0, s72, 0
    s_nop 0
    buffer_load_dwordx4 v0, s[8:11], s62 offen offset:0 sc1 lds
    buffer_load_dwordx4 v0, s[8:11], s62 offen offset:1024 sc1 lds
    buffer_load_dwordx4 v0, s[8:11], s62 offen offset:2048 sc1 lds
    buffer_load_dwordx4 v0, s[8:11], s62 offen offset:3072 sc1 lds
    s_add_u32 s62, s62, 4096
    s_add_u32 m0, s72, 4096
    s_nop 0
    buffer_load_dwordx4 v0, s[8:11], s62 offen offset:0 sc1 lds
    buffer_load_dwordx4 v0, s[8:11], s62 offen offset:1024 sc1 lds
    buffer_load_dwordx4 v0, s[8:11], s62 offen offset:2048 sc1 lds
    buffer_load_dwordx4 v0, s[8:11], s62 offen offset:3072 sc1 lds
    s_add_u32 s62, s62, 61440
    s_add_u32 m0, s72, 32768
    s_nop 0
    buffer_load_dwordx4 v0, s[8:11], s62 offen offset:0 sc1 lds
    buffer_load_dwordx4 v0, s[8:11], s62 offen offset:1024 sc1 lds
    buffer_load_dwordx4 v0, s[8:11], s62 offen offset:2048 sc1 lds
    buffer_load_dwordx4 v0, s[8:11], s62 offen offset:3072 sc1 lds
    s_add_u32 s62, s62, 4096
    s_add_u32 m0, s72, 36864
    s_nop 0
    buffer_load_dwordx4 v0, s[8:11], s62 offen offset:0 sc1 lds
    buffer_load_dwordx4 v0, s[8:11], s62 offen offset:1024 sc1 lds
    buffer_load_dwordx4 v0, s[8:11], s62 offen offset:2048 sc1 lds
    buffer_load_dwordx4 v0, s[8:11], s62 offen offset:3072 sc1 lds
    s_add_u32 s62, s62, 61440
    s_add_u32 m0, s72, 65536
    s_nop 0
    buffer_load_dwordx4 v0, s[8:11], s62 offen offset:0 sc1 lds
    buffer_load_dwordx4 v0, s[8:11], s62 offen offset:1024 sc1 lds
    buffer_load_dwordx4 v0, s[8:11], s62 offen offset:2048 sc1 lds
    buffer_load_dwordx4 v0, s[8:11], s62 offen offset:3072 sc1 lds
    s_add_u32 s62, s62, 4096
    s_add_u32 m0, s72, 69632
    s_nop 0
    buffer_load_dwordx4 v0, s[8:11], s62 offen offset:0 sc1 lds
    buffer_load_dwordx4 v0, s[8:11], s62 offen offset:1024 sc1 lds
    buffer_load_dwordx4 v0, s[8:11], s62 offen offset:2048 sc1 lds
    buffer_load_dwordx4 v0, s[8:11], s62 offen offset:3072 sc1 lds
    s_add_u32 s62, s62, 61440
    v_mov_b32 v64, 0
    v_mov_b32 v65, 0
    v_mov_b32 v66, 0
    v_mov_b32 v67, 0
    v_mov_b32 v68, 0
    v_mov_b32 v69, 0
    v_mov_b32 v70, 0
    v_mov_b32 v71, 0
    v_mov_b32 v72, 0
    v_mov_b32 v73, 0
    v_mov_b32 v74, 0
    v_mov_b32 v75, 0
    v_mov_b32 v76, 0
    v_mov_b32 v77, 0
    v_mov_b32 v78, 0
    v_mov_b32 v79, 0
    v_mov_b32 v80, 0
    v_mov_b32 v81, 0
    v_mov_b32 v82, 0
    v_mov_b32 v83, 0
    v_mov_b32 v84, 0
    v_mov_b32 v85, 0
    v_mov_b32 v86, 0
    v_mov_b32 v87, 0
    v_mov_b32 v88, 0
    v_mov_b32 v89, 0
    v_mov_b32 v90, 0
    v_mov_b32 v91, 0
    v_mov_b32 v92, 0
    v_mov_b32 v93, 0
    v_mov_b32 v94, 0
    v_mov_b32 v95, 0
    s_waitcnt vmcnt(16)
    s_cmp_eq_u32 s75, 1
    s_cbranch_scc1 W_str_v
    s_cmp_eq_u32 s75, 2
    s_cbranch_scc1 W_str_h
W_str_k:
    s_waitcnt vmcnt(18)
    s_barrier
    ds_read_b128 v[32:35], v0 offset:0
    ds_read_b128 v[36:39], v0 offset:16384
    ds_read_b128 v[40:43], v0 offset:1024
    ds_read_b128 v[44:47], v0 offset:17408
    ds_read_b128 v[48:51], v0 offset:2048
    ds_read_b128 v[52:55], v0 offset:18432
    s_waitcnt lgkmcnt(5)
    v_mfma_f32_16x16x32_bf16 v[64:67], v[128:131], v[32:35], 0
    v_mfma_f32_16x16x32_bf16 v[68:71], v[192:195], v[32:35], 0
    ds_read_b128 v[56:59], v0 offset:3072
    s_waitcnt lgkmcnt(5)
    v_mfma_f32_16x16x32_bf16 v[72:75], v[128:131], v[36:39], 0
    s_add_u32 m0, s72, 98304
    v_cvt_pk_bf16_f32 v96, v80, v81
    v_mfma_f32_16x16x32_bf16 v[76:79], v[192:195], v[36:39], 0
    ds_read_b128 v[60:63], v0 offset:19456
    v_cvt_pk_bf16_f32 v97, v82, v83
    s_waitcnt lgkmcnt(5)
    v_mfma_f32_16x16x32_bf16 v[64:67], v[132:135], v[40:43], v[64:67]
    buffer_load_dwordx4 v0, s[8:11], s62 offen offset:0 sc1 lds
    v_cvt_pk_bf16_f32 v98, v84, v85
    v_mfma_f32_16x16x32_bf16 v[68:71], v[196:199], v[40:43], v[68:71]
    ds_read_b128 v[32:35], v0 offset:4096
    v_cvt_pk_bf16_f32 v99, v86, v87
    s_waitcnt lgkmcnt(5)
    v_mfma_f32_16x16x32_bf16 v[72:75], v[132:135], v[44:47], v[72:75]
    buffer_load_dwordx4 v0, s[8:11], s62 offen offset:1024 sc1 lds
    buffer_store_dwordx4 v[96:99], v0, s[8:11], s73 offen offset:0 sc1
    v_mfma_f32_16x16x32_bf16 v[76:79], v[196:199], v[44:47], v[76:79]
    ds_read_b128 v[36:39], v0 offset:20480
    v_cvt_pk_bf16_f32 v100, v88, v89
    s_waitcnt lgkmcnt(5)
    v_mfma_f32_16x16x32_bf16 v[64:67], v[136:139], v[48:51], v[64:67]
    buffer_load_dwordx4 v0, s[8:11], s62 offen offset:2048 sc1 lds
    v_cvt_pk_bf16_f32 v101, v90, v91
    v_mfma_f32_16x16x32_bf16 v[68:71], v[200:203], v[48:51], v[68:71]
    ds_read_b128 v[40:43], v0 offset:5120
    v_cvt_pk_bf16_f32 v102, v92, v93
    s_waitcnt lgkmcnt(5)
    v_mfma_f32_16x16x32_bf16 v[72:75], v[136:139], v[52:55], v[72:75]
    buffer_load_dwordx4 v0, s[8:11], s62 offen offset:3072 sc1 lds
    v_cvt_pk_bf16_f32 v103, v94, v95
    v_mfma_f32_16x16x32_bf16 v[76:79], v[200:203], v[52:55], v[76:79]
    ds_read_b128 v[44:47], v0 offset:21504
    buffer_store_dwordx4 v[100:103], v0, s[8:11], s73 offen offset:1024 sc1
    s_waitcnt lgkmcnt(5)
    v_mfma_f32_16x16x32_bf16 v[64:67], v[140:143], v[56:59], v[64:67]
    s_add_u32 s62, s62, 4096
    s_mov_b32 s73, s76
    v_mfma_f32_16x16x32_bf16 v[68:71], v[204:207], v[56:59], v[68:71]
    ds_read_b128 v[48:51], v0 offset:6144
    s_add_u32 s76, s76, s74
    s_waitcnt lgkmcnt(5)
    v_mfma_f32_16x16x32_bf16 v[72:75], v[140:143], v[60:63], v[72:75]
    s_add_u32 m0, s72, 102400
    v_mfma_f32_16x16x32_bf16 v[76:79], v[204:207], v[60:63], v[76:79]
    ds_read_b128 v[52:55], v0 offset:22528
    s_waitcnt lgkmcnt(5)
    v_mfma_f32_16x16x32_bf16 v[64:67], v[144:147], v[32:35], v[64:67]
    buffer_load_dwordx4 v0, s[8:11], s62 offen offset:0 sc1 lds
    v_mfma_f32_16x16x32_bf16 v[68:71], v[208:211], v[32:35], v[68:71]
    ds_read_b128 v[56:59], v0 offset:7168
    s_waitcnt lgkmcnt(5)
    v_mfma_f32_16x16x32_bf16 v[72:75], v[144:147], v[36:39], v[72:75]
    buffer_load_dwordx4 v0, s[8:11], s62 offen offset:1024 sc1 lds
    v_mfma_f32_16x16x32_bf16 v[76:79], v[208:211], v[36:39], v[76:79]
    ds_read_b128 v[60:63], v0 offset:23552
    s_waitcnt lgkmcnt(5)
    v_mfma_f32_16x16x32_bf16 v[64:67], v[148:151], v[40:43], v[64:67]
    buffer_load_dwordx4 v0, s[8:11], s62 offen offset:2048 sc1 lds
    v_mfma_f32_16x16x32_bf16 v[68:71], v[212:215], v[40:43], v[68:71]
    ds_read_b128 v[32:35], v0 offset:8192
    s_waitcnt lgkmcnt(5)
    v_mfma_f32_16x16x32_bf16 v[72:75], v[148:151], v[44:47], v[72:75]
    buffer_load_dwordx4 v0, s[8:11], s62 offen offset:3072 sc1 lds
    v_mfma_f32_16x16x32_bf16 v[76:79], v[212:215], v[44:47], v[76:79]
    ds_read_b128 v[36:39], v0 offset:24576
    s_waitcnt lgkmcnt(5)
    v_mfma_f32_16x16x32_bf16 v[64:67], v[152:155], v[48:51], v[64:67]
    s_add_u32 s62, s62, 61440
    v_mfma_f32_16x16x32_bf16 v[68:71], v[216:219], v[48:51], v[68:71]
    ds_read_b128 v[40:43], v0 offset:9216
    s_waitcnt lgkmcnt(5)
    v_mfma_f32_16x16x32_bf16 v[72:75], v[152:155], v[52:55], v[72:75]
    v_mfma_f32_16x16x32_bf16 v[76:79], v[216:219], v[52:55], v[76:79]
    ds_read_b128 v[44:47], v0 offset:25600
    s_waitcnt lgkmcnt(5)
    v_mfma_f32_16x16x32_bf16 v[64:67], v[156:159], v[56:59], v[64:67]
    v_mfma_f32_16x16x32_bf16 v[68:71], v[220:223], v[56:59], v[68:71]
    ds_read_b128 v[48:51], v0 offset:10240
    s_waitcnt lgkmcnt(5)
    v_mfma_f32_16x16x32_bf16 v[72:75], v[156:159], v[60:63], v[72:75]
    v_mfma_f32_16x16x32_bf16 v[76:79], v[220:223], v[60:63], v[76:79]
    ds_read_b128 v[52:55], v0 offset:26624
    s_waitcnt lgkmcnt(5)
    v_mfma_f32_16x16x32_bf16 v[64:67], v[160:163], v[32:35], v[64:67]
    v_mfma_f32_16x16x32_bf16 v[68:71], v[224:227], v[32:35], v[68:71]
    ds_read_b128 v[56:59], v0 offset:11264
    s_waitcnt lgkmcnt(5)
    v_mfma_f32_16x16x32_bf16 v[72:75], v[160:163], v[36:39], v[72:75]
    v_mfma_f32_16x16x32_bf16 v[76:79], v[224:227], v[36:39], v[76:79]
    ds_read_b128 v[60:63], v0 offset:27648
    s_waitcnt lgkmcnt(5)
    v_mfma_f32_16x16x32_bf16 v[64:67], v[164:167], v[40:43], v[64:67]
    v_mfma_f32_16x16x32_bf16 v[68:71], v[228:231], v[40:43], v[68:71]
    ds_read_b128 v[32:35], v0 offset:12288
    s_waitcnt lgkmcnt(5)
    v_mfma_f32_16x16x32_bf16 v[72:75], v[164:167], v[44:47], v[72:75]
    v_mfma_f32_16x16x32_bf16 v[76:79], v[228:231], v[44:47], v[76:79]
    ds_read_b128 v[36:39], v0 offset:28672
    s_waitcnt lgkmcnt(5)
    v_mfma_f32_16x16x32_bf16 v[64:67], v[168:171], v[48:51], v[64:67]
    v_mfma_f32_16x16x32_bf16 v[68:71], v[232:235], v[48:51], v[68:71]
    ds_read_b128 v[40:43], v0 offset:13312
    s_waitcnt lgkmcnt(5)
    v_mfma_f32_16x16x32_bf16 v[72:75], v[168:171], v[52:55], v[72:75]
    v_mfma_f32_16x16x32_bf16 v[76:79], v[232:235], v[52:55], v[76:79]
    ds_read_b128 v[44:47], v0 offset:29696
    s_waitcnt lgkmcnt(5)
    v_mfma_f32_16x16x32_bf16 v[64:67], v[172:175], v[56:59], v[64:67]
    v_mfma_f32_16x16x32_bf16 v[68:71], v[236:239], v[56:59], v[68:71]
    ds_read_b128 v[48:51], v0 offset:14336
    s_waitcnt lgkmcnt(5)
    v_mfma_f32_16x16x32_bf16 v[72:75], v[172:175], v[60:63], v[72:75]
    v_mfma_f32_16x16x32_bf16 v[76:79], v[236:239], v[60:63], v[76:79]
    ds_read_b128 v[52:55], v0 offset:30720
    s_waitcnt lgkmcnt(5)
    v_mfma_f32_16x16x32_bf16 v[64:67], v[176:179], v[32:35], v[64:67]
    v_mfma_f32_16x16x32_bf16 v[68:71], v[240:243], v[32:35], v[68:71]
    ds_read_b128 v[56:59], v0 offset:15360
    s_waitcnt lgkmcnt(5)
    v_mfma_f32_16x16x32_bf16 v[72:75], v[176:179], v[36:39], v[72:75]
    v_mfma_f32_16x16x32_bf16 v[76:79], v[240:243], v[36:39], v[76:79]
    ds_read_b128 v[60:63], v0 offset:31744
    s_waitcnt lgkmcnt(5)
    v_mfma_f32_16x16x32_bf16 v[64:67], v[180:183], v[40:43], v[64:67]
    v_mfma_f32_16x16x32_bf16 v[68:71], v[244:247], v[40:43], v[68:71]
    s_waitcnt lgkmcnt(4)
    v_mfma_f32_16x16x32_bf16 v[72:75], v[180:183], v[44:47], v[72:75]
    v_mfma_f32_16x16x32_bf16 v[76:79], v[244:247], v[44:47], v[76:79]
    s_waitcnt lgkmcnt(3)
    v_mfma_f32_16x16x32_bf16 v[64:67], v[184:187], v[48:51], v[64:67]
    v_mfma_f32_16x16x32_bf16 v[68:71], v[248:251], v[48:51], v[68:71]
    s_waitcnt lgkmcnt(2)
    v_mfma_f32_16x16x32_bf16 v[72:75], v[184:187], v[52:55], v[72:75]
    v_mfma_f32_16x16x32_bf16 v[76:79], v[248:251], v[52:55], v[76:79]
    s_waitcnt lgkmcnt(1)
    v_mfma_f32_16x16x32_bf16 v[64:67], v[188:191], v[56:59], v[64:67]
    v_mfma_f32_16x16x32_bf16 v[68:71], v[252:255], v[56:59], v[68:71]
    s_waitcnt lgkmcnt(0)
    v_mfma_f32_16x16x32_bf16 v[72:75], v[188:191], v[60:63], v[72:75]
    v_mfma_f32_16x16x32_bf16 v[76:79], v[252:255], v[60:63], v[76:79]
    s_waitcnt vmcnt(18)
    s_barrier
    ds_read_b128 v[32:35], v0 offset:32768
    ds_read_b128 v[36:39], v0 offset:49152
    ds_read_b128 v[40:43], v0 offset:33792
    ds_read_b128 v[44:47], v0 offset:50176
    ds_read_b128 v[48:51], v0 offset:34816
    ds_read_b128 v[52:55], v0 offset:51200
    s_waitcnt lgkmcnt(5)
    v_mfma_f32_16x16x32_bf16 v[80:83], v[128:131], v[32:35], 0
    v_mfma_f32_16x16x32_bf16 v[84:87], v[192:195], v[32:35], 0
    ds_read_b128 v[56:59], v0 offset:35840
    s_waitcnt lgkmcnt(5)
    v_mfma_f32_16x16x32_bf16 v[88:91], v[128:131], v[36:39], 0
    s_add_u32 m0, s72, 0
    v_cvt_pk_bf16_f32 v96, v64, v65
    v_mfma_f32_16x16x32_bf16 v[92:95], v[192:195], v[36:39], 0
    ds_read_b128 v[60:63], v0 offset:52224
    v_cvt_pk_bf16_f32 v97, v66, v67
    s_waitcnt lgkmcnt(5)
    v_mfma_f32_16x16x32_bf16 v[80:83], v[132:135], v[40:43], v[80:83]
    buffer_load_dwordx4 v0, s[8:11], s62 offen offset:0 sc1 lds
    v_cvt_pk_bf16_f32 v98, v68, v69
    v_mfma_f32_16x16x32_bf16 v[84:87], v[196:199], v[40:43], v[84:87]
    ds_read_b128 v[32:35], v0 offset:36864
    v_cvt_pk_bf16_f32 v99, v70, v71
    s_waitcnt lgkmcnt(5)
    v_mfma_f32_16x16x32_bf16 v[88:91], v[132:135], v[44:47], v[88:91]
    buffer_load_dwordx4 v0, s[8:11], s62 offen offset:1024 sc1 lds
    buffer_store_dwordx4 v[96:99], v0, s[8:11], s73 offen offset:0 sc1
    v_mfma_f32_16x16x32_bf16 v[92:95], v[196:199], v[44:47], v[92:95]
    ds_read_b128 v[36:39], v0 offset:53248
    v_cvt_pk_bf16_f32 v100, v72, v73
    s_waitcnt lgkmcnt(5)
    v_mfma_f32_16x16x32_bf16 v[80:83], v[136:139], v[48:51], v[80:83]
    buffer_load_dwordx4 v0, s[8:11], s62 offen offset:2048 sc1 lds
    v_cvt_pk_bf16_f32 v101, v74, v75
    v_mfma_f32_16x16x32_bf16 v[84:87], v[200:203], v[48:51], v[84:87]
    ds_read_b128 v[40:43], v0 offset:37888
    v_cvt_pk_bf16_f32 v102, v76, v77
    s_waitcnt lgkmcnt(5)
    v_mfma_f32_16x16x32_bf16 v[88:91], v[136:139], v[52:55], v[88:91]
    buffer_load_dwordx4 v0, s[8:11], s62 offen offset:3072 sc1 lds
    v_cvt_pk_bf16_f32 v103, v78, v79
    v_mfma_f32_16x16x32_bf16 v[92:95], v[200:203], v[52:55], v[92:95]
    ds_read_b128 v[44:47], v0 offset:54272
    buffer_store_dwordx4 v[100:103], v0, s[8:11], s73 offen offset:1024 sc1
    s_waitcnt lgkmcnt(5)
    v_mfma_f32_16x16x32_bf16 v[80:83], v[140:143], v[56:59], v[80:83]
    s_add_u32 s62, s62, 4096
    s_mov_b32 s73, s76
    v_mfma_f32_16x16x32_bf16 v[84:87], v[204:207], v[56:59], v[84:87]
    ds_read_b128 v[48:51], v0 offset:38912
    s_add_u32 s76, s76, s74
    s_waitcnt lgkmcnt(5)
    v_mfma_f32_16x16x32_bf16 v[88:91], v[140:143], v[60:63], v[88:91]
    s_add_u32 m0, s72, 4096
    v_mfma_f32_16x16x32_bf16 v[92:95], v[204:207], v[60:63], v[92:95]
    ds_read_b128 v[52:55], v0 offset:55296
    s_waitcnt lgkmcnt(5)
    v_mfma_f32_16x16x32_bf16 v[80:83], v[144:147], v[32:35], v[80:83]
    buffer_load_dwordx4 v0, s[8:11], s62 offen offset:0 sc1 lds
    v_mfma_f32_16x16x32_bf16 v[84:87], v[208:211], v[32:35], v[84:87]
    ds_read_b128 v[56:59], v0 offset:39936
    s_waitcnt lgkmcnt(5)
    v_mfma_f32_16x16x32_bf16 v[88:91], v[144:147], v[36:39], v[88:91]
    buffer_load_dwordx4 v0, s[8:11], s62 offen offset:1024 sc1 lds
    v_mfma_f32_16x16x32_bf16 v[92:95], v[208:211], v[36:39], v[92:95]
    ds_read_b128 v[60:63], v0 offset:56320
    s_waitcnt lgkmcnt(5)
    v_mfma_f32_16x16x32_bf16 v[80:83], v[148:151], v[40:43], v[80:83]
    buffer_load_dwordx4 v0, s[8:11], s62 offen offset:2048 sc1 lds
    v_mfma_f32_16x16x32_bf16 v[84:87], v[212:215], v[40:43], v[84:87]
    ds_read_b128 v[32:35], v0 offset:40960
    s_waitcnt lgkmcnt(5)
    v_mfma_f32_16x16x32_bf16 v[88:91], v[148:151], v[44:47], v[88:91]
    buffer_load_dwordx4 v0, s[8:11], s62 offen offset:3072 sc1 lds
    v_mfma_f32_16x16x32_bf16 v[92:95], v[212:215], v[44:47], v[92:95]
    ds_read_b128 v[36:39], v0 offset:57344
    s_waitcnt lgkmcnt(5)
    v_mfma_f32_16x16x32_bf16 v[80:83], v[152:155], v[48:51], v[80:83]
    s_add_u32 s62, s62, 61440
    v_mfma_f32_16x16x32_bf16 v[84:87], v[216:219], v[48:51], v[84:87]
    ds_read_b128 v[40:43], v0 offset:41984
    s_waitcnt lgkmcnt(5)
    v_mfma_f32_16x16x32_bf16 v[88:91], v[152:155], v[52:55], v[88:91]
    v_mfma_f32_16x16x32_bf16 v[92:95], v[216:219], v[52:55], v[92:95]
    ds_read_b128 v[44:47], v0 offset:58368
    s_waitcnt lgkmcnt(5)
    v_mfma_f32_16x16x32_bf16 v[80:83], v[156:159], v[56:59], v[80:83]
    v_mfma_f32_16x16x32_bf16 v[84:87], v[220:223], v[56:59], v[84:87]
    ds_read_b128 v[48:51], v0 offset:43008
    s_waitcnt lgkmcnt(5)
    v_mfma_f32_16x16x32_bf16 v[88:91], v[156:159], v[60:63], v[88:91]
    v_mfma_f32_16x16x32_bf16 v[92:95], v[220:223], v[60:63], v[92:95]
    ds_read_b128 v[52:55], v0 offset:59392
    s_waitcnt lgkmcnt(5)
    v_mfma_f32_16x16x32_bf16 v[80:83], v[160:163], v[32:35], v[80:83]
    v_mfma_f32_16x16x32_bf16 v[84:87], v[224:227], v[32:35], v[84:87]
    ds_read_b128 v[56:59], v0 offset:44032
    s_waitcnt lgkmcnt(5)
    v_mfma_f32_16x16x32_bf16 v[88:91], v[160:163], v[36:39], v[88:91]
    v_mfma_f32_16x16x32_bf16 v[92:95], v[224:227], v[36:39], v[92:95]
    ds_read_b128 v[60:63], v0 offset:60416
    s_waitcnt lgkmcnt(5)
    v_mfma_f32_16x16x32_bf16 v[80:83], v[164:167], v[40:43], v[80:83]
    v_mfma_f32_16x16x32_bf16 v[84:87], v[228:231], v[40:43], v[84:87]
    ds_read_b128 v[32:35], v0 offset:45056
    s_waitcnt lgkmcnt(5)
    v_mfma_f32_16x16x32_bf16 v[88:91], v[164:167], v[44:47], v[88:91]
    v_mfma_f32_16x16x32_bf16 v[92:95], v[228:231], v[44:47], v[92:95]
    ds_read_b128 v[36:39], v0 offset:61440
    s_waitcnt lgkmcnt(5)
    v_mfma_f32_16x16x32_bf16 v[80:83], v[168:171], v[48:51], v[80:83]
    v_mfma_f32_16x16x32_bf16 v[84:87], v[232:235], v[48:51], v[84:87]
    ds_read_b128 v[40:43], v0 offset:46080
    s_waitcnt lgkmcnt(5)
    v_mfma_f32_16x16x32_bf16 v[88:91], v[168:171], v[52:55], v[88:91]
    v_mfma_f32_16x16x32_bf16 v[92:95], v[232:235], v[52:55], v[92:95]
    ds_read_b128 v[44:47], v0 offset:62464
    s_waitcnt lgkmcnt(5)
    v_mfma_f32_16x16x32_bf16 v[80:83], v[172:175], v[56:59], v[80:83]
    v_mfma_f32_16x16x32_bf16 v[84:87], v[236:239], v[56:59], v[84:87]
    ds_read_b128 v[48:51], v0 offset:47104
    s_waitcnt lgkmcnt(5)
    v_mfma_f32_16x16x32_bf16 v[88:91], v[172:175], v[60:63], v[88:91]
    v_mfma_f32_16x16x32_bf16 v[92:95], v[236:239], v[60:63], v[92:95]
    ds_read_b128 v[52:55], v0 offset:63488
    s_waitcnt lgkmcnt(5)
    v_mfma_f32_16x16x32_bf16 v[80:83], v[176:179], v[32:35], v[80:83]
    v_mfma_f32_16x16x32_bf16 v[84:87], v[240:243], v[32:35], v[84:87]
    ds_read_b128 v[56:59], v0 offset:48128
    s_waitcnt lgkmcnt(5)
    v_mfma_f32_16x16x32_bf16 v[88:91], v[176:179], v[36:39], v[88:91]
    v_mfma_f32_16x16x32_bf16 v[92:95], v[240:243], v[36:39], v[92:95]
    ds_read_b128 v[60:63], v0 offset:64512
    s_waitcnt lgkmcnt(5)
    v_mfma_f32_16x16x32_bf16 v[80:83], v[180:183], v[40:43], v[80:83]
    v_mfma_f32_16x16x32_bf16 v[84:87], v[244:247], v[40:43], v[84:87]
    s_waitcnt lgkmcnt(4)
    v_mfma_f32_16x16x32_bf16 v[88:91], v[180:183], v[44:47], v[88:91]
    v_mfma_f32_16x16x32_bf16 v[92:95], v[244:247], v[44:47], v[92:95]
    s_waitcnt lgkmcnt(3)
    v_mfma_f32_16x16x32_bf16 v[80:83], v[184:187], v[48:51], v[80:83]
    v_mfma_f32_16x16x32_bf16 v[84:87], v[248:251], v[48:51], v[84:87]
    s_waitcnt lgkmcnt(2)
    v_mfma_f32_16x16x32_bf16 v[88:91], v[184:187], v[52:55], v[88:91]
    v_mfma_f32_16x16x32_bf16 v[92:95], v[248:251], v[52:55], v[92:95]
    s_waitcnt lgkmcnt(1)
    v_mfma_f32_16x16x32_bf16 v[80:83], v[188:191], v[56:59], v[80:83]
    v_mfma_f32_16x16x32_bf16 v[84:87], v[252:255], v[56:59], v[84:87]
    s_waitcnt lgkmcnt(0)
    v_mfma_f32_16x16x32_bf16 v[88:91], v[188:191], v[60:63], v[88:91]
    v_mfma_f32_16x16x32_bf16 v[92:95], v[252:255], v[60:63], v[92:95]
    s_waitcnt vmcnt(10)
    s_barrier
    s_cmp_lg_u32 s54, 0
    s_cbranch_scc1 W_nosig_70
    s_cmp_eq_u32 s57, 0
    s_cbranch_scc1 W_nosig_70
    s_mov_b64 exec, 1
    s_lshl_b32 s58, s57, 2
    s_add_u32 s58, s58, 124
    s_cmp_lt_u32 s55, 64
    s_cselect_b32 s59, 0x10001, 1
    v_mov_b32 v10, s59
    buffer_atomic_add v10, v1, s[12:15], s58 offen
    s_mov_b64 exec, -1
    s_nop 3
W_nosig_70:
    ds_read_b128 v[32:35], v4 offset:0
    ds_read_b128 v[36:39], v4 offset:16384
    ds_read_b128 v[40:43], v4 offset:1024
    ds_read_b128 v[44:47], v4 offset:17408
    ds_read_b128 v[48:51], v4 offset:2048
    ds_read_b128 v[52:55], v4 offset:18432
    s_waitcnt lgkmcnt(5)
    v_mfma_f32_16x16x32_bf16 v[64:67], v[128:131], v[32:35], 0
    v_mfma_f32_16x16x32_bf16 v[68:71], v[192:195], v[32:35], 0
    ds_read_b128 v[56:59], v4 offset:3072
    s_waitcnt lgkmcnt(5)
    v_mfma_f32_16x16x32_bf16 v[72:75], v[128:131], v[36:39], 0
    s_add_u32 m0, s72, 32768
    v_cvt_pk_bf16_f32 v96, v80, v81
    v_mfma_f32_16x16x32_bf16 v[76:79], v[192:195], v[36:39], 0
    ds_read_b128 v[60:63], v4 offset:19456
    v_cvt_pk_bf16_f32 v97, v82, v83
    s_waitcnt lgkmcnt(5)
    v_mfma_f32_16x16x32_bf16 v[64:67], v[132:135], v[40:43], v[64:67]
    buffer_load_dwordx4 v0, s[8:11], s62 offen offset:0 sc1 lds
    v_cvt_pk_bf16_f32 v98, v84, v85
    v_mfma_f32_16x16x32_bf16 v[68:71], v[196:199], v[40:43], v[68:71]
    ds_read_b128 v[32:35], v4 offset:4096
    v_cvt_pk_bf16_f32 v99, v86, v87
    s_waitcnt lgkmcnt(5)
    v_mfma_f32_16x16x32_bf16 v[72:75], v[132:135], v[44:47], v[72:75]
    buffer_load_dwordx4 v0, s[8:11], s62 offen offset:1024 sc1 lds
    buffer_store_dwordx4 v[96:99], v0, s[8:11], s73 offen offset:0 sc1
    v_mfma_f32_16x16x32_bf16 v[76:79], v[196:199], v[44:47], v[76:79]
    ds_read_b128 v[36:39], v4 offset:20480
    v_cvt_pk_bf16_f32 v100, v88, v89
    s_waitcnt lgkmcnt(5)
    v_mfma_f32_16x16x32_bf16 v[64:67], v[136:139], v[48:51], v[64:67]
    buffer_load_dwordx4 v0, s[8:11], s62 offen offset:2048 sc1 lds
    v_cvt_pk_bf16_f32 v101, v90, v91
    v_mfma_f32_16x16x32_bf16 v[68:71], v[200:203], v[48:51], v[68:71]
    ds_read_b128 v[40:43], v4 offset:5120
    v_cvt_pk_bf16_f32 v102, v92, v93
    s_waitcnt lgkmcnt(5)
    v_mfma_f32_16x16x32_bf16 v[72:75], v[136:139], v[52:55], v[72:75]
    buffer_load_dwordx4 v0, s[8:11], s62 offen offset:3072 sc1 lds
    v_cvt_pk_bf16_f32 v103, v94, v95
    v_mfma_f32_16x16x32_bf16 v[76:79], v[200:203], v[52:55], v[76:79]
    ds_read_b128 v[44:47], v4 offset:21504
    buffer_store_dwordx4 v[100:103], v0, s[8:11], s73 offen offset:1024 sc1
    s_waitcnt lgkmcnt(5)
    v_mfma_f32_16x16x32_bf16 v[64:67], v[140:143], v[56:59], v[64:67]
    s_add_u32 s62, s62, 4096
    s_mov_b32 s73, s76
    v_mfma_f32_16x16x32_bf16 v[68:71], v[204:207], v[56:59], v[68:71]
    ds_read_b128 v[48:51], v4 offset:6144
    s_add_u32 s76, s76, s74
    s_waitcnt lgkmcnt(5)
    v_mfma_f32_16x16x32_bf16 v[72:75], v[140:143], v[60:63], v[72:75]
    s_add_u32 m0, s72, 36864
    v_mfma_f32_16x16x32_bf16 v[76:79], v[204:207], v[60:63], v[76:79]
    ds_read_b128 v[52:55], v4 offset:22528
    s_waitcnt lgkmcnt(5)
    v_mfma_f32_16x16x32_bf16 v[64:67], v[144:147], v[32:35], v[64:67]
    buffer_load_dwordx4 v0, s[8:11], s62 offen offset:0 sc1 lds
    v_mfma_f32_16x16x32_bf16 v[68:71], v[208:211], v[32:35], v[68:71]
    ds_read_b128 v[56:59], v4 offset:7168
    s_waitcnt lgkmcnt(5)
    v_mfma_f32_16x16x32_bf16 v[72:75], v[144:147], v[36:39], v[72:75]
    buffer_load_dwordx4 v0, s[8:11], s62 offen offset:1024 sc1 lds
    v_mfma_f32_16x16x32_bf16 v[76:79], v[208:211], v[36:39], v[76:79]
    ds_read_b128 v[60:63], v4 offset:23552
    s_waitcnt lgkmcnt(5)
    v_mfma_f32_16x16x32_bf16 v[64:67], v[148:151], v[40:43], v[64:67]
    buffer_load_dwordx4 v0, s[8:11], s62 offen offset:2048 sc1 lds
    v_mfma_f32_16x16x32_bf16 v[68:71], v[212:215], v[40:43], v[68:71]
    ds_read_b128 v[32:35], v4 offset:8192
    s_waitcnt lgkmcnt(5)
    v_mfma_f32_16x16x32_bf16 v[72:75], v[148:151], v[44:47], v[72:75]
    buffer_load_dwordx4 v0, s[8:11], s62 offen offset:3072 sc1 lds
    v_mfma_f32_16x16x32_bf16 v[76:79], v[212:215], v[44:47], v[76:79]
    ds_read_b128 v[36:39], v4 offset:24576
    s_waitcnt lgkmcnt(5)
    v_mfma_f32_16x16x32_bf16 v[64:67], v[152:155], v[48:51], v[64:67]
    s_add_u32 s62, s62, 61440
    v_mfma_f32_16x16x32_bf16 v[68:71], v[216:219], v[48:51], v[68:71]
    ds_read_b128 v[40:43], v4 offset:9216
    s_waitcnt lgkmcnt(5)
    v_mfma_f32_16x16x32_bf16 v[72:75], v[152:155], v[52:55], v[72:75]
    v_mfma_f32_16x16x32_bf16 v[76:79], v[216:219], v[52:55], v[76:79]
    ds_read_b128 v[44:47], v4 offset:25600
    s_waitcnt lgkmcnt(5)
    v_mfma_f32_16x16x32_bf16 v[64:67], v[156:159], v[56:59], v[64:67]
    v_mfma_f32_16x16x32_bf16 v[68:71], v[220:223], v[56:59], v[68:71]
    ds_read_b128 v[48:51], v4 offset:10240
    s_waitcnt lgkmcnt(5)
    v_mfma_f32_16x16x32_bf16 v[72:75], v[156:159], v[60:63], v[72:75]
    v_mfma_f32_16x16x32_bf16 v[76:79], v[220:223], v[60:63], v[76:79]
    ds_read_b128 v[52:55], v4 offset:26624
    s_waitcnt lgkmcnt(5)
    v_mfma_f32_16x16x32_bf16 v[64:67], v[160:163], v[32:35], v[64:67]
    v_mfma_f32_16x16x32_bf16 v[68:71], v[224:227], v[32:35], v[68:71]
    ds_read_b128 v[56:59], v4 offset:11264
    s_waitcnt lgkmcnt(5)
    v_mfma_f32_16x16x32_bf16 v[72:75], v[160:163], v[36:39], v[72:75]
    v_mfma_f32_16x16x32_bf16 v[76:79], v[224:227], v[36:39], v[76:79]
    ds_read_b128 v[60:63], v4 offset:27648
    s_waitcnt lgkmcnt(5)
    v_mfma_f32_16x16x32_bf16 v[64:67], v[164:167], v[40:43], v[64:67]
    v_mfma_f32_16x16x32_bf16 v[68:71], v[228:231], v[40:43], v[68:71]
    ds_read_b128 v[32:35], v4 offset:12288
    s_waitcnt lgkmcnt(5)
    v_mfma_f32_16x16x32_bf16 v[72:75], v[164:167], v[44:47], v[72:75]
    v_mfma_f32_16x16x32_bf16 v[76:79], v[228:231], v[44:47], v[76:79]
    ds_read_b128 v[36:39], v4 offset:28672
    s_waitcnt lgkmcnt(5)
    v_mfma_f32_16x16x32_bf16 v[64:67], v[168:171], v[48:51], v[64:67]
    v_mfma_f32_16x16x32_bf16 v[68:71], v[232:235], v[48:51], v[68:71]
    ds_read_b128 v[40:43], v4 offset:13312
    s_waitcnt lgkmcnt(5)
    v_mfma_f32_16x16x32_bf16 v[72:75], v[168:171], v[52:55], v[72:75]
    v_mfma_f32_16x16x32_bf16 v[76:79], v[232:235], v[52:55], v[76:79]
    ds_read_b128 v[44:47], v4 offset:29696
    s_waitcnt lgkmcnt(5)
    v_mfma_f32_16x16x32_bf16 v[64:67], v[172:175], v[56:59], v[64:67]
    v_mfma_f32_16x16x32_bf16 v[68:71], v[236:239], v[56:59], v[68:71]
    ds_read_b128 v[48:51], v4 offset:14336
    s_waitcnt lgkmcnt(5)
    v_mfma_f32_16x16x32_bf16 v[72:75], v[172:175], v[60:63], v[72:75]
    v_mfma_f32_16x16x32_bf16 v[76:79], v[236:239], v[60:63], v[76:79]
    ds_read_b128 v[52:55], v4 offset:30720
    s_waitcnt lgkmcnt(5)
    v_mfma_f32_16x16x32_bf16 v[64:67], v[176:179], v[32:35], v[64:67]
    v_mfma_f32_16x16x32_bf16 v[68:71], v[240:243], v[32:35], v[68:71]
    ds_read_b128 v[56:59], v4 offset:15360
    s_waitcnt lgkmcnt(5)
    v_mfma_f32_16x16x32_bf16 v[72:75], v[176:179], v[36:39], v[72:75]
    v_mfma_f32_16x16x32_bf16 v[76:79], v[240:243], v[36:39], v[76:79]
    ds_read_b128 v[60:63], v4 offset:31744
    s_waitcnt lgkmcnt(5)
    v_mfma_f32_16x16x32_bf16 v[64:67], v[180:183], v[40:43], v[64:67]
    v_mfma_f32_16x16x32_bf16 v[68:71], v[244:247], v[40:43], v[68:71]
    s_waitcnt lgkmcnt(4)
    v_mfma_f32_16x16x32_bf16 v[72:75], v[180:183], v[44:47], v[72:75]
    v_mfma_f32_16x16x32_bf16 v[76:79], v[244:247], v[44:47], v[76:79]
    s_waitcnt lgkmcnt(3)
    v_mfma_f32_16x16x32_bf16 v[64:67], v[184:187], v[48:51], v[64:67]
    v_mfma_f32_16x16x32_bf16 v[68:71], v[248:251], v[48:51], v[68:71]
    s_waitcnt lgkmcnt(2)
    v_mfma_f32_16x16x32_bf16 v[72:75], v[184:187], v[52:55], v[72:75]
    v_mfma_f32_16x16x32_bf16 v[76:79], v[248:251], v[52:55], v[76:79]
    s_waitcnt lgkmcnt(1)
    v_mfma_f32_16x16x32_bf16 v[64:67], v[188:191], v[56:59], v[64:67]
    v_mfma_f32_16x16x32_bf16 v[68:71], v[252:255], v[56:59], v[68:71]
    s_waitcnt lgkmcnt(0)
    v_mfma_f32_16x16x32_bf16 v[72:75], v[188:191], v[60:63], v[72:75]
    v_mfma_f32_16x16x32_bf16 v[76:79], v[252:255], v[60:63], v[76:79]
    s_waitcnt vmcnt(18)
    s_barrier
    ds_read_b128 v[32:35], v4 offset:32768
    ds_read_b128 v[36:39], v4 offset:49152
    ds_read_b128 v[40:43], v4 offset:33792
    ds_read_b128 v[44:47], v4 offset:50176
    ds_read_b128 v[48:51], v4 offset:34816
    ds_read_b128 v[52:55], v4 offset:51200
    s_waitcnt lgkmcnt(5)
    v_mfma_f32_16x16x32_bf16 v[80:83], v[128:131], v[32:35], 0
    v_mfma_f32_16x16x32_bf16 v[84:87], v[192:195], v[32:35], 0
    ds_read_b128 v[56:59], v4 offset:35840
    s_waitcnt lgkmcnt(5)
    v_mfma_f32_16x16x32_bf16 v[88:91], v[128:131], v[36:39], 0
    s_add_u32 m0, s72, 65536
    v_cvt_pk_bf16_f32 v96, v64, v65
    v_mfma_f32_16x16x32_bf16 v[92:95], v[192:195], v[36:39], 0
    ds_read_b128 v[60:63], v4 offset:52224
    v_cvt_pk_bf16_f32 v97, v66, v67
    s_waitcnt lgkmcnt(5)
    v_mfma_f32_16x16x32_bf16 v[80:83], v[132:135], v[40:43], v[80:83]
    buffer_load_dwordx4 v0, s[8:11], s62 offen offset:0 sc1 lds
    v_cvt_pk_bf16_f32 v98, v68, v69
    v_mfma_f32_16x16x32_bf16 v[84:87], v[196:199], v[40:43], v[84:87]
    ds_read_b128 v[32:35], v4 offset:36864
    v_cvt_pk_bf16_f32 v99, v70, v71
    s_waitcnt lgkmcnt(5)
    v_mfma_f32_16x16x32_bf16 v[88:91], v[132:135], v[44:47], v[88:91]
    buffer_load_dwordx4 v0, s[8:11], s62 offen offset:1024 sc1 lds
    buffer_store_dwordx4 v[96:99], v0, s[8:11], s73 offen offset:0 sc1
    v_mfma_f32_16x16x32_bf16 v[92:95], v[196:199], v[44:47], v[92:95]
    ds_read_b128 v[36:39], v4 offset:53248
    v_cvt_pk_bf16_f32 v100, v72, v73
    s_waitcnt lgkmcnt(5)
    v_mfma_f32_16x16x32_bf16 v[80:83], v[136:139], v[48:51], v[80:83]
    buffer_load_dwordx4 v0, s[8:11], s62 offen offset:2048 sc1 lds
    v_cvt_pk_bf16_f32 v101, v74, v75
    v_mfma_f32_16x16x32_bf16 v[84:87], v[200:203], v[48:51], v[84:87]
    ds_read_b128 v[40:43], v4 offset:37888
    v_cvt_pk_bf16_f32 v102, v76, v77
    s_waitcnt lgkmcnt(5)
    v_mfma_f32_16x16x32_bf16 v[88:91], v[136:139], v[52:55], v[88:91]
    buffer_load_dwordx4 v0, s[8:11], s62 offen offset:3072 sc1 lds
    v_cvt_pk_bf16_f32 v103, v78, v79
    v_mfma_f32_16x16x32_bf16 v[92:95], v[200:203], v[52:55], v[92:95]
    ds_read_b128 v[44:47], v4 offset:54272
    buffer_store_dwordx4 v[100:103], v0, s[8:11], s73 offen offset:1024 sc1
    s_waitcnt lgkmcnt(5)
    v_mfma_f32_16x16x32_bf16 v[80:83], v[140:143], v[56:59], v[80:83]
    s_add_u32 s62, s62, 4096
    s_mov_b32 s73, s76
    v_mfma_f32_16x16x32_bf16 v[84:87], v[204:207], v[56:59], v[84:87]
    ds_read_b128 v[48:51], v4 offset:38912
    s_add_u32 s76, s76, s74
    s_waitcnt lgkmcnt(5)
    v_mfma_f32_16x16x32_bf16 v[88:91], v[140:143], v[60:63], v[88:91]
    s_add_u32 m0, s72, 69632
    v_mfma_f32_16x16x32_bf16 v[92:95], v[204:207], v[60:63], v[92:95]
    ds_read_b128 v[52:55], v4 offset:55296
    s_waitcnt lgkmcnt(5)
    v_mfma_f32_16x16x32_bf16 v[80:83], v[144:147], v[32:35], v[80:83]
    buffer_load_dwordx4 v0, s[8:11], s62 offen offset:0 sc1 lds
    v_mfma_f32_16x16x32_bf16 v[84:87], v[208:211], v[32:35], v[84:87]
    ds_read_b128 v[56:59], v4 offset:39936
    s_waitcnt lgkmcnt(5)
    v_mfma_f32_16x16x32_bf16 v[88:91], v[144:147], v[36:39], v[88:91]
    buffer_load_dwordx4 v0, s[8:11], s62 offen offset:1024 sc1 lds
    v_mfma_f32_16x16x32_bf16 v[92:95], v[208:211], v[36:39], v[92:95]
    ds_read_b128 v[60:63], v4 offset:56320
    s_waitcnt lgkmcnt(5)
    v_mfma_f32_16x16x32_bf16 v[80:83], v[148:151], v[40:43], v[80:83]
    buffer_load_dwordx4 v0, s[8:11], s62 offen offset:2048 sc1 lds
    v_mfma_f32_16x16x32_bf16 v[84:87], v[212:215], v[40:43], v[84:87]
    ds_read_b128 v[32:35], v4 offset:40960
    s_waitcnt lgkmcnt(5)
    v_mfma_f32_16x16x32_bf16 v[88:91], v[148:151], v[44:47], v[88:91]
    buffer_load_dwordx4 v0, s[8:11], s62 offen offset:3072 sc1 lds
    v_mfma_f32_16x16x32_bf16 v[92:95], v[212:215], v[44:47], v[92:95]
    ds_read_b128 v[36:39], v4 offset:57344
    s_waitcnt lgkmcnt(5)
    v_mfma_f32_16x16x32_bf16 v[80:83], v[152:155], v[48:51], v[80:83]
    s_add_u32 s62, s62, 61440
    v_mfma_f32_16x16x32_bf16 v[84:87], v[216:219], v[48:51], v[84:87]
    ds_read_b128 v[40:43], v4 offset:41984
    s_waitcnt lgkmcnt(5)
    v_mfma_f32_16x16x32_bf16 v[88:91], v[152:155], v[52:55], v[88:91]
    v_mfma_f32_16x16x32_bf16 v[92:95], v[216:219], v[52:55], v[92:95]
    ds_read_b128 v[44:47], v4 offset:58368
    s_waitcnt lgkmcnt(5)
    v_mfma_f32_16x16x32_bf16 v[80:83], v[156:159], v[56:59], v[80:83]
    v_mfma_f32_16x16x32_bf16 v[84:87], v[220:223], v[56:59], v[84:87]
    ds_read_b128 v[48:51], v4 offset:43008
    s_waitcnt lgkmcnt(5)
    v_mfma_f32_16x16x32_bf16 v[88:91], v[156:159], v[60:63], v[88:91]
    v_mfma_f32_16x16x32_bf16 v[92:95], v[220:223], v[60:63], v[92:95]
    ds_read_b128 v[52:55], v4 offset:59392
    s_waitcnt lgkmcnt(5)
    v_mfma_f32_16x16x32_bf16 v[80:83], v[160:163], v[32:35], v[80:83]
    v_mfma_f32_16x16x32_bf16 v[84:87], v[224:227], v[32:35], v[84:87]
    ds_read_b128 v[56:59], v4 offset:44032
    s_waitcnt lgkmcnt(5)
    v_mfma_f32_16x16x32_bf16 v[88:91], v[160:163], v[36:39], v[88:91]
    v_mfma_f32_16x16x32_bf16 v[92:95], v[224:227], v[36:39], v[92:95]
    ds_read_b128 v[60:63], v4 offset:60416
    s_waitcnt lgkmcnt(5)
    v_mfma_f32_16x16x32_bf16 v[80:83], v[164:167], v[40:43], v[80:83]
    v_mfma_f32_16x16x32_bf16 v[84:87], v[228:231], v[40:43], v[84:87]
    ds_read_b128 v[32:35], v4 offset:45056
    s_waitcnt lgkmcnt(5)
    v_mfma_f32_16x16x32_bf16 v[88:91], v[164:167], v[44:47], v[88:91]
    v_mfma_f32_16x16x32_bf16 v[92:95], v[228:231], v[44:47], v[92:95]
    ds_read_b128 v[36:39], v4 offset:61440
    s_waitcnt lgkmcnt(5)
    v_mfma_f32_16x16x32_bf16 v[80:83], v[168:171], v[48:51], v[80:83]
    v_mfma_f32_16x16x32_bf16 v[84:87], v[232:235], v[48:51], v[84:87]
    ds_read_b128 v[40:43], v4 offset:46080
    s_waitcnt lgkmcnt(5)
    v_mfma_f32_16x16x32_bf16 v[88:91], v[168:171], v[52:55], v[88:91]
    v_mfma_f32_16x16x32_bf16 v[92:95], v[232:235], v[52:55], v[92:95]
    ds_read_b128 v[44:47], v4 offset:62464
    s_waitcnt lgkmcnt(5)
    v_mfma_f32_16x16x32_bf16 v[80:83], v[172:175], v[56:59], v[80:83]
    v_mfma_f32_16x16x32_bf16 v[84:87], v[236:239], v[56:59], v[84:87]
    ds_read_b128 v[48:51], v4 offset:47104
    s_waitcnt lgkmcnt(5)
    v_mfma_f32_16x16x32_bf16 v[88:91], v[172:175], v[60:63], v[88:91]
    v_mfma_f32_16x16x32_bf16 v[92:95], v[236:239], v[60:63], v[92:95]
    ds_read_b128 v[52:55], v4 offset:63488
    s_waitcnt lgkmcnt(5)
    v_mfma_f32_16x16x32_bf16 v[80:83], v[176:179], v[32:35], v[80:83]
    v_mfma_f32_16x16x32_bf16 v[84:87], v[240:243], v[32:35], v[84:87]
    ds_read_b128 v[56:59], v4 offset:48128
    s_waitcnt lgkmcnt(5)
    v_mfma_f32_16x16x32_bf16 v[88:91], v[176:179], v[36:39], v[88:91]
    v_mfma_f32_16x16x32_bf16 v[92:95], v[240:243], v[36:39], v[92:95]
    ds_read_b128 v[60:63], v4 offset:64512
    s_waitcnt lgkmcnt(5)
    v_mfma_f32_16x16x32_bf16 v[80:83], v[180:183], v[40:43], v[80:83]
    v_mfma_f32_16x16x32_bf16 v[84:87], v[244:247], v[40:43], v[84:87]
    s_waitcnt lgkmcnt(4)
    v_mfma_f32_16x16x32_bf16 v[88:91], v[180:183], v[44:47], v[88:91]
    v_mfma_f32_16x16x32_bf16 v[92:95], v[244:247], v[44:47], v[92:95]
    s_waitcnt lgkmcnt(3)
    v_mfma_f32_16x16x32_bf16 v[80:83], v[184:187], v[48:51], v[80:83]
    v_mfma_f32_16x16x32_bf16 v[84:87], v[248:251], v[48:51], v[84:87]
    s_waitcnt lgkmcnt(2)
    v_mfma_f32_16x16x32_bf16 v[88:91], v[184:187], v[52:55], v[88:91]
    v_mfma_f32_16x16x32_bf16 v[92:95], v[248:251], v[52:55], v[92:95]
    s_waitcnt lgkmcnt(1)
    v_mfma_f32_16x16x32_bf16 v[80:83], v[188:191], v[56:59], v[80:83]
    v_mfma_f32_16x16x32_bf16 v[84:87], v[252:255], v[56:59], v[84:87]
    s_waitcnt lgkmcnt(0)
    v_mfma_f32_16x16x32_bf16 v[88:91], v[188:191], v[60:63], v[88:91]
    v_mfma_f32_16x16x32_bf16 v[92:95], v[252:255], v[60:63], v[92:95]
    s_add_u32 s57, s57, 1
    s_cmp_lt_u32 s57, 8
    s_cbranch_scc1 W_str_k
    s_nop 7
    s_nop 3
    v_cvt_pk_bf16_f32 v96, v80, v81
    v_cvt_pk_bf16_f32 v97, v82, v83
    v_cvt_pk_bf16_f32 v98, v84, v85
    v_cvt_pk_bf16_f32 v99, v86, v87
    buffer_store_dwordx4 v[96:99], v0, s[8:11], s73 offen offset:0 sc1
    v_cvt_pk_bf16_f32 v100, v88, v89
    v_cvt_pk_bf16_f32 v101, v90, v91
    v_cvt_pk_bf16_f32 v102, v92, v93
    v_cvt_pk_bf16_f32 v103, v94, v95
    buffer_store_dwordx4 v[100:103], v0, s[8:11], s73 offen offset:1024 sc1
    s_mov_b32 s73, s76
    s_add_u32 s76, s76, s74
    s_branch W_str_end
W_str_v:
    s_waitcnt vmcnt(18)
    s_barrier
    ds_read_b128 v[32:35], v0 offset:0
    ds_read_b128 v[36:39], v0 offset:16384
    ds_read_b128 v[40:43], v0 offset:1024
    ds_read_b128 v[44:47], v0 offset:17408
    ds_read_b128 v[48:51], v0 offset:2048
    ds_read_b128 v[52:55], v0 offset:18432
    s_waitcnt lgkmcnt(5)
    v_mfma_f32_16x16x32_bf16 v[64:67], v[32:35], v[128:131], 0
    v_mfma_f32_16x16x32_bf16 v[68:71], v[32:35], v[192:195], 0
    ds_read_b128 v[56:59], v0 offset:3072
    s_waitcnt lgkmcnt(5)
    v_mfma_f32_16x16x32_bf16 v[72:75], v[36:39], v[128:131], 0
    s_add_u32 m0, s72, 98304
    v_cvt_pk_bf16_f32 v96, v80, v81
    v_mfma_f32_16x16x32_bf16 v[76:79], v[36:39], v[192:195], 0
    ds_read_b128 v[60:63], v0 offset:19456
    v_cvt_pk_bf16_f32 v97, v82, v83
    s_waitcnt lgkmcnt(5)
    v_mfma_f32_16x16x32_bf16 v[64:67], v[40:43], v[132:135], v[64:67]
    buffer_load_dwordx4 v0, s[8:11], s62 offen offset:0 sc1 lds
    v_cvt_pk_bf16_f32 v98, v88, v89
    v_mfma_f32_16x16x32_bf16 v[68:71], v[40:43], v[196:199], v[68:71]
    ds_read_b128 v[32:35], v0 offset:4096
    v_cvt_pk_bf16_f32 v99, v90, v91
    s_waitcnt lgkmcnt(5)
    v_mfma_f32_16x16x32_bf16 v[72:75], v[44:47], v[132:135], v[72:75]
    buffer_load_dwordx4 v0, s[8:11], s62 offen offset:1024 sc1 lds
    buffer_store_dwordx4 v[96:99], v0, s[8:11], s73 offen offset:0 sc1
    v_mfma_f32_16x16x32_bf16 v[76:79], v[44:47], v[196:199], v[76:79]
    ds_read_b128 v[36:39], v0 offset:20480
    v_cvt_pk_bf16_f32 v100, v84, v85
    s_waitcnt lgkmcnt(5)
    v_mfma_f32_16x16x32_bf16 v[64:67], v[48:51], v[136:139], v[64:67]
    buffer_load_dwordx4 v0, s[8:11], s62 offen offset:2048 sc1 lds
    v_cvt_pk_bf16_f32 v101, v86, v87
    v_mfma_f32_16x16x32_bf16 v[68:71], v[48:51], v[200:203], v[68:71]
    ds_read_b128 v[40:43], v0 offset:5120
    v_cvt_pk_bf16_f32 v102, v92, v93
    s_waitcnt lgkmcnt(5)
    v_mfma_f32_16x16x32_bf16 v[72:75], v[52:55], v[136:139], v[72:75]
    buffer_load_dwordx4 v0, s[8:11], s62 offen offset:3072 sc1 lds
    v_cvt_pk_bf16_f32 v103, v94, v95
    v_mfma_f32_16x16x32_bf16 v[76:79], v[52:55], v[200:203], v[76:79]
    ds_read_b128 v[44:47], v0 offset:21504
    buffer_store_dwordx4 v[100:103], v0, s[8:11], s73 offen offset:1024 sc1
    s_waitcnt lgkmcnt(5)
    v_mfma_f32_16x16x32_bf16 v[64:67], v[56:59], v[140:143], v[64:67]
    s_add_u32 s62, s62, 4096
    s_mov_b32 s73, s76
    v_mfma_f32_16x16x32_bf16 v[68:71], v[56:59], v[204:207], v[68:71]
    ds_read_b128 v[48:51], v0 offset:6144
    s_add_u32 s76, s76, s74
    s_waitcnt lgkmcnt(5)
    v_mfma_f32_16x16x32_bf16 v[72:75], v[60:63], v[140:143], v[72:75]
    s_add_u32 m0, s72, 102400
    v_mfma_f32_16x16x32_bf16 v[76:79], v[60:63], v[204:207], v[76:79]
    ds_read_b128 v[52:55], v0 offset:22528
    s_waitcnt lgkmcnt(5)
    v_mfma_f32_16x16x32_bf16 v[64:67], v[32:35], v[144:147], v[64:67]
    buffer_load_dwordx4 v0, s[8:11], s62 offen offset:0 sc1 lds
    v_mfma_f32_16x16x32_bf16 v[68:71], v[32:35], v[208:211], v[68:71]
    ds_read_b128 v[56:59], v0 offset:7168
    s_waitcnt lgkmcnt(5)
    v_mfma_f32_16x16x32_bf16 v[72:75], v[36:39], v[144:147], v[72:75]
    buffer_load_dwordx4 v0, s[8:11], s62 offen offset:1024 sc1 lds
    v_mfma_f32_16x16x32_bf16 v[76:79], v[36:39], v[208:211], v[76:79]
    ds_read_b128 v[60:63], v0 offset:23552
    s_waitcnt lgkmcnt(5)
    v_mfma_f32_16x16x32_bf16 v[64:67], v[40:43], v[148:151], v[64:67]
    buffer_load_dwordx4 v0, s[8:11], s62 offen offset:2048 sc1 lds
    v_mfma_f32_16x16x32_bf16 v[68:71], v[40:43], v[212:215], v[68:71]
    ds_read_b128 v[32:35], v0 offset:8192
    s_waitcnt lgkmcnt(5)
    v_mfma_f32_16x16x32_bf16 v[72:75], v[44:47], v[148:151], v[72:75]
    buffer_load_dwordx4 v0, s[8:11], s62 offen offset:3072 sc1 lds
    v_mfma_f32_16x16x32_bf16 v[76:79], v[44:47], v[212:215], v[76:79]
    ds_read_b128 v[36:39], v0 offset:24576
    s_waitcnt lgkmcnt(5)
    v_mfma_f32_16x16x32_bf16 v[64:67], v[48:51], v[152:155], v[64:67]
    s_add_u32 s62, s62, 61440
    v_mfma_f32_16x16x32_bf16 v[68:71], v[48:51], v[216:219], v[68:71]
    ds_read_b128 v[40:43], v0 offset:9216
    s_waitcnt lgkmcnt(5)
    v_mfma_f32_16x16x32_bf16 v[72:75], v[52:55], v[152:155], v[72:75]
    v_mfma_f32_16x16x32_bf16 v[76:79], v[52:55], v[216:219], v[76:79]
    ds_read_b128 v[44:47], v0 offset:25600
    s_waitcnt lgkmcnt(5)
    v_mfma_f32_16x16x32_bf16 v[64:67], v[56:59], v[156:159], v[64:67]
    v_mfma_f32_16x16x32_bf16 v[68:71], v[56:59], v[220:223], v[68:71]
    ds_read_b128 v[48:51], v0 offset:10240
    s_waitcnt lgkmcnt(5)
    v_mfma_f32_16x16x32_bf16 v[72:75], v[60:63], v[156:159], v[72:75]
    v_mfma_f32_16x16x32_bf16 v[76:79], v[60:63], v[220:223], v[76:79]
    ds_read_b128 v[52:55], v0 offset:26624
    s_waitcnt lgkmcnt(5)
    v_mfma_f32_16x16x32_bf16 v[64:67], v[32:35], v[160:163], v[64:67]
    v_mfma_f32_16x16x32_bf16 v[68:71], v[32:35], v[224:227], v[68:71]
    ds_read_b128 v[56:59], v0 offset:11264
    s_waitcnt lgkmcnt(5)
    v_mfma_f32_16x16x32_bf16 v[72:75], v[36:39], v[160:163], v[72:75]
    v_mfma_f32_16x16x32_bf16 v[76:79], v[36:39], v[224:227], v[76:79]
    ds_read_b128 v[60:63], v0 offset:27648
    s_waitcnt lgkmcnt(5)
    v_mfma_f32_16x16x32_bf16 v[64:67], v[40:43], v[164:167], v[64:67]
    v_mfma_f32_16x16x32_bf16 v[68:71], v[40:43], v[228:231], v[68:71]
    ds_read_b128 v[32:35], v0 offset:12288
    s_waitcnt lgkmcnt(5)
    v_mfma_f32_16x16x32_bf16 v[72:75], v[44:47], v[164:167], v[72:75]
    v_mfma_f32_16x16x32_bf16 v[76:79], v[44:47], v[228:231], v[76:79]
    ds_read_b128 v[36:39], v0 offset:28672
    s_waitcnt lgkmcnt(5)
    v_mfma_f32_16x16x32_bf16 v[64:67], v[48:51], v[168:171], v[64:67]
    v_mfma_f32_16x16x32_bf16 v[68:71], v[48:51], v[232:235], v[68:71]
    ds_read_b128 v[40:43], v0 offset:13312
    s_waitcnt lgkmcnt(5)
    v_mfma_f32_16x16x32_bf16 v[72:75], v[52:55], v[168:171], v[72:75]
    v_mfma_f32_16x16x32_bf16 v[76:79], v[52:55], v[232:235], v[76:79]
    ds_read_b128 v[44:47], v0 offset:29696
    s_waitcnt lgkmcnt(5)
    v_mfma_f32_16x16x32_bf16 v[64:67], v[56:59], v[172:175], v[64:67]
    v_mfma_f32_16x16x32_bf16 v[68:71], v[56:59], v[236:239], v[68:71]
    ds_read_b128 v[48:51], v0 offset:14336
    s_waitcnt lgkmcnt(5)
    v_mfma_f32_16x16x32_bf16 v[72:75], v[60:63], v[172:175], v[72:75]
    v_mfma_f32_16x16x32_bf16 v[76:79], v[60:63], v[236:239], v[76:79]
    ds_read_b128 v[52:55], v0 offset:30720
    s_waitcnt lgkmcnt(5)
    v_mfma_f32_16x16x32_bf16 v[64:67], v[32:35], v[176:179], v[64:67]
    v_mfma_f32_16x16x32_bf16 v[68:71], v[32:35], v[240:243], v[68:71]
    ds_read_b128 v[56:59], v0 offset:15360
    s_waitcnt lgkmcnt(5)
    v_mfma_f32_16x16x32_bf16 v[72:75], v[36:39], v[176:179], v[72:75]
    v_mfma_f32_16x16x32_bf16 v[76:79], v[36:39], v[240:243], v[76:79]
    ds_read_b128 v[60:63], v0 offset:31744
    s_waitcnt lgkmcnt(5)
    v_mfma_f32_16x16x32_bf16 v[64:67], v[40:43], v[180:183], v[64:67]
    v_mfma_f32_16x16x32_bf16 v[68:71], v[40:43], v[244:247], v[68:71]
    s_waitcnt lgkmcnt(4)
    v_mfma_f32_16x16x32_bf16 v[72:75], v[44:47], v[180:183], v[72:75]
    v_mfma_f32_16x16x32_bf16 v[76:79], v[44:47], v[244:247], v[76:79]
    s_waitcnt lgkmcnt(3)
    v_mfma_f32_16x16x32_bf16 v[64:67], v[48:51], v[184:187], v[64:67]
    v_mfma_f32_16x16x32_bf16 v[68:71], v[48:51], v[248:251], v[68:71]
    s_waitcnt lgkmcnt(2)
    v_mfma_f32_16x16x32_bf16 v[72:75], v[52:55], v[184:187], v[72:75]
    v_mfma_f32_16x16x32_bf16 v[76:79], v[52:55], v[248:251], v[76:79]
    s_waitcnt lgkmcnt(1)
    v_mfma_f32_16x16x32_bf16 v[64:67], v[56:59], v[188:191], v[64:67]
    v_mfma_f32_16x16x32_bf16 v[68:71], v[56:59], v[252:255], v[68:71]
    s_waitcnt lgkmcnt(0)
    v_mfma_f32_16x16x32_bf16 v[72:75], v[60:63], v[188:191], v[72:75]
    v_mfma_f32_16x16x32_bf16 v[76:79], v[60:63], v[252:255], v[76:79]
    s_waitcnt vmcnt(18)
    s_barrier
    ds_read_b128 v[32:35], v0 offset:32768
    ds_read_b128 v[36:39], v0 offset:49152
    ds_read_b128 v[40:43], v0 offset:33792
    ds_read_b128 v[44:47], v0 offset:50176
    ds_read_b128 v[48:51], v0 offset:34816
    ds_read_b128 v[52:55], v0 offset:51200
    s_waitcnt lgkmcnt(5)
    v_mfma_f32_16x16x32_bf16 v[80:83], v[32:35], v[128:131], 0
    v_mfma_f32_16x16x32_bf16 v[84:87], v[32:35], v[192:195], 0
    ds_read_b128 v[56:59], v0 offset:35840
    s_waitcnt lgkmcnt(5)
    v_mfma_f32_16x16x32_bf16 v[88:91], v[36:39], v[128:131], 0
    s_add_u32 m0, s72, 0
    v_cvt_pk_bf16_f32 v96, v64, v65
    v_mfma_f32_16x16x32_bf16 v[92:95], v[36:39], v[192:195], 0
    ds_read_b128 v[60:63], v0 offset:52224
    v_cvt_pk_bf16_f32 v97, v66, v67
    s_waitcnt lgkmcnt(5)
    v_mfma_f32_16x16x32_bf16 v[80:83], v[40:43], v[132:135], v[80:83]
    buffer_load_dwordx4 v0, s[8:11], s62 offen offset:0 sc1 lds
    v_cvt_pk_bf16_f32 v98, v72, v73
    v_mfma_f32_16x16x32_bf16 v[84:87], v[40:43], v[196:199], v[84:87]
    ds_read_b128 v[32:35], v0 offset:36864
    v_cvt_pk_bf16_f32 v99, v74, v75
    s_waitcnt lgkmcnt(5)
    v_mfma_f32_16x16x32_bf16 v[88:91], v[44:47], v[132:135], v[88:91]
    buffer_load_dwordx4 v0, s[8:11], s62 offen offset:1024 sc1 lds
    buffer_store_dwordx4 v[96:99], v0, s[8:11], s73 offen offset:0 sc1
    v_mfma_f32_16x16x32_bf16 v[92:95], v[44:47], v[196:199], v[92:95]
    ds_read_b128 v[36:39], v0 offset:53248
    v_cvt_pk_bf16_f32 v100, v68, v69
    s_waitcnt lgkmcnt(5)
    v_mfma_f32_16x16x32_bf16 v[80:83], v[48:51], v[136:139], v[80:83]
    buffer_load_dwordx4 v0, s[8:11], s62 offen offset:2048 sc1 lds
    v_cvt_pk_bf16_f32 v101, v70, v71
    v_mfma_f32_16x16x32_bf16 v[84:87], v[48:51], v[200:203], v[84:87]
    ds_read_b128 v[40:43], v0 offset:37888
    v_cvt_pk_bf16_f32 v102, v76, v77
    s_waitcnt lgkmcnt(5)
    v_mfma_f32_16x16x32_bf16 v[88:91], v[52:55], v[136:139], v[88:91]
    buffer_load_dwordx4 v0, s[8:11], s62 offen offset:3072 sc1 lds
    v_cvt_pk_bf16_f32 v103, v78, v79
    v_mfma_f32_16x16x32_bf16 v[92:95], v[52:55], v[200:203], v[92:95]
    ds_read_b128 v[44:47], v0 offset:54272
    buffer_store_dwordx4 v[100:103], v0, s[8:11], s73 offen offset:1024 sc1
    s_waitcnt lgkmcnt(5)
    v_mfma_f32_16x16x32_bf16 v[80:83], v[56:59], v[140:143], v[80:83]
    s_add_u32 s62, s62, 4096
    s_mov_b32 s73, s76
    v_mfma_f32_16x16x32_bf16 v[84:87], v[56:59], v[204:207], v[84:87]
    ds_read_b128 v[48:51], v0 offset:38912
    s_add_u32 s76, s76, s74
    s_waitcnt lgkmcnt(5)
    v_mfma_f32_16x16x32_bf16 v[88:91], v[60:63], v[140:143], v[88:91]
    s_add_u32 m0, s72, 4096
    v_mfma_f32_16x16x32_bf16 v[92:95], v[60:63], v[204:207], v[92:95]
    ds_read_b128 v[52:55], v0 offset:55296
    s_waitcnt lgkmcnt(5)
    v_mfma_f32_16x16x32_bf16 v[80:83], v[32:35], v[144:147], v[80:83]
    buffer_load_dwordx4 v0, s[8:11], s62 offen offset:0 sc1 lds
    v_mfma_f32_16x16x32_bf16 v[84:87], v[32:35], v[208:211], v[84:87]
    ds_read_b128 v[56:59], v0 offset:39936
    s_waitcnt lgkmcnt(5)
    v_mfma_f32_16x16x32_bf16 v[88:91], v[36:39], v[144:147], v[88:91]
    buffer_load_dwordx4 v0, s[8:11], s62 offen offset:1024 sc1 lds
    v_mfma_f32_16x16x32_bf16 v[92:95], v[36:39], v[208:211], v[92:95]
    ds_read_b128 v[60:63], v0 offset:56320
    s_waitcnt lgkmcnt(5)
    v_mfma_f32_16x16x32_bf16 v[80:83], v[40:43], v[148:151], v[80:83]
    buffer_load_dwordx4 v0, s[8:11], s62 offen offset:2048 sc1 lds
    v_mfma_f32_16x16x32_bf16 v[84:87], v[40:43], v[212:215], v[84:87]
    ds_read_b128 v[32:35], v0 offset:40960
    s_waitcnt lgkmcnt(5)
    v_mfma_f32_16x16x32_bf16 v[88:91], v[44:47], v[148:151], v[88:91]
    buffer_load_dwordx4 v0, s[8:11], s62 offen offset:3072 sc1 lds
    v_mfma_f32_16x16x32_bf16 v[92:95], v[44:47], v[212:215], v[92:95]
    ds_read_b128 v[36:39], v0 offset:57344
    s_waitcnt lgkmcnt(5)
    v_mfma_f32_16x16x32_bf16 v[80:83], v[48:51], v[152:155], v[80:83]
    s_add_u32 s62, s62, 61440
    v_mfma_f32_16x16x32_bf16 v[84:87], v[48:51], v[216:219], v[84:87]
    ds_read_b128 v[40:43], v0 offset:41984
    s_waitcnt lgkmcnt(5)
    v_mfma_f32_16x16x32_bf16 v[88:91], v[52:55], v[152:155], v[88:91]
    v_mfma_f32_16x16x32_bf16 v[92:95], v[52:55], v[216:219], v[92:95]
    ds_read_b128 v[44:47], v0 offset:58368
    s_waitcnt lgkmcnt(5)
    v_mfma_f32_16x16x32_bf16 v[80:83], v[56:59], v[156:159], v[80:83]
    v_mfma_f32_16x16x32_bf16 v[84:87], v[56:59], v[220:223], v[84:87]
    ds_read_b128 v[48:51], v0 offset:43008
    s_waitcnt lgkmcnt(5)
    v_mfma_f32_16x16x32_bf16 v[88:91], v[60:63], v[156:159], v[88:91]
    v_mfma_f32_16x16x32_bf16 v[92:95], v[60:63], v[220:223], v[92:95]
    ds_read_b128 v[52:55], v0 offset:59392
    s_waitcnt lgkmcnt(5)
    v_mfma_f32_16x16x32_bf16 v[80:83], v[32:35], v[160:163], v[80:83]
    v_mfma_f32_16x16x32_bf16 v[84:87], v[32:35], v[224:227], v[84:87]
    ds_read_b128 v[56:59], v0 offset:44032
    s_waitcnt lgkmcnt(5)
    v_mfma_f32_16x16x32_bf16 v[88:91], v[36:39], v[160:163], v[88:91]
    v_mfma_f32_16x16x32_bf16 v[92:95], v[36:39], v[224:227], v[92:95]
    ds_read_b128 v[60:63], v0 offset:60416
    s_waitcnt lgkmcnt(5)
    v_mfma_f32_16x16x32_bf16 v[80:83], v[40:43], v[164:167], v[80:83]
    v_mfma_f32_16x16x32_bf16 v[84:87], v[40:43], v[228:231], v[84:87]
    ds_read_b128 v[32:35], v0 offset:45056
    s_waitcnt lgkmcnt(5)
    v_mfma_f32_16x16x32_bf16 v[88:91], v[44:47], v[164:167], v[88:91]
    v_mfma_f32_16x16x32_bf16 v[92:95], v[44:47], v[228:231], v[92:95]
    ds_read_b128 v[36:39], v0 offset:61440
    s_waitcnt lgkmcnt(5)
    v_mfma_f32_16x16x32_bf16 v[80:83], v[48:51], v[168:171], v[80:83]
    v_mfma_f32_16x16x32_bf16 v[84:87], v[48:51], v[232:235], v[84:87]
    ds_read_b128 v[40:43], v0 offset:46080
    s_waitcnt lgkmcnt(5)
    v_mfma_f32_16x16x32_bf16 v[88:91], v[52:55], v[168:171], v[88:91]
    v_mfma_f32_16x16x32_bf16 v[92:95], v[52:55], v[232:235], v[92:95]
    ds_read_b128 v[44:47], v0 offset:62464
    s_waitcnt lgkmcnt(5)
    v_mfma_f32_16x16x32_bf16 v[80:83], v[56:59], v[172:175], v[80:83]
    v_mfma_f32_16x16x32_bf16 v[84:87], v[56:59], v[236:239], v[84:87]
    ds_read_b128 v[48:51], v0 offset:47104
    s_waitcnt lgkmcnt(5)
    v_mfma_f32_16x16x32_bf16 v[88:91], v[60:63], v[172:175], v[88:91]
    v_mfma_f32_16x16x32_bf16 v[92:95], v[60:63], v[236:239], v[92:95]
    ds_read_b128 v[52:55], v0 offset:63488
    s_waitcnt lgkmcnt(5)
    v_mfma_f32_16x16x32_bf16 v[80:83], v[32:35], v[176:179], v[80:83]
    v_mfma_f32_16x16x32_bf16 v[84:87], v[32:35], v[240:243], v[84:87]
    ds_read_b128 v[56:59], v0 offset:48128
    s_waitcnt lgkmcnt(5)
    v_mfma_f32_16x16x32_bf16 v[88:91], v[36:39], v[176:179], v[88:91]
    v_mfma_f32_16x16x32_bf16 v[92:95], v[36:39], v[240:243], v[92:95]
    ds_read_b128 v[60:63], v0 offset:64512
    s_waitcnt lgkmcnt(5)
    v_mfma_f32_16x16x32_bf16 v[80:83], v[40:43], v[180:183], v[80:83]
    v_mfma_f32_16x16x32_bf16 v[84:87], v[40:43], v[244:247], v[84:87]
    s_waitcnt lgkmcnt(4)
    v_mfma_f32_16x16x32_bf16 v[88:91], v[44:47], v[180:183], v[88:91]
    v_mfma_f32_16x16x32_bf16 v[92:95], v[44:47], v[244:247], v[92:95]
    s_waitcnt lgkmcnt(3)
    v_mfma_f32_16x16x32_bf16 v[80:83], v[48:51], v[184:187], v[80:83]
    v_mfma_f32_16x16x32_bf16 v[84:87], v[48:51], v[248:251], v[84:87]
    s_waitcnt lgkmcnt(2)
    v_mfma_f32_16x16x32_bf16 v[88:91], v[52:55], v[184:187], v[88:91]
    v_mfma_f32_16x16x32_bf16 v[92:95], v[52:55], v[248:251], v[92:95]
    s_waitcnt lgkmcnt(1)
    v_mfma_f32_16x16x32_bf16 v[80:83], v[56:59], v[188:191], v[80:83]
    v_mfma_f32_16x16x32_bf16 v[84:87], v[56:59], v[252:255], v[84:87]
    s_waitcnt lgkmcnt(0)
    v_mfma_f32_16x16x32_bf16 v[88:91], v[60:63], v[188:191], v[88:91]
    v_mfma_f32_16x16x32_bf16 v[92:95], v[60:63], v[252:255], v[92:95]
    s_waitcnt vmcnt(10)
    s_barrier
    s_cmp_lg_u32 s54, 0
    s_cbranch_scc1 W_nosig_71
    s_cmp_eq_u32 s57, 0
    s_cbranch_scc1 W_nosig_71
    s_mov_b64 exec, 1
    s_lshl_b32 s58, s57, 2
    s_add_u32 s58, s58, 124
    s_cmp_lt_u32 s55, 64
    s_cselect_b32 s59, 0x10001, 1
    v_mov_b32 v10, s59
    buffer_atomic_add v10, v1, s[12:15], s58 offen
    s_mov_b64 exec, -1
    s_nop 3
W_nosig_71:
    ds_read_b128 v[32:35], v4 offset:0
    ds_read_b128 v[36:39], v4 offset:16384
    ds_read_b128 v[40:43], v4 offset:1024
    ds_read_b128 v[44:47], v4 offset:17408
    ds_read_b128 v[48:51], v4 offset:2048
    ds_read_b128 v[52:55], v4 offset:18432
    s_waitcnt lgkmcnt(5)
    v_mfma_f32_16x16x32_bf16 v[64:67], v[32:35], v[128:131], 0
    v_mfma_f32_16x16x32_bf16 v[68:71], v[32:35], v[192:195], 0
    ds_read_b128 v[56:59], v4 offset:3072
    s_waitcnt lgkmcnt(5)
    v_mfma_f32_16x16x32_bf16 v[72:75], v[36:39], v[128:131], 0
    s_add_u32 m0, s72, 32768
    v_cvt_pk_bf16_f32 v96, v80, v81
    v_mfma_f32_16x16x32_bf16 v[76:79], v[36:39], v[192:195], 0
    ds_read_b128 v[60:63], v4 offset:19456
    v_cvt_pk_bf16_f32 v97, v82, v83
    s_waitcnt lgkmcnt(5)
    v_mfma_f32_16x16x32_bf16 v[64:67], v[40:43], v[132:135], v[64:67]
    buffer_load_dwordx4 v0, s[8:11], s62 offen offset:0 sc1 lds
    v_cvt_pk_bf16_f32 v98, v88, v89
    v_mfma_f32_16x16x32_bf16 v[68:71], v[40:43], v[196:199], v[68:71]
    ds_read_b128 v[32:35], v4 offset:4096
    v_cvt_pk_bf16_f32 v99, v90, v91
    s_waitcnt lgkmcnt(5)
    v_mfma_f32_16x16x32_bf16 v[72:75], v[44:47], v[132:135], v[72:75]
    buffer_load_dwordx4 v0, s[8:11], s62 offen offset:1024 sc1 lds
    buffer_store_dwordx4 v[96:99], v0, s[8:11], s73 offen offset:0 sc1
    v_mfma_f32_16x16x32_bf16 v[76:79], v[44:47], v[196:199], v[76:79]
    ds_read_b128 v[36:39], v4 offset:20480
    v_cvt_pk_bf16_f32 v100, v84, v85
    s_waitcnt lgkmcnt(5)
    v_mfma_f32_16x16x32_bf16 v[64:67], v[48:51], v[136:139], v[64:67]
    buffer_load_dwordx4 v0, s[8:11], s62 offen offset:2048 sc1 lds
    v_cvt_pk_bf16_f32 v101, v86, v87
    v_mfma_f32_16x16x32_bf16 v[68:71], v[48:51], v[200:203], v[68:71]
    ds_read_b128 v[40:43], v4 offset:5120
    v_cvt_pk_bf16_f32 v102, v92, v93
    s_waitcnt lgkmcnt(5)
    v_mfma_f32_16x16x32_bf16 v[72:75], v[52:55], v[136:139], v[72:75]
    buffer_load_dwordx4 v0, s[8:11], s62 offen offset:3072 sc1 lds
    v_cvt_pk_bf16_f32 v103, v94, v95
    v_mfma_f32_16x16x32_bf16 v[76:79], v[52:55], v[200:203], v[76:79]
    ds_read_b128 v[44:47], v4 offset:21504
    buffer_store_dwordx4 v[100:103], v0, s[8:11], s73 offen offset:1024 sc1
    s_waitcnt lgkmcnt(5)
    v_mfma_f32_16x16x32_bf16 v[64:67], v[56:59], v[140:143], v[64:67]
    s_add_u32 s62, s62, 4096
    s_mov_b32 s73, s76
    v_mfma_f32_16x16x32_bf16 v[68:71], v[56:59], v[204:207], v[68:71]
    ds_read_b128 v[48:51], v4 offset:6144
    s_add_u32 s76, s76, s74
    s_waitcnt lgkmcnt(5)
    v_mfma_f32_16x16x32_bf16 v[72:75], v[60:63], v[140:143], v[72:75]
    s_add_u32 m0, s72, 36864
    v_mfma_f32_16x16x32_bf16 v[76:79], v[60:63], v[204:207], v[76:79]
    ds_read_b128 v[52:55], v4 offset:22528
    s_waitcnt lgkmcnt(5)
    v_mfma_f32_16x16x32_bf16 v[64:67], v[32:35], v[144:147], v[64:67]
    buffer_load_dwordx4 v0, s[8:11], s62 offen offset:0 sc1 lds
    v_mfma_f32_16x16x32_bf16 v[68:71], v[32:35], v[208:211], v[68:71]
    ds_read_b128 v[56:59], v4 offset:7168
    s_waitcnt lgkmcnt(5)
    v_mfma_f32_16x16x32_bf16 v[72:75], v[36:39], v[144:147], v[72:75]
    buffer_load_dwordx4 v0, s[8:11], s62 offen offset:1024 sc1 lds
    v_mfma_f32_16x16x32_bf16 v[76:79], v[36:39], v[208:211], v[76:79]
    ds_read_b128 v[60:63], v4 offset:23552
    s_waitcnt lgkmcnt(5)
    v_mfma_f32_16x16x32_bf16 v[64:67], v[40:43], v[148:151], v[64:67]
    buffer_load_dwordx4 v0, s[8:11], s62 offen offset:2048 sc1 lds
    v_mfma_f32_16x16x32_bf16 v[68:71], v[40:43], v[212:215], v[68:71]
    ds_read_b128 v[32:35], v4 offset:8192
    s_waitcnt lgkmcnt(5)
    v_mfma_f32_16x16x32_bf16 v[72:75], v[44:47], v[148:151], v[72:75]
    buffer_load_dwordx4 v0, s[8:11], s62 offen offset:3072 sc1 lds
    v_mfma_f32_16x16x32_bf16 v[76:79], v[44:47], v[212:215], v[76:79]
    ds_read_b128 v[36:39], v4 offset:24576
    s_waitcnt lgkmcnt(5)
    v_mfma_f32_16x16x32_bf16 v[64:67], v[48:51], v[152:155], v[64:67]
    s_add_u32 s62, s62, 61440
    v_mfma_f32_16x16x32_bf16 v[68:71], v[48:51], v[216:219], v[68:71]
    ds_read_b128 v[40:43], v4 offset:9216
    s_waitcnt lgkmcnt(5)
    v_mfma_f32_16x16x32_bf16 v[72:75], v[52:55], v[152:155], v[72:75]
    v_mfma_f32_16x16x32_bf16 v[76:79], v[52:55], v[216:219], v[76:79]
    ds_read_b128 v[44:47], v4 offset:25600
    s_waitcnt lgkmcnt(5)
    v_mfma_f32_16x16x32_bf16 v[64:67], v[56:59], v[156:159], v[64:67]
    v_mfma_f32_16x16x32_bf16 v[68:71], v[56:59], v[220:223], v[68:71]
    ds_read_b128 v[48:51], v4 offset:10240
    s_waitcnt lgkmcnt(5)
    v_mfma_f32_16x16x32_bf16 v[72:75], v[60:63], v[156:159], v[72:75]
    v_mfma_f32_16x16x32_bf16 v[76:79], v[60:63], v[220:223], v[76:79]
    ds_read_b128 v[52:55], v4 offset:26624
    s_waitcnt lgkmcnt(5)
    v_mfma_f32_16x16x32_bf16 v[64:67], v[32:35], v[160:163], v[64:67]
    v_mfma_f32_16x16x32_bf16 v[68:71], v[32:35], v[224:227], v[68:71]
    ds_read_b128 v[56:59], v4 offset:11264
    s_waitcnt lgkmcnt(5)
    v_mfma_f32_16x16x32_bf16 v[72:75], v[36:39], v[160:163], v[72:75]
    v_mfma_f32_16x16x32_bf16 v[76:79], v[36:39], v[224:227], v[76:79]
    ds_read_b128 v[60:63], v4 offset:27648
    s_waitcnt lgkmcnt(5)
    v_mfma_f32_16x16x32_bf16 v[64:67], v[40:43], v[164:167], v[64:67]
    v_mfma_f32_16x16x32_bf16 v[68:71], v[40:43], v[228:231], v[68:71]
    ds_read_b128 v[32:35], v4 offset:12288
    s_waitcnt lgkmcnt(5)
    v_mfma_f32_16x16x32_bf16 v[72:75], v[44:47], v[164:167], v[72:75]
    v_mfma_f32_16x16x32_bf16 v[76:79], v[44:47], v[228:231], v[76:79]
    ds_read_b128 v[36:39], v4 offset:28672
    s_waitcnt lgkmcnt(5)
    v_mfma_f32_16x16x32_bf16 v[64:67], v[48:51], v[168:171], v[64:67]
    v_mfma_f32_16x16x32_bf16 v[68:71], v[48:51], v[232:235], v[68:71]
    ds_read_b128 v[40:43], v4 offset:13312
    s_waitcnt lgkmcnt(5)
    v_mfma_f32_16x16x32_bf16 v[72:75], v[52:55], v[168:171], v[72:75]
    v_mfma_f32_16x16x32_bf16 v[76:79], v[52:55], v[232:235], v[76:79]
    ds_read_b128 v[44:47], v4 offset:29696
    s_waitcnt lgkmcnt(5)
    v_mfma_f32_16x16x32_bf16 v[64:67], v[56:59], v[172:175], v[64:67]
    v_mfma_f32_16x16x32_bf16 v[68:71], v[56:59], v[236:239], v[68:71]
    ds_read_b128 v[48:51], v4 offset:14336
    s_waitcnt lgkmcnt(5)
    v_mfma_f32_16x16x32_bf16 v[72:75], v[60:63], v[172:175], v[72:75]
    v_mfma_f32_16x16x32_bf16 v[76:79], v[60:63], v[236:239], v[76:79]
    ds_read_b128 v[52:55], v4 offset:30720
    s_waitcnt lgkmcnt(5)
    v_mfma_f32_16x16x32_bf16 v[64:67], v[32:35], v[176:179], v[64:67]
    v_mfma_f32_16x16x32_bf16 v[68:71], v[32:35], v[240:243], v[68:71]
    ds_read_b128 v[56:59], v4 offset:15360
    s_waitcnt lgkmcnt(5)
    v_mfma_f32_16x16x32_bf16 v[72:75], v[36:39], v[176:179], v[72:75]
    v_mfma_f32_16x16x32_bf16 v[76:79], v[36:39], v[240:243], v[76:79]
    ds_read_b128 v[60:63], v4 offset:31744
    s_waitcnt lgkmcnt(5)
    v_mfma_f32_16x16x32_bf16 v[64:67], v[40:43], v[180:183], v[64:67]
    v_mfma_f32_16x16x32_bf16 v[68:71], v[40:43], v[244:247], v[68:71]
    s_waitcnt lgkmcnt(4)
    v_mfma_f32_16x16x32_bf16 v[72:75], v[44:47], v[180:183], v[72:75]
    v_mfma_f32_16x16x32_bf16 v[76:79], v[44:47], v[244:247], v[76:79]
    s_waitcnt lgkmcnt(3)
    v_mfma_f32_16x16x32_bf16 v[64:67], v[48:51], v[184:187], v[64:67]
    v_mfma_f32_16x16x32_bf16 v[68:71], v[48:51], v[248:251], v[68:71]
    s_waitcnt lgkmcnt(2)
    v_mfma_f32_16x16x32_bf16 v[72:75], v[52:55], v[184:187], v[72:75]
    v_mfma_f32_16x16x32_bf16 v[76:79], v[52:55], v[248:251], v[76:79]
    s_waitcnt lgkmcnt(1)
    v_mfma_f32_16x16x32_bf16 v[64:67], v[56:59], v[188:191], v[64:67]
    v_mfma_f32_16x16x32_bf16 v[68:71], v[56:59], v[252:255], v[68:71]
    s_waitcnt lgkmcnt(0)
    v_mfma_f32_16x16x32_bf16 v[72:75], v[60:63], v[188:191], v[72:75]
    v_mfma_f32_16x16x32_bf16 v[76:79], v[60:63], v[252:255], v[76:79]
    s_waitcnt vmcnt(18)
    s_barrier
    ds_read_b128 v[32:35], v4 offset:32768
    ds_read_b128 v[36:39], v4 offset:49152
    ds_read_b128 v[40:43], v4 offset:33792
    ds_read_b128 v[44:47], v4 offset:50176
    ds_read_b128 v[48:51], v4 offset:34816
    ds_read_b128 v[52:55], v4 offset:51200
    s_waitcnt lgkmcnt(5)
    v_mfma_f32_16x16x32_bf16 v[80:83], v[32:35], v[128:131], 0
    v_mfma_f32_16x16x32_bf16 v[84:87], v[32:35], v[192:195], 0
    ds_read_b128 v[56:59], v4 offset:35840
    s_waitcnt lgkmcnt(5)
    v_mfma_f32_16x16x32_bf16 v[88:91], v[36:39], v[128:131], 0
    s_add_u32 m0, s72, 65536
    v_cvt_pk_bf16_f32 v96, v64, v65
    v_mfma_f32_16x16x32_bf16 v[92:95], v[36:39], v[192:195], 0
    ds_read_b128 v[60:63], v4 offset:52224
    v_cvt_pk_bf16_f32 v97, v66, v67
    s_waitcnt lgkmcnt(5)
    v_mfma_f32_16x16x32_bf16 v[80:83], v[40:43], v[132:135], v[80:83]
    buffer_load_dwordx4 v0, s[8:11], s62 offen offset:0 sc1 lds
    v_cvt_pk_bf16_f32 v98, v72, v73
    v_mfma_f32_16x16x32_bf16 v[84:87], v[40:43], v[196:199], v[84:87]
    ds_read_b128 v[32:35], v4 offset:36864
    v_cvt_pk_bf16_f32 v99, v74, v75
    s_waitcnt lgkmcnt(5)
    v_mfma_f32_16x16x32_bf16 v[88:91], v[44:47], v[132:135], v[88:91]
    buffer_load_dwordx4 v0, s[8:11], s62 offen offset:1024 sc1 lds
    buffer_store_dwordx4 v[96:99], v0, s[8:11], s73 offen offset:0 sc1
    v_mfma_f32_16x16x32_bf16 v[92:95], v[44:47], v[196:199], v[92:95]
    ds_read_b128 v[36:39], v4 offset:53248
    v_cvt_pk_bf16_f32 v100, v68, v69
    s_waitcnt lgkmcnt(5)
    v_mfma_f32_16x16x32_bf16 v[80:83], v[48:51], v[136:139], v[80:83]
    buffer_load_dwordx4 v0, s[8:11], s62 offen offset:2048 sc1 lds
    v_cvt_pk_bf16_f32 v101, v70, v71
    v_mfma_f32_16x16x32_bf16 v[84:87], v[48:51], v[200:203], v[84:87]
    ds_read_b128 v[40:43], v4 offset:37888
    v_cvt_pk_bf16_f32 v102, v76, v77
    s_waitcnt lgkmcnt(5)
    v_mfma_f32_16x16x32_bf16 v[88:91], v[52:55], v[136:139], v[88:91]
    buffer_load_dwordx4 v0, s[8:11], s62 offen offset:3072 sc1 lds
    v_cvt_pk_bf16_f32 v103, v78, v79
    v_mfma_f32_16x16x32_bf16 v[92:95], v[52:55], v[200:203], v[92:95]
    ds_read_b128 v[44:47], v4 offset:54272
    buffer_store_dwordx4 v[100:103], v0, s[8:11], s73 offen offset:1024 sc1
    s_waitcnt lgkmcnt(5)
    v_mfma_f32_16x16x32_bf16 v[80:83], v[56:59], v[140:143], v[80:83]
    s_add_u32 s62, s62, 4096
    s_mov_b32 s73, s76
    v_mfma_f32_16x16x32_bf16 v[84:87], v[56:59], v[204:207], v[84:87]
    ds_read_b128 v[48:51], v4 offset:38912
    s_add_u32 s76, s76, s74
    s_waitcnt lgkmcnt(5)
    v_mfma_f32_16x16x32_bf16 v[88:91], v[60:63], v[140:143], v[88:91]
    s_add_u32 m0, s72, 69632
    v_mfma_f32_16x16x32_bf16 v[92:95], v[60:63], v[204:207], v[92:95]
    ds_read_b128 v[52:55], v4 offset:55296
    s_waitcnt lgkmcnt(5)
    v_mfma_f32_16x16x32_bf16 v[80:83], v[32:35], v[144:147], v[80:83]
    buffer_load_dwordx4 v0, s[8:11], s62 offen offset:0 sc1 lds
    v_mfma_f32_16x16x32_bf16 v[84:87], v[32:35], v[208:211], v[84:87]
    ds_read_b128 v[56:59], v4 offset:39936
    s_waitcnt lgkmcnt(5)
    v_mfma_f32_16x16x32_bf16 v[88:91], v[36:39], v[144:147], v[88:91]
    buffer_load_dwordx4 v0, s[8:11], s62 offen offset:1024 sc1 lds
    v_mfma_f32_16x16x32_bf16 v[92:95], v[36:39], v[208:211], v[92:95]
    ds_read_b128 v[60:63], v4 offset:56320
    s_waitcnt lgkmcnt(5)
    v_mfma_f32_16x16x32_bf16 v[80:83], v[40:43], v[148:151], v[80:83]
    buffer_load_dwordx4 v0, s[8:11], s62 offen offset:2048 sc1 lds
    v_mfma_f32_16x16x32_bf16 v[84:87], v[40:43], v[212:215], v[84:87]
    ds_read_b128 v[32:35], v4 offset:40960
    s_waitcnt lgkmcnt(5)
    v_mfma_f32_16x16x32_bf16 v[88:91], v[44:47], v[148:151], v[88:91]
    buffer_load_dwordx4 v0, s[8:11], s62 offen offset:3072 sc1 lds
    v_mfma_f32_16x16x32_bf16 v[92:95], v[44:47], v[212:215], v[92:95]
    ds_read_b128 v[36:39], v4 offset:57344
    s_waitcnt lgkmcnt(5)
    v_mfma_f32_16x16x32_bf16 v[80:83], v[48:51], v[152:155], v[80:83]
    s_add_u32 s62, s62, 61440
    v_mfma_f32_16x16x32_bf16 v[84:87], v[48:51], v[216:219], v[84:87]
    ds_read_b128 v[40:43], v4 offset:41984
    s_waitcnt lgkmcnt(5)
    v_mfma_f32_16x16x32_bf16 v[88:91], v[52:55], v[152:155], v[88:91]
    v_mfma_f32_16x16x32_bf16 v[92:95], v[52:55], v[216:219], v[92:95]
    ds_read_b128 v[44:47], v4 offset:58368
    s_waitcnt lgkmcnt(5)
    v_mfma_f32_16x16x32_bf16 v[80:83], v[56:59], v[156:159], v[80:83]
    v_mfma_f32_16x16x32_bf16 v[84:87], v[56:59], v[220:223], v[84:87]
    ds_read_b128 v[48:51], v4 offset:43008
    s_waitcnt lgkmcnt(5)
    v_mfma_f32_16x16x32_bf16 v[88:91], v[60:63], v[156:159], v[88:91]
    v_mfma_f32_16x16x32_bf16 v[92:95], v[60:63], v[220:223], v[92:95]
    ds_read_b128 v[52:55], v4 offset:59392
    s_waitcnt lgkmcnt(5)
    v_mfma_f32_16x16x32_bf16 v[80:83], v[32:35], v[160:163], v[80:83]
    v_mfma_f32_16x16x32_bf16 v[84:87], v[32:35], v[224:227], v[84:87]
    ds_read_b128 v[56:59], v4 offset:44032
    s_waitcnt lgkmcnt(5)
    v_mfma_f32_16x16x32_bf16 v[88:91], v[36:39], v[160:163], v[88:91]
    v_mfma_f32_16x16x32_bf16 v[92:95], v[36:39], v[224:227], v[92:95]
    ds_read_b128 v[60:63], v4 offset:60416
    s_waitcnt lgkmcnt(5)
    v_mfma_f32_16x16x32_bf16 v[80:83], v[40:43], v[164:167], v[80:83]
    v_mfma_f32_16x16x32_bf16 v[84:87], v[40:43], v[228:231], v[84:87]
    ds_read_b128 v[32:35], v4 offset:45056
    s_waitcnt lgkmcnt(5)
    v_mfma_f32_16x16x32_bf16 v[88:91], v[44:47], v[164:167], v[88:91]
    v_mfma_f32_16x16x32_bf16 v[92:95], v[44:47], v[228:231], v[92:95]
    ds_read_b128 v[36:39], v4 offset:61440
    s_waitcnt lgkmcnt(5)
    v_mfma_f32_16x16x32_bf16 v[80:83], v[48:51], v[168:171], v[80:83]
    v_mfma_f32_16x16x32_bf16 v[84:87], v[48:51], v[232:235], v[84:87]
    ds_read_b128 v[40:43], v4 offset:46080
    s_waitcnt lgkmcnt(5)
    v_mfma_f32_16x16x32_bf16 v[88:91], v[52:55], v[168:171], v[88:91]
    v_mfma_f32_16x16x32_bf16 v[92:95], v[52:55], v[232:235], v[92:95]
    ds_read_b128 v[44:47], v4 offset:62464
    s_waitcnt lgkmcnt(5)
    v_mfma_f32_16x16x32_bf16 v[80:83], v[56:59], v[172:175], v[80:83]
    v_mfma_f32_16x16x32_bf16 v[84:87], v[56:59], v[236:239], v[84:87]
    ds_read_b128 v[48:51], v4 offset:47104
    s_waitcnt lgkmcnt(5)
    v_mfma_f32_16x16x32_bf16 v[88:91], v[60:63], v[172:175], v[88:91]
    v_mfma_f32_16x16x32_bf16 v[92:95], v[60:63], v[236:239], v[92:95]
    ds_read_b128 v[52:55], v4 offset:63488
    s_waitcnt lgkmcnt(5)
    v_mfma_f32_16x16x32_bf16 v[80:83], v[32:35], v[176:179], v[80:83]
    v_mfma_f32_16x16x32_bf16 v[84:87], v[32:35], v[240:243], v[84:87]
    ds_read_b128 v[56:59], v4 offset:48128
    s_waitcnt lgkmcnt(5)
    v_mfma_f32_16x16x32_bf16 v[88:91], v[36:39], v[176:179], v[88:91]
    v_mfma_f32_16x16x32_bf16 v[92:95], v[36:39], v[240:243], v[92:95]
    ds_read_b128 v[60:63], v4 offset:64512
    s_waitcnt lgkmcnt(5)
    v_mfma_f32_16x16x32_bf16 v[80:83], v[40:43], v[180:183], v[80:83]
    v_mfma_f32_16x16x32_bf16 v[84:87], v[40:43], v[244:247], v[84:87]
    s_waitcnt lgkmcnt(4)
    v_mfma_f32_16x16x32_bf16 v[88:91], v[44:47], v[180:183], v[88:91]
    v_mfma_f32_16x16x32_bf16 v[92:95], v[44:47], v[244:247], v[92:95]
    s_waitcnt lgkmcnt(3)
    v_mfma_f32_16x16x32_bf16 v[80:83], v[48:51], v[184:187], v[80:83]
    v_mfma_f32_16x16x32_bf16 v[84:87], v[48:51], v[248:251], v[84:87]
    s_waitcnt lgkmcnt(2)
    v_mfma_f32_16x16x32_bf16 v[88:91], v[52:55], v[184:187], v[88:91]
    v_mfma_f32_16x16x32_bf16 v[92:95], v[52:55], v[248:251], v[92:95]
    s_waitcnt lgkmcnt(1)
    v_mfma_f32_16x16x32_bf16 v[80:83], v[56:59], v[188:191], v[80:83]
    v_mfma_f32_16x16x32_bf16 v[84:87], v[56:59], v[252:255], v[84:87]
    s_waitcnt lgkmcnt(0)
    v_mfma_f32_16x16x32_bf16 v[88:91], v[60:63], v[188:191], v[88:91]
    v_mfma_f32_16x16x32_bf16 v[92:95], v[60:63], v[252:255], v[92:95]
    s_add_u32 s57, s57, 1
    s_cmp_lt_u32 s57, 8
    s_cbranch_scc1 W_str_v
    s_nop 7
    s_nop 3
    v_cvt_pk_bf16_f32 v96, v80, v81
    v_cvt_pk_bf16_f32 v97, v82, v83
    v_cvt_pk_bf16_f32 v98, v88, v89
    v_cvt_pk_bf16_f32 v99, v90, v91
    buffer_store_dwordx4 v[96:99], v0, s[8:11], s73 offen offset:0 sc1
    v_cvt_pk_bf16_f32 v100, v84, v85
    v_cvt_pk_bf16_f32 v101, v86, v87
    v_cvt_pk_bf16_f32 v102, v92, v93
    v_cvt_pk_bf16_f32 v103, v94, v95
    buffer_store_dwordx4 v[100:103], v0, s[8:11], s73 offen offset:1024 sc1
    s_mov_b32 s73, s76
    s_add_u32 s76, s76, s74
    s_branch W_str_end
W_str_h:
    s_waitcnt vmcnt(18)
    s_barrier
    ds_read_b128 v[32:35], v0 offset:0
    ds_read_b128 v[36:39], v0 offset:16384
    ds_read_b128 v[40:43], v0 offset:1024
    ds_read_b128 v[44:47], v0 offset:17408
    ds_read_b128 v[48:51], v0 offset:2048
    ds_read_b128 v[52:55], v0 offset:18432
    s_waitcnt lgkmcnt(5)
    v_mfma_f32_16x16x32_bf16 v[64:67], v[128:131], v[32:35], 0
    v_mfma_f32_16x16x32_bf16 v[68:71], v[192:195], v[32:35], 0
    ds_read_b128 v[56:59], v0 offset:3072
    s_waitcnt lgkmcnt(5)
    v_mfma_f32_16x16x32_bf16 v[72:75], v[128:131], v[36:39], 0
    s_add_u32 m0, s72, 98304
    v_cvt_pk_bf16_f32 v80, v80, v80
    v_lshlrev_b32 v80, 16, v80
    v_mfma_f32_16x16x32_bf16 v[76:79], v[192:195], v[36:39], 0
    ds_read_b128 v[60:63], v0 offset:19456
    v_mul_f32 v20, 0xbfb8aa3b, v80
    v_exp_f32 v20, v20
    s_waitcnt lgkmcnt(5)
    v_mfma_f32_16x16x32_bf16 v[64:67], v[132:135], v[40:43], v[64:67]
    buffer_load_dwordx4 v0, s[8:11], s62 offen offset:0 sc1 lds
    v_add_f32 v20, 1.0, v20
    v_rcp_f32 v20, v20
    v_mfma_f32_16x16x32_bf16 v[68:71], v[196:199], v[40:43], v[68:71]
    ds_read_b128 v[32:35], v0 offset:4096
    v_mul_f32 v80, v80, v20
    v_cvt_pk_bf16_f32 v81, v81, v81
    s_waitcnt lgkmcnt(5)
    v_mfma_f32_16x16x32_bf16 v[72:75], v[132:135], v[44:47], v[72:75]
    buffer_load_dwordx4 v0, s[8:11], s62 offen offset:1024 sc1 lds
    v_lshlrev_b32 v81, 16, v81
    v_mul_f32 v21, 0xbfb8aa3b, v81
    v_mfma_f32_16x16x32_bf16 v[76:79], v[196:199], v[44:47], v[76:79]
    ds_read_b128 v[36:39], v0 offset:20480
    v_exp_f32 v21, v21
    s_nop 0
    v_add_f32 v21, 1.0, v21
    s_waitcnt lgkmcnt(5)
    v_mfma_f32_16x16x32_bf16 v[64:67], v[136:139], v[48:51], v[64:67]
    buffer_load_dwordx4 v0, s[8:11], s62 offen offset:2048 sc1 lds
    v_rcp_f32 v21, v21
    s_nop 0
    v_mul_f32 v81, v81, v21
    v_mfma_f32_16x16x32_bf16 v[68:71], v[200:203], v[48:51], v[68:71]
    ds_read_b128 v[40:43], v0 offset:5120
    v_cvt_pk_bf16_f32 v82, v82, v82
    v_lshlrev_b32 v82, 16, v82
    s_waitcnt lgkmcnt(5)
    v_mfma_f32_16x16x32_bf16 v[72:75], v[136:139], v[52:55], v[72:75]
    buffer_load_dwordx4 v0, s[8:11], s62 offen offset:3072 sc1 lds
    v_mul_f32 v22, 0xbfb8aa3b, v82
    v_exp_f32 v22, v22
    v_mfma_f32_16x16x32_bf16 v[76:79], v[200:203], v[52:55], v[76:79]
    ds_read_b128 v[44:47], v0 offset:21504
    v_add_f32 v22, 1.0, v22
    v_rcp_f32 v22, v22
    s_waitcnt lgkmcnt(5)
    v_mfma_f32_16x16x32_bf16 v[64:67], v[140:143], v[56:59], v[64:67]
    s_add_u32 s62, s62, 4096
    v_mul_f32 v82, v82, v22
    v_cvt_pk_bf16_f32 v83, v83, v83
    v_mfma_f32_16x16x32_bf16 v[68:71], v[204:207], v[56:59], v[68:71]
    ds_read_b128 v[48:51], v0 offset:6144
    v_lshlrev_b32 v83, 16, v83
    v_mul_f32 v23, 0xbfb8aa3b, v83
    s_waitcnt lgkmcnt(5)
    v_mfma_f32_16x16x32_bf16 v[72:75], v[140:143], v[60:63], v[72:75]
    s_add_u32 m0, s72, 102400
    v_exp_f32 v23, v23
    s_nop 0
    v_add_f32 v23, 1.0, v23
    v_mfma_f32_16x16x32_bf16 v[76:79], v[204:207], v[60:63], v[76:79]
    ds_read_b128 v[52:55], v0 offset:22528
    v_rcp_f32 v23, v23
    s_nop 0
    v_mul_f32 v83, v83, v23
    s_waitcnt lgkmcnt(5)
    v_mfma_f32_16x16x32_bf16 v[64:67], v[144:147], v[32:35], v[64:67]
    buffer_load_dwordx4 v0, s[8:11], s62 offen offset:0 sc1 lds
    v_cvt_pk_bf16_f32 v84, v84, v84
    v_lshlrev_b32 v84, 16, v84
    v_mfma_f32_16x16x32_bf16 v[68:71], v[208:211], v[32:35], v[68:71]
    ds_read_b128 v[56:59], v0 offset:7168
    v_mul_f32 v20, 0xbfb8aa3b, v84
    v_exp_f32 v20, v20
    s_waitcnt lgkmcnt(5)
    v_mfma_f32_16x16x32_bf16 v[72:75], v[144:147], v[36:39], v[72:75]
    buffer_load_dwordx4 v0, s[8:11], s62 offen offset:1024 sc1 lds
    v_add_f32 v20, 1.0, v20
    v_rcp_f32 v20, v20
    v_mfma_f32_16x16x32_bf16 v[76:79], v[208:211], v[36:39], v[76:79]
    ds_read_b128 v[60:63], v0 offset:23552
    v_mul_f32 v84, v84, v20
    v_cvt_pk_bf16_f32 v85, v85, v85
    s_waitcnt lgkmcnt(5)
    v_mfma_f32_16x16x32_bf16 v[64:67], v[148:151], v[40:43], v[64:67]
    buffer_load_dwordx4 v0, s[8:11], s62 offen offset:2048 sc1 lds
    v_lshlrev_b32 v85, 16, v85
    v_mul_f32 v21, 0xbfb8aa3b, v85
    v_mfma_f32_16x16x32_bf16 v[68:71], v[212:215], v[40:43], v[68:71]
    ds_read_b128 v[32:35], v0 offset:8192
    v_exp_f32 v21, v21
    s_nop 0
    v_add_f32 v21, 1.0, v21
    s_waitcnt lgkmcnt(5)
    v_mfma_f32_16x16x32_bf16 v[72:75], v[148:151], v[44:47], v[72:75]
    buffer_load_dwordx4 v0, s[8:11], s62 offen offset:3072 sc1 lds
    v_rcp_f32 v21, v21
    s_nop 0
    v_mul_f32 v85, v85, v21
    v_mfma_f32_16x16x32_bf16 v[76:79], v[212:215], v[44:47], v[76:79]
    ds_read_b128 v[36:39], v0 offset:24576
    v_cvt_pk_bf16_f32 v86, v86, v86
    v_lshlrev_b32 v86, 16, v86
    s_waitcnt lgkmcnt(5)
    v_mfma_f32_16x16x32_bf16 v[64:67], v[152:155], v[48:51], v[64:67]
    s_add_u32 s62, s62, 61440
    v_mul_f32 v22, 0xbfb8aa3b, v86
    v_exp_f32 v22, v22
    v_mfma_f32_16x16x32_bf16 v[68:71], v[216:219], v[48:51], v[68:71]
    ds_read_b128 v[40:43], v0 offset:9216
    v_add_f32 v22, 1.0, v22
    v_rcp_f32 v22, v22
    s_waitcnt lgkmcnt(5)
    v_mfma_f32_16x16x32_bf16 v[72:75], v[152:155], v[52:55], v[72:75]
    v_mul_f32 v86, v86, v22
    v_cvt_pk_bf16_f32 v87, v87, v87
    v_mfma_f32_16x16x32_bf16 v[76:79], v[216:219], v[52:55], v[76:79]
    ds_read_b128 v[44:47], v0 offset:25600
    v_lshlrev_b32 v87, 16, v87
    v_mul_f32 v23, 0xbfb8aa3b, v87
    s_waitcnt lgkmcnt(5)
    v_mfma_f32_16x16x32_bf16 v[64:67], v[156:159], v[56:59], v[64:67]
    v_exp_f32 v23, v23
    s_nop 0
    v_add_f32 v23, 1.0, v23
    v_mfma_f32_16x16x32_bf16 v[68:71], v[220:223], v[56:59], v[68:71]
    ds_read_b128 v[48:51], v0 offset:10240
    v_rcp_f32 v23, v23
    s_nop 0
    v_mul_f32 v87, v87, v23
    s_waitcnt lgkmcnt(5)
    v_mfma_f32_16x16x32_bf16 v[72:75], v[156:159], v[60:63], v[72:75]
    v_cvt_pk_bf16_f32 v96, v80, v81
    v_cvt_pk_bf16_f32 v97, v82, v83
    v_mfma_f32_16x16x32_bf16 v[76:79], v[220:223], v[60:63], v[76:79]
    ds_read_b128 v[52:55], v0 offset:26624
    v_cvt_pk_bf16_f32 v98, v84, v85
    v_cvt_pk_bf16_f32 v99, v86, v87
    s_waitcnt lgkmcnt(5)
    v_mfma_f32_16x16x32_bf16 v[64:67], v[160:163], v[32:35], v[64:67]
    buffer_store_dwordx4 v[96:99], v0, s[8:11], s73 offen offset:0 sc1
    v_cvt_pk_bf16_f32 v88, v88, v88
    v_mfma_f32_16x16x32_bf16 v[68:71], v[224:227], v[32:35], v[68:71]
    ds_read_b128 v[56:59], v0 offset:11264
    v_lshlrev_b32 v88, 16, v88
    v_mul_f32 v20, 0xbfb8aa3b, v88
    s_waitcnt lgkmcnt(5)
    v_mfma_f32_16x16x32_bf16 v[72:75], v[160:163], v[36:39], v[72:75]
    v_exp_f32 v20, v20
    s_nop 0
    v_add_f32 v20, 1.0, v20
    v_mfma_f32_16x16x32_bf16 v[76:79], v[224:227], v[36:39], v[76:79]
    ds_read_b128 v[60:63], v0 offset:27648
    v_rcp_f32 v20, v20
    s_nop 0
    v_mul_f32 v88, v88, v20
    s_waitcnt lgkmcnt(5)
    v_mfma_f32_16x16x32_bf16 v[64:67], v[164:167], v[40:43], v[64:67]
    v_cvt_pk_bf16_f32 v89, v89, v89
    v_lshlrev_b32 v89, 16, v89
    v_mfma_f32_16x16x32_bf16 v[68:71], v[228:231], v[40:43], v[68:71]
    ds_read_b128 v[32:35], v0 offset:12288
    v_mul_f32 v21, 0xbfb8aa3b, v89
    v_exp_f32 v21, v21
    s_waitcnt lgkmcnt(5)
    v_mfma_f32_16x16x32_bf16 v[72:75], v[164:167], v[44:47], v[72:75]
    v_add_f32 v21, 1.0, v21
    v_rcp_f32 v21, v21
    v_mfma_f32_16x16x32_bf16 v[76:79], v[228:231], v[44:47], v[76:79]
    ds_read_b128 v[36:39], v0 offset:28672
    v_mul_f32 v89, v89, v21
    v_cvt_pk_bf16_f32 v90, v90, v90
    s_waitcnt lgkmcnt(5)
    v_mfma_f32_16x16x32_bf16 v[64:67], v[168:171], v[48:51], v[64:67]
    v_lshlrev_b32 v90, 16, v90
    v_mul_f32 v22, 0xbfb8aa3b, v90
    v_mfma_f32_16x16x32_bf16 v[68:71], v[232:235], v[48:51], v[68:71]
    ds_read_b128 v[40:43], v0 offset:13312
    v_exp_f32 v22, v22
    s_nop 0
    v_add_f32 v22, 1.0, v22
    s_waitcnt lgkmcnt(5)
    v_mfma_f32_16x16x32_bf16 v[72:75], v[168:171], v[52:55], v[72:75]
    v_rcp_f32 v22, v22
    s_nop 0
    v_mul_f32 v90, v90, v22
    v_mfma_f32_16x16x32_bf16 v[76:79], v[232:235], v[52:55], v[76:79]
    ds_read_b128 v[44:47], v0 offset:29696
    v_cvt_pk_bf16_f32 v91, v91, v91
    v_lshlrev_b32 v91, 16, v91
    s_waitcnt lgkmcnt(5)
    v_mfma_f32_16x16x32_bf16 v[64:67], v[172:175], v[56:59], v[64:67]
    v_mul_f32 v23, 0xbfb8aa3b, v91
    v_exp_f32 v23, v23
    v_mfma_f32_16x16x32_bf16 v[68:71], v[236:239], v[56:59], v[68:71]
    ds_read_b128 v[48:51], v0 offset:14336
    v_add_f32 v23, 1.0, v23
    v_rcp_f32 v23, v23
    s_waitcnt lgkmcnt(5)
    v_mfma_f32_16x16x32_bf16 v[72:75], v[172:175], v[60:63], v[72:75]
    v_mul_f32 v91, v91, v23
    v_cvt_pk_bf16_f32 v92, v92, v92
    v_mfma_f32_16x16x32_bf16 v[76:79], v[236:239], v[60:63], v[76:79]
    ds_read_b128 v[52:55], v0 offset:30720
    v_lshlrev_b32 v92, 16, v92
    v_mul_f32 v20, 0xbfb8aa3b, v92
    s_waitcnt lgkmcnt(5)
    v_mfma_f32_16x16x32_bf16 v[64:67], v[176:179], v[32:35], v[64:67]
    v_exp_f32 v20, v20
    s_nop 0
    v_add_f32 v20, 1.0, v20
    v_mfma_f32_16x16x32_bf16 v[68:71], v[240:243], v[32:35], v[68:71]
    ds_read_b128 v[56:59], v0 offset:15360
    v_rcp_f32 v20, v20
    s_nop 0
    v_mul_f32 v92, v92, v20
    s_waitcnt lgkmcnt(5)
    v_mfma_f32_16x16x32_bf16 v[72:75], v[176:179], v[36:39], v[72:75]
    v_cvt_pk_bf16_f32 v93, v93, v93
    v_lshlrev_b32 v93, 16, v93
    v_mfma_f32_16x16x32_bf16 v[76:79], v[240:243], v[36:39], v[76:79]
    ds_read_b128 v[60:63], v0 offset:31744
    v_mul_f32 v21, 0xbfb8aa3b, v93
    v_exp_f32 v21, v21
    s_waitcnt lgkmcnt(5)
    v_mfma_f32_16x16x32_bf16 v[64:67], v[180:183], v[40:43], v[64:67]
    v_add_f32 v21, 1.0, v21
    v_rcp_f32 v21, v21
    v_mfma_f32_16x16x32_bf16 v[68:71], v[244:247], v[40:43], v[68:71]
    v_mul_f32 v93, v93, v21
    v_cvt_pk_bf16_f32 v94, v94, v94
    s_waitcnt lgkmcnt(4)
    v_mfma_f32_16x16x32_bf16 v[72:75], v[180:183], v[44:47], v[72:75]
    v_lshlrev_b32 v94, 16, v94
    v_mul_f32 v22, 0xbfb8aa3b, v94
    v_mfma_f32_16x16x32_bf16 v[76:79], v[244:247], v[44:47], v[76:79]
    v_exp_f32 v22, v22
    s_nop 0
    v_add_f32 v22, 1.0, v22
    s_waitcnt lgkmcnt(3)
    v_mfma_f32_16x16x32_bf16 v[64:67], v[184:187], v[48:51], v[64:67]
    v_rcp_f32 v22, v22
    s_nop 0
    v_mul_f32 v94, v94, v22
    v_mfma_f32_16x16x32_bf16 v[68:71], v[248:251], v[48:51], v[68:71]
    v_cvt_pk_bf16_f32 v95, v95, v95
    v_lshlrev_b32 v95, 16, v95
    s_waitcnt lgkmcnt(2)
    v_mfma_f32_16x16x32_bf16 v[72:75], v[184:187], v[52:55], v[72:75]
    v_mul_f32 v23, 0xbfb8aa3b, v95
    v_exp_f32 v23, v23
    v_mfma_f32_16x16x32_bf16 v[76:79], v[248:251], v[52:55], v[76:79]
    v_add_f32 v23, 1.0, v23
    v_rcp_f32 v23, v23
    s_waitcnt lgkmcnt(1)
    v_mfma_f32_16x16x32_bf16 v[64:67], v[188:191], v[56:59], v[64:67]
    v_mul_f32 v95, v95, v23
    v_cvt_pk_bf16_f32 v100, v88, v89
    v_mfma_f32_16x16x32_bf16 v[68:71], v[252:255], v[56:59], v[68:71]
    v_cvt_pk_bf16_f32 v101, v90, v91
    v_cvt_pk_bf16_f32 v102, v92, v93
    s_waitcnt lgkmcnt(0)
    v_mfma_f32_16x16x32_bf16 v[72:75], v[188:191], v[60:63], v[72:75]
    v_cvt_pk_bf16_f32 v103, v94, v95
    buffer_store_dwordx4 v[100:103], v0, s[8:11], s73 offen offset:1024 sc1
    v_mfma_f32_16x16x32_bf16 v[76:79], v[252:255], v[60:63], v[76:79]
    s_mov_b32 s73, s76
    s_add_u32 s76, s76, s74
    s_waitcnt vmcnt(18)
    s_barrier
    ds_read_b128 v[32:35], v0 offset:32768
    ds_read_b128 v[36:39], v0 offset:49152
    ds_read_b128 v[40:43], v0 offset:33792
    ds_read_b128 v[44:47], v0 offset:50176
    ds_read_b128 v[48:51], v0 offset:34816
    ds_read_b128 v[52:55], v0 offset:51200
    s_waitcnt lgkmcnt(5)
    v_mfma_f32_16x16x32_bf16 v[80:83], v[128:131], v[32:35], 0
    v_mfma_f32_16x16x32_bf16 v[84:87], v[192:195], v[32:35], 0
    ds_read_b128 v[56:59], v0 offset:35840
    s_waitcnt lgkmcnt(5)
    v_mfma_f32_16x16x32_bf16 v[88:91], v[128:131], v[36:39], 0
    s_add_u32 m0, s72, 0
    v_cvt_pk_bf16_f32 v64, v64, v64
    v_lshlrev_b32 v64, 16, v64
    v_mfma_f32_16x16x32_bf16 v[92:95], v[192:195], v[36:39], 0
    ds_read_b128 v[60:63], v0 offset:52224
    v_mul_f32 v20, 0xbfb8aa3b, v64
    v_exp_f32 v20, v20
    s_waitcnt lgkmcnt(5)
    v_mfma_f32_16x16x32_bf16 v[80:83], v[132:135], v[40:43], v[80:83]
    buffer_load_dwordx4 v0, s[8:11], s62 offen offset:0 sc1 lds
    v_add_f32 v20, 1.0, v20
    v_rcp_f32 v20, v20
    v_mfma_f32_16x16x32_bf16 v[84:87], v[196:199], v[40:43], v[84:87]
    ds_read_b128 v[32:35], v0 offset:36864
    v_mul_f32 v64, v64, v20
    v_cvt_pk_bf16_f32 v65, v65, v65
    s_waitcnt lgkmcnt(5)
    v_mfma_f32_16x16x32_bf16 v[88:91], v[132:135], v[44:47], v[88:91]
    buffer_load_dwordx4 v0, s[8:11], s62 offen offset:1024 sc1 lds
    v_lshlrev_b32 v65, 16, v65
    v_mul_f32 v21, 0xbfb8aa3b, v65
    v_mfma_f32_16x16x32_bf16 v[92:95], v[196:199], v[44:47], v[92:95]
    ds_read_b128 v[36:39], v0 offset:53248
    v_exp_f32 v21, v21
    s_nop 0
    v_add_f32 v21, 1.0, v21
    s_waitcnt lgkmcnt(5)
    v_mfma_f32_16x16x32_bf16 v[80:83], v[136:139], v[48:51], v[80:83]
    buffer_load_dwordx4 v0, s[8:11], s62 offen offset:2048 sc1 lds
    v_rcp_f32 v21, v21
    s_nop 0
    v_mul_f32 v65, v65, v21
    v_mfma_f32_16x16x32_bf16 v[84:87], v[200:203], v[48:51], v[84:87]
    ds_read_b128 v[40:43], v0 offset:37888
    v_cvt_pk_bf16_f32 v66, v66, v66
    v_lshlrev_b32 v66, 16, v66
    s_waitcnt lgkmcnt(5)
    v_mfma_f32_16x16x32_bf16 v[88:91], v[136:139], v[52:55], v[88:91]
    buffer_load_dwordx4 v0, s[8:11], s62 offen offset:3072 sc1 lds
    v_mul_f32 v22, 0xbfb8aa3b, v66
    v_exp_f32 v22, v22
    v_mfma_f32_16x16x32_bf16 v[92:95], v[200:203], v[52:55], v[92:95]
    ds_read_b128 v[44:47], v0 offset:54272
    v_add_f32 v22, 1.0, v22
    v_rcp_f32 v22, v22
    s_waitcnt lgkmcnt(5)
    v_mfma_f32_16x16x32_bf16 v[80:83], v[140:143], v[56:59], v[80:83]
    s_add_u32 s62, s62, 4096
    v_mul_f32 v66, v66, v22
    v_cvt_pk_bf16_f32 v67, v67, v67
    v_mfma_f32_16x16x32_bf16 v[84:87], v[204:207], v[56:59], v[84:87]
    ds_read_b128 v[48:51], v0 offset:38912
    v_lshlrev_b32 v67, 16, v67
    v_mul_f32 v23, 0xbfb8aa3b, v67
    s_waitcnt lgkmcnt(5)
    v_mfma_f32_16x16x32_bf16 v[88:91], v[140:143], v[60:63], v[88:91]
    s_add_u32 m0, s72, 4096
    v_exp_f32 v23, v23
    s_nop 0
    v_add_f32 v23, 1.0, v23
    v_mfma_f32_16x16x32_bf16 v[92:95], v[204:207], v[60:63], v[92:95]
    ds_read_b128 v[52:55], v0 offset:55296
    v_rcp_f32 v23, v23
    s_nop 0
    v_mul_f32 v67, v67, v23
    s_waitcnt lgkmcnt(5)
    v_mfma_f32_16x16x32_bf16 v[80:83], v[144:147], v[32:35], v[80:83]
    buffer_load_dwordx4 v0, s[8:11], s62 offen offset:0 sc1 lds
    v_cvt_pk_bf16_f32 v68, v68, v68
    v_lshlrev_b32 v68, 16, v68
    v_mfma_f32_16x16x32_bf16 v[84:87], v[208:211], v[32:35], v[84:87]
    ds_read_b128 v[56:59], v0 offset:39936
    v_mul_f32 v20, 0xbfb8aa3b, v68
    v_exp_f32 v20, v20
    s_waitcnt lgkmcnt(5)
    v_mfma_f32_16x16x32_bf16 v[88:91], v[144:147], v[36:39], v[88:91]
    buffer_load_dwordx4 v0, s[8:11], s62 offen offset:1024 sc1 lds
    v_add_f32 v20, 1.0, v20
    v_rcp_f32 v20, v20
    v_mfma_f32_16x16x32_bf16 v[92:95], v[208:211], v[36:39], v[92:95]
    ds_read_b128 v[60:63], v0 offset:56320
    v_mul_f32 v68, v68, v20
    v_cvt_pk_bf16_f32 v69, v69, v69
    s_waitcnt lgkmcnt(5)
    v_mfma_f32_16x16x32_bf16 v[80:83], v[148:151], v[40:43], v[80:83]
    buffer_load_dwordx4 v0, s[8:11], s62 offen offset:2048 sc1 lds
    v_lshlrev_b32 v69, 16, v69
    v_mul_f32 v21, 0xbfb8aa3b, v69
    v_mfma_f32_16x16x32_bf16 v[84:87], v[212:215], v[40:43], v[84:87]
    ds_read_b128 v[32:35], v0 offset:40960
    v_exp_f32 v21, v21
    s_nop 0
    v_add_f32 v21, 1.0, v21
    s_waitcnt lgkmcnt(5)
    v_mfma_f32_16x16x32_bf16 v[88:91], v[148:151], v[44:47], v[88:91]
    buffer_load_dwordx4 v0, s[8:11], s62 offen offset:3072 sc1 lds
    v_rcp_f32 v21, v21
    s_nop 0
    v_mul_f32 v69, v69, v21
    v_mfma_f32_16x16x32_bf16 v[92:95], v[212:215], v[44:47], v[92:95]
    ds_read_b128 v[36:39], v0 offset:57344
    v_cvt_pk_bf16_f32 v70, v70, v70
    v_lshlrev_b32 v70, 16, v70
    s_waitcnt lgkmcnt(5)
    v_mfma_f32_16x16x32_bf16 v[80:83], v[152:155], v[48:51], v[80:83]
    s_add_u32 s62, s62, 61440
    v_mul_f32 v22, 0xbfb8aa3b, v70
    v_exp_f32 v22, v22
    v_mfma_f32_16x16x32_bf16 v[84:87], v[216:219], v[48:51], v[84:87]
    ds_read_b128 v[40:43], v0 offset:41984
    v_add_f32 v22, 1.0, v22
    v_rcp_f32 v22, v22
    s_waitcnt lgkmcnt(5)
    v_mfma_f32_16x16x32_bf16 v[88:91], v[152:155], v[52:55], v[88:91]
    v_mul_f32 v70, v70, v22
    v_cvt_pk_bf16_f32 v71, v71, v71
    v_mfma_f32_16x16x32_bf16 v[92:95], v[216:219], v[52:55], v[92:95]
    ds_read_b128 v[44:47], v0 offset:58368
    v_lshlrev_b32 v71, 16, v71
    v_mul_f32 v23, 0xbfb8aa3b, v71
    s_waitcnt lgkmcnt(5)
    v_mfma_f32_16x16x32_bf16 v[80:83], v[156:159], v[56:59], v[80:83]
    v_exp_f32 v23, v23
    s_nop 0
    v_add_f32 v23, 1.0, v23
    v_mfma_f32_16x16x32_bf16 v[84:87], v[220:223], v[56:59], v[84:87]
    ds_read_b128 v[48:51], v0 offset:43008
    v_rcp_f32 v23, v23
    s_nop 0
    v_mul_f32 v71, v71, v23
    s_waitcnt lgkmcnt(5)
    v_mfma_f32_16x16x32_bf16 v[88:91], v[156:159], v[60:63], v[88:91]
    v_cvt_pk_bf16_f32 v96, v64, v65
    v_cvt_pk_bf16_f32 v97, v66, v67
    v_mfma_f32_16x16x32_bf16 v[92:95], v[220:223], v[60:63], v[92:95]
    ds_read_b128 v[52:55], v0 offset:59392
    v_cvt_pk_bf16_f32 v98, v68, v69
    v_cvt_pk_bf16_f32 v99, v70, v71
    s_waitcnt lgkmcnt(5)
    v_mfma_f32_16x16x32_bf16 v[80:83], v[160:163], v[32:35], v[80:83]
    buffer_store_dwordx4 v[96:99], v0, s[8:11], s73 offen offset:0 sc1
    v_cvt_pk_bf16_f32 v72, v72, v72
    v_mfma_f32_16x16x32_bf16 v[84:87], v[224:227], v[32:35], v[84:87]
    ds_read_b128 v[56:59], v0 offset:44032
    v_lshlrev_b32 v72, 16, v72
    v_mul_f32 v20, 0xbfb8aa3b, v72
    s_waitcnt lgkmcnt(5)
    v_mfma_f32_16x16x32_bf16 v[88:91], v[160:163], v[36:39], v[88:91]
    v_exp_f32 v20, v20
    s_nop 0
    v_add_f32 v20, 1.0, v20
    v_mfma_f32_16x16x32_bf16 v[92:95], v[224:227], v[36:39], v[92:95]
    ds_read_b128 v[60:63], v0 offset:60416
    v_rcp_f32 v20, v20
    s_nop 0
    v_mul_f32 v72, v72, v20
    s_waitcnt lgkmcnt(5)
    v_mfma_f32_16x16x32_bf16 v[80:83], v[164:167], v[40:43], v[80:83]
    v_cvt_pk_bf16_f32 v73, v73, v73
    v_lshlrev_b32 v73, 16, v73
    v_mfma_f32_16x16x32_bf16 v[84:87], v[228:231], v[40:43], v[84:87]
    ds_read_b128 v[32:35], v0 offset:45056
    v_mul_f32 v21, 0xbfb8aa3b, v73
    v_exp_f32 v21, v21
    s_waitcnt lgkmcnt(5)
    v_mfma_f32_16x16x32_bf16 v[88:91], v[164:167], v[44:47], v[88:91]
    v_add_f32 v21, 1.0, v21
    v_rcp_f32 v21, v21
    v_mfma_f32_16x16x32_bf16 v[92:95], v[228:231], v[44:47], v[92:95]
    ds_read_b128 v[36:39], v0 offset:61440
    v_mul_f32 v73, v73, v21
    v_cvt_pk_bf16_f32 v74, v74, v74
    s_waitcnt lgkmcnt(5)
    v_mfma_f32_16x16x32_bf16 v[80:83], v[168:171], v[48:51], v[80:83]
    v_lshlrev_b32 v74, 16, v74
    v_mul_f32 v22, 0xbfb8aa3b, v74
    v_mfma_f32_16x16x32_bf16 v[84:87], v[232:235], v[48:51], v[84:87]
    ds_read_b128 v[40:43], v0 offset:46080
    v_exp_f32 v22, v22
    s_nop 0
    v_add_f32 v22, 1.0, v22
    s_waitcnt lgkmcnt(5)
    v_mfma_f32_16x16x32_bf16 v[88:91], v[168:171], v[52:55], v[88:91]
    v_rcp_f32 v22, v22
    s_nop 0
    v_mul_f32 v74, v74, v22
    v_mfma_f32_16x16x32_bf16 v[92:95], v[232:235], v[52:55], v[92:95]
    ds_read_b128 v[44:47], v0 offset:62464
    v_cvt_pk_bf16_f32 v75, v75, v75
    v_lshlrev_b32 v75, 16, v75
    s_waitcnt lgkmcnt(5)
    v_mfma_f32_16x16x32_bf16 v[80:83], v[172:175], v[56:59], v[80:83]
    v_mul_f32 v23, 0xbfb8aa3b, v75
    v_exp_f32 v23, v23
    v_mfma_f32_16x16x32_bf16 v[84:87], v[236:239], v[56:59], v[84:87]
    ds_read_b128 v[48:51], v0 offset:47104
    v_add_f32 v23, 1.0, v23
    v_rcp_f32 v23, v23
    s_waitcnt lgkmcnt(5)
    v_mfma_f32_16x16x32_bf16 v[88:91], v[172:175], v[60:63], v[88:91]
    v_mul_f32 v75, v75, v23
    v_cvt_pk_bf16_f32 v76, v76, v76
    v_mfma_f32_16x16x32_bf16 v[92:95], v[236:239], v[60:63], v[92:95]
    ds_read_b128 v[52:55], v0 offset:63488
    v_lshlrev_b32 v76, 16, v76
    v_mul_f32 v20, 0xbfb8aa3b, v76
    s_waitcnt lgkmcnt(5)
    v_mfma_f32_16x16x32_bf16 v[80:83], v[176:179], v[32:35], v[80:83]
    v_exp_f32 v20, v20
    s_nop 0
    v_add_f32 v20, 1.0, v20
    v_mfma_f32_16x16x32_bf16 v[84:87], v[240:243], v[32:35], v[84:87]
    ds_read_b128 v[56:59], v0 offset:48128
    v_rcp_f32 v20, v20
    s_nop 0
    v_mul_f32 v76, v76, v20
    s_waitcnt lgkmcnt(5)
    v_mfma_f32_16x16x32_bf16 v[88:91], v[176:179], v[36:39], v[88:91]
    v_cvt_pk_bf16_f32 v77, v77, v77
    v_lshlrev_b32 v77, 16, v77
    v_mfma_f32_16x16x32_bf16 v[92:95], v[240:243], v[36:39], v[92:95]
    ds_read_b128 v[60:63], v0 offset:64512
    v_mul_f32 v21, 0xbfb8aa3b, v77
    v_exp_f32 v21, v21
    s_waitcnt lgkmcnt(5)
    v_mfma_f32_16x16x32_bf16 v[80:83], v[180:183], v[40:43], v[80:83]
    v_add_f32 v21, 1.0, v21
    v_rcp_f32 v21, v21
    v_mfma_f32_16x16x32_bf16 v[84:87], v[244:247], v[40:43], v[84:87]
    v_mul_f32 v77, v77, v21
    v_cvt_pk_bf16_f32 v78, v78, v78
    s_waitcnt lgkmcnt(4)
    v_mfma_f32_16x16x32_bf16 v[88:91], v[180:183], v[44:47], v[88:91]
    v_lshlrev_b32 v78, 16, v78
    v_mul_f32 v22, 0xbfb8aa3b, v78
    v_mfma_f32_16x16x32_bf16 v[92:95], v[244:247], v[44:47], v[92:95]
    v_exp_f32 v22, v22
    s_nop 0
    v_add_f32 v22, 1.0, v22
    s_waitcnt lgkmcnt(3)
    v_mfma_f32_16x16x32_bf16 v[80:83], v[184:187], v[48:51], v[80:83]
    v_rcp_f32 v22, v22
    s_nop 0
    v_mul_f32 v78, v78, v22
    v_mfma_f32_16x16x32_bf16 v[84:87], v[248:251], v[48:51], v[84:87]
    v_cvt_pk_bf16_f32 v79, v79, v79
    v_lshlrev_b32 v79, 16, v79
    s_waitcnt lgkmcnt(2)
    v_mfma_f32_16x16x32_bf16 v[88:91], v[184:187], v[52:55], v[88:91]
    v_mul_f32 v23, 0xbfb8aa3b, v79
    v_exp_f32 v23, v23
    v_mfma_f32_16x16x32_bf16 v[92:95], v[248:251], v[52:55], v[92:95]
    v_add_f32 v23, 1.0, v23
    v_rcp_f32 v23, v23
    s_waitcnt lgkmcnt(1)
    v_mfma_f32_16x16x32_bf16 v[80:83], v[188:191], v[56:59], v[80:83]
    v_mul_f32 v79, v79, v23
    v_cvt_pk_bf16_f32 v100, v72, v73
    v_mfma_f32_16x16x32_bf16 v[84:87], v[252:255], v[56:59], v[84:87]
    v_cvt_pk_bf16_f32 v101, v74, v75
    v_cvt_pk_bf16_f32 v102, v76, v77
    s_waitcnt lgkmcnt(0)
    v_mfma_f32_16x16x32_bf16 v[88:91], v[188:191], v[60:63], v[88:91]
    v_cvt_pk_bf16_f32 v103, v78, v79
    buffer_store_dwordx4 v[100:103], v0, s[8:11], s73 offen offset:1024 sc1
    v_mfma_f32_16x16x32_bf16 v[92:95], v[252:255], v[60:63], v[92:95]
    s_mov_b32 s73, s76
    s_add_u32 s76, s76, s74
    s_waitcnt vmcnt(10)
    s_barrier
    s_cmp_lg_u32 s54, 0
    s_cbranch_scc1 W_nosig_72
    s_cmp_eq_u32 s57, 0
    s_cbranch_scc1 W_nosig_72
    s_mov_b64 exec, 1
    s_lshl_b32 s58, s57, 2
    s_add_u32 s58, s58, 124
    s_cmp_lt_u32 s55, 64
    s_cselect_b32 s59, 0x10001, 1
    v_mov_b32 v10, s59
    buffer_atomic_add v10, v1, s[12:15], s58 offen
    s_mov_b64 exec, -1
    s_nop 3
W_nosig_72:
    ds_read_b128 v[32:35], v4 offset:0
    ds_read_b128 v[36:39], v4 offset:16384
    ds_read_b128 v[40:43], v4 offset:1024
    ds_read_b128 v[44:47], v4 offset:17408
    ds_read_b128 v[48:51], v4 offset:2048
    ds_read_b128 v[52:55], v4 offset:18432
    s_waitcnt lgkmcnt(5)
    v_mfma_f32_16x16x32_bf16 v[64:67], v[128:131], v[32:35], 0
    v_mfma_f32_16x16x32_bf16 v[68:71], v[192:195], v[32:35], 0
    ds_read_b128 v[56:59], v4 offset:3072
    s_waitcnt lgkmcnt(5)
    v_mfma_f32_16x16x32_bf16 v[72:75], v[128:131], v[36:39], 0
    s_add_u32 m0, s72, 32768
    v_cvt_pk_bf16_f32 v80, v80, v80
    v_lshlrev_b32 v80, 16, v80
    v_mfma_f32_16x16x32_bf16 v[76:79], v[192:195], v[36:39], 0
    ds_read_b128 v[60:63], v4 offset:19456
    v_mul_f32 v20, 0xbfb8aa3b, v80
    v_exp_f32 v20, v20
    s_waitcnt lgkmcnt(5)
    v_mfma_f32_16x16x32_bf16 v[64:67], v[132:135], v[40:43], v[64:67]
    buffer_load_dwordx4 v0, s[8:11], s62 offen offset:0 sc1 lds
    v_add_f32 v20, 1.0, v20
    v_rcp_f32 v20, v20
    v_mfma_f32_16x16x32_bf16 v[68:71], v[196:199], v[40:43], v[68:71]
    ds_read_b128 v[32:35], v4 offset:4096
    v_mul_f32 v80, v80, v20
    v_cvt_pk_bf16_f32 v81, v81, v81
    s_waitcnt lgkmcnt(5)
    v_mfma_f32_16x16x32_bf16 v[72:75], v[132:135], v[44:47], v[72:75]
    buffer_load_dwordx4 v0, s[8:11], s62 offen offset:1024 sc1 lds
    v_lshlrev_b32 v81, 16, v81
    v_mul_f32 v21, 0xbfb8aa3b, v81
    v_mfma_f32_16x16x32_bf16 v[76:79], v[196:199], v[44:47], v[76:79]
    ds_read_b128 v[36:39], v4 offset:20480
    v_exp_f32 v21, v21
    s_nop 0
    v_add_f32 v21, 1.0, v21
    s_waitcnt lgkmcnt(5)
    v_mfma_f32_16x16x32_bf16 v[64:67], v[136:139], v[48:51], v[64:67]
    buffer_load_dwordx4 v0, s[8:11], s62 offen offset:2048 sc1 lds
    v_rcp_f32 v21, v21
    s_nop 0
    v_mul_f32 v81, v81, v21
    v_mfma_f32_16x16x32_bf16 v[68:71], v[200:203], v[48:51], v[68:71]
    ds_read_b128 v[40:43], v4 offset:5120
    v_cvt_pk_bf16_f32 v82, v82, v82
    v_lshlrev_b32 v82, 16, v82
    s_waitcnt lgkmcnt(5)
    v_mfma_f32_16x16x32_bf16 v[72:75], v[136:139], v[52:55], v[72:75]
    buffer_load_dwordx4 v0, s[8:11], s62 offen offset:3072 sc1 lds
    v_mul_f32 v22, 0xbfb8aa3b, v82
    v_exp_f32 v22, v22
    v_mfma_f32_16x16x32_bf16 v[76:79], v[200:203], v[52:55], v[76:79]
    ds_read_b128 v[44:47], v4 offset:21504
    v_add_f32 v22, 1.0, v22
    v_rcp_f32 v22, v22
    s_waitcnt lgkmcnt(5)
    v_mfma_f32_16x16x32_bf16 v[64:67], v[140:143], v[56:59], v[64:67]
    s_add_u32 s62, s62, 4096
    v_mul_f32 v82, v82, v22
    v_cvt_pk_bf16_f32 v83, v83, v83
    v_mfma_f32_16x16x32_bf16 v[68:71], v[204:207], v[56:59], v[68:71]
    ds_read_b128 v[48:51], v4 offset:6144
    v_lshlrev_b32 v83, 16, v83
    v_mul_f32 v23, 0xbfb8aa3b, v83
    s_waitcnt lgkmcnt(5)
    v_mfma_f32_16x16x32_bf16 v[72:75], v[140:143], v[60:63], v[72:75]
    s_add_u32 m0, s72, 36864
    v_exp_f32 v23, v23
    s_nop 0
    v_add_f32 v23, 1.0, v23
    v_mfma_f32_16x16x32_bf16 v[76:79], v[204:207], v[60:63], v[76:79]
    ds_read_b128 v[52:55], v4 offset:22528
    v_rcp_f32 v23, v23
    s_nop 0
    v_mul_f32 v83, v83, v23
    s_waitcnt lgkmcnt(5)
    v_mfma_f32_16x16x32_bf16 v[64:67], v[144:147], v[32:35], v[64:67]
    buffer_load_dwordx4 v0, s[8:11], s62 offen offset:0 sc1 lds
    v_cvt_pk_bf16_f32 v84, v84, v84
    v_lshlrev_b32 v84, 16, v84
    v_mfma_f32_16x16x32_bf16 v[68:71], v[208:211], v[32:35], v[68:71]
    ds_read_b128 v[56:59], v4 offset:7168
    v_mul_f32 v20, 0xbfb8aa3b, v84
    v_exp_f32 v20, v20
    s_waitcnt lgkmcnt(5)
    v_mfma_f32_16x16x32_bf16 v[72:75], v[144:147], v[36:39], v[72:75]
    buffer_load_dwordx4 v0, s[8:11], s62 offen offset:1024 sc1 lds
    v_add_f32 v20, 1.0, v20
    v_rcp_f32 v20, v20
    v_mfma_f32_16x16x32_bf16 v[76:79], v[208:211], v[36:39], v[76:79]
    ds_read_b128 v[60:63], v4 offset:23552
    v_mul_f32 v84, v84, v20
    v_cvt_pk_bf16_f32 v85, v85, v85
    s_waitcnt lgkmcnt(5)
    v_mfma_f32_16x16x32_bf16 v[64:67], v[148:151], v[40:43], v[64:67]
    buffer_load_dwordx4 v0, s[8:11], s62 offen offset:2048 sc1 lds
    v_lshlrev_b32 v85, 16, v85
    v_mul_f32 v21, 0xbfb8aa3b, v85
    v_mfma_f32_16x16x32_bf16 v[68:71], v[212:215], v[40:43], v[68:71]
    ds_read_b128 v[32:35], v4 offset:8192
    v_exp_f32 v21, v21
    s_nop 0
    v_add_f32 v21, 1.0, v21
    s_waitcnt lgkmcnt(5)
    v_mfma_f32_16x16x32_bf16 v[72:75], v[148:151], v[44:47], v[72:75]
    buffer_load_dwordx4 v0, s[8:11], s62 offen offset:3072 sc1 lds
    v_rcp_f32 v21, v21
    s_nop 0
    v_mul_f32 v85, v85, v21
    v_mfma_f32_16x16x32_bf16 v[76:79], v[212:215], v[44:47], v[76:79]
    ds_read_b128 v[36:39], v4 offset:24576
    v_cvt_pk_bf16_f32 v86, v86, v86
    v_lshlrev_b32 v86, 16, v86
    s_waitcnt lgkmcnt(5)
    v_mfma_f32_16x16x32_bf16 v[64:67], v[152:155], v[48:51], v[64:67]
    s_add_u32 s62, s62, 61440
    v_mul_f32 v22, 0xbfb8aa3b, v86
    v_exp_f32 v22, v22
    v_mfma_f32_16x16x32_bf16 v[68:71], v[216:219], v[48:51], v[68:71]
    ds_read_b128 v[40:43], v4 offset:9216
    v_add_f32 v22, 1.0, v22
    v_rcp_f32 v22, v22
    s_waitcnt lgkmcnt(5)
    v_mfma_f32_16x16x32_bf16 v[72:75], v[152:155], v[52:55], v[72:75]
    v_mul_f32 v86, v86, v22
    v_cvt_pk_bf16_f32 v87, v87, v87
    v_mfma_f32_16x16x32_bf16 v[76:79], v[216:219], v[52:55], v[76:79]
    ds_read_b128 v[44:47], v4 offset:25600
    v_lshlrev_b32 v87, 16, v87
    v_mul_f32 v23, 0xbfb8aa3b, v87
    s_waitcnt lgkmcnt(5)
    v_mfma_f32_16x16x32_bf16 v[64:67], v[156:159], v[56:59], v[64:67]
    v_exp_f32 v23, v23
    s_nop 0
    v_add_f32 v23, 1.0, v23
    v_mfma_f32_16x16x32_bf16 v[68:71], v[220:223], v[56:59], v[68:71]
    ds_read_b128 v[48:51], v4 offset:10240
    v_rcp_f32 v23, v23
    s_nop 0
    v_mul_f32 v87, v87, v23
    s_waitcnt lgkmcnt(5)
    v_mfma_f32_16x16x32_bf16 v[72:75], v[156:159], v[60:63], v[72:75]
    v_cvt_pk_bf16_f32 v96, v80, v81
    v_cvt_pk_bf16_f32 v97, v82, v83
    v_mfma_f32_16x16x32_bf16 v[76:79], v[220:223], v[60:63], v[76:79]
    ds_read_b128 v[52:55], v4 offset:26624
    v_cvt_pk_bf16_f32 v98, v84, v85
    v_cvt_pk_bf16_f32 v99, v86, v87
    s_waitcnt lgkmcnt(5)
    v_mfma_f32_16x16x32_bf16 v[64:67], v[160:163], v[32:35], v[64:67]
    buffer_store_dwordx4 v[96:99], v0, s[8:11], s73 offen offset:0 sc1
    v_cvt_pk_bf16_f32 v88, v88, v88
    v_mfma_f32_16x16x32_bf16 v[68:71], v[224:227], v[32:35], v[68:71]
    ds_read_b128 v[56:59], v4 offset:11264
    v_lshlrev_b32 v88, 16, v88
    v_mul_f32 v20, 0xbfb8aa3b, v88
    s_waitcnt lgkmcnt(5)
    v_mfma_f32_16x16x32_bf16 v[72:75], v[160:163], v[36:39], v[72:75]
    v_exp_f32 v20, v20
    s_nop 0
    v_add_f32 v20, 1.0, v20
    v_mfma_f32_16x16x32_bf16 v[76:79], v[224:227], v[36:39], v[76:79]
    ds_read_b128 v[60:63], v4 offset:27648
    v_rcp_f32 v20, v20
    s_nop 0
    v_mul_f32 v88, v88, v20
    s_waitcnt lgkmcnt(5)
    v_mfma_f32_16x16x32_bf16 v[64:67], v[164:167], v[40:43], v[64:67]
    v_cvt_pk_bf16_f32 v89, v89, v89
    v_lshlrev_b32 v89, 16, v89
    v_mfma_f32_16x16x32_bf16 v[68:71], v[228:231], v[40:43], v[68:71]
    ds_read_b128 v[32:35], v4 offset:12288
    v_mul_f32 v21, 0xbfb8aa3b, v89
    v_exp_f32 v21, v21
    s_waitcnt lgkmcnt(5)
    v_mfma_f32_16x16x32_bf16 v[72:75], v[164:167], v[44:47], v[72:75]
    v_add_f32 v21, 1.0, v21
    v_rcp_f32 v21, v21
    v_mfma_f32_16x16x32_bf16 v[76:79], v[228:231], v[44:47], v[76:79]
    ds_read_b128 v[36:39], v4 offset:28672
    v_mul_f32 v89, v89, v21
    v_cvt_pk_bf16_f32 v90, v90, v90
    s_waitcnt lgkmcnt(5)
    v_mfma_f32_16x16x32_bf16 v[64:67], v[168:171], v[48:51], v[64:67]
    v_lshlrev_b32 v90, 16, v90
    v_mul_f32 v22, 0xbfb8aa3b, v90
    v_mfma_f32_16x16x32_bf16 v[68:71], v[232:235], v[48:51], v[68:71]
    ds_read_b128 v[40:43], v4 offset:13312
    v_exp_f32 v22, v22
    s_nop 0
    v_add_f32 v22, 1.0, v22
    s_waitcnt lgkmcnt(5)
    v_mfma_f32_16x16x32_bf16 v[72:75], v[168:171], v[52:55], v[72:75]
    v_rcp_f32 v22, v22
    s_nop 0
    v_mul_f32 v90, v90, v22
    v_mfma_f32_16x16x32_bf16 v[76:79], v[232:235], v[52:55], v[76:79]
    ds_read_b128 v[44:47], v4 offset:29696
    v_cvt_pk_bf16_f32 v91, v91, v91
    v_lshlrev_b32 v91, 16, v91
    s_waitcnt lgkmcnt(5)
    v_mfma_f32_16x16x32_bf16 v[64:67], v[172:175], v[56:59], v[64:67]
    v_mul_f32 v23, 0xbfb8aa3b, v91
    v_exp_f32 v23, v23
    v_mfma_f32_16x16x32_bf16 v[68:71], v[236:239], v[56:59], v[68:71]
    ds_read_b128 v[48:51], v4 offset:14336
    v_add_f32 v23, 1.0, v23
    v_rcp_f32 v23, v23
    s_waitcnt lgkmcnt(5)
    v_mfma_f32_16x16x32_bf16 v[72:75], v[172:175], v[60:63], v[72:75]
    v_mul_f32 v91, v91, v23
    v_cvt_pk_bf16_f32 v92, v92, v92
    v_mfma_f32_16x16x32_bf16 v[76:79], v[236:239], v[60:63], v[76:79]
    ds_read_b128 v[52:55], v4 offset:30720
    v_lshlrev_b32 v92, 16, v92
    v_mul_f32 v20, 0xbfb8aa3b, v92
    s_waitcnt lgkmcnt(5)
    v_mfma_f32_16x16x32_bf16 v[64:67], v[176:179], v[32:35], v[64:67]
    v_exp_f32 v20, v20
    s_nop 0
    v_add_f32 v20, 1.0, v20
    v_mfma_f32_16x16x32_bf16 v[68:71], v[240:243], v[32:35], v[68:71]
    ds_read_b128 v[56:59], v4 offset:15360
    v_rcp_f32 v20, v20
    s_nop 0
    v_mul_f32 v92, v92, v20
    s_waitcnt lgkmcnt(5)
    v_mfma_f32_16x16x32_bf16 v[72:75], v[176:179], v[36:39], v[72:75]
    v_cvt_pk_bf16_f32 v93, v93, v93
    v_lshlrev_b32 v93, 16, v93
    v_mfma_f32_16x16x32_bf16 v[76:79], v[240:243], v[36:39], v[76:79]
    ds_read_b128 v[60:63], v4 offset:31744
    v_mul_f32 v21, 0xbfb8aa3b, v93
    v_exp_f32 v21, v21
    s_waitcnt lgkmcnt(5)
    v_mfma_f32_16x16x32_bf16 v[64:67], v[180:183], v[40:43], v[64:67]
    v_add_f32 v21, 1.0, v21
    v_rcp_f32 v21, v21
    v_mfma_f32_16x16x32_bf16 v[68:71], v[244:247], v[40:43], v[68:71]
    v_mul_f32 v93, v93, v21
    v_cvt_pk_bf16_f32 v94, v94, v94
    s_waitcnt lgkmcnt(4)
    v_mfma_f32_16x16x32_bf16 v[72:75], v[180:183], v[44:47], v[72:75]
    v_lshlrev_b32 v94, 16, v94
    v_mul_f32 v22, 0xbfb8aa3b, v94
    v_mfma_f32_16x16x32_bf16 v[76:79], v[244:247], v[44:47], v[76:79]
    v_exp_f32 v22, v22
    s_nop 0
    v_add_f32 v22, 1.0, v22
    s_waitcnt lgkmcnt(3)
    v_mfma_f32_16x16x32_bf16 v[64:67], v[184:187], v[48:51], v[64:67]
    v_rcp_f32 v22, v22
    s_nop 0
    v_mul_f32 v94, v94, v22
    v_mfma_f32_16x16x32_bf16 v[68:71], v[248:251], v[48:51], v[68:71]
    v_cvt_pk_bf16_f32 v95, v95, v95
    v_lshlrev_b32 v95, 16, v95
    s_waitcnt lgkmcnt(2)
    v_mfma_f32_16x16x32_bf16 v[72:75], v[184:187], v[52:55], v[72:75]
    v_mul_f32 v23, 0xbfb8aa3b, v95
    v_exp_f32 v23, v23
    v_mfma_f32_16x16x32_bf16 v[76:79], v[248:251], v[52:55], v[76:79]
    v_add_f32 v23, 1.0, v23
    v_rcp_f32 v23, v23
    s_waitcnt lgkmcnt(1)
    v_mfma_f32_16x16x32_bf16 v[64:67], v[188:191], v[56:59], v[64:67]
    v_mul_f32 v95, v95, v23
    v_cvt_pk_bf16_f32 v100, v88, v89
    v_mfma_f32_16x16x32_bf16 v[68:71], v[252:255], v[56:59], v[68:71]
    v_cvt_pk_bf16_f32 v101, v90, v91
    v_cvt_pk_bf16_f32 v102, v92, v93
    s_waitcnt lgkmcnt(0)
    v_mfma_f32_16x16x32_bf16 v[72:75], v[188:191], v[60:63], v[72:75]
    v_cvt_pk_bf16_f32 v103, v94, v95
    buffer_store_dwordx4 v[100:103], v0, s[8:11], s73 offen offset:1024 sc1
    v_mfma_f32_16x16x32_bf16 v[76:79], v[252:255], v[60:63], v[76:79]
    s_mov_b32 s73, s76
    s_add_u32 s76, s76, s74
    s_waitcnt vmcnt(18)
    s_barrier
    ds_read_b128 v[32:35], v4 offset:32768
    ds_read_b128 v[36:39], v4 offset:49152
    ds_read_b128 v[40:43], v4 offset:33792
    ds_read_b128 v[44:47], v4 offset:50176
    ds_read_b128 v[48:51], v4 offset:34816
    ds_read_b128 v[52:55], v4 offset:51200
    s_waitcnt lgkmcnt(5)
    v_mfma_f32_16x16x32_bf16 v[80:83], v[128:131], v[32:35], 0
    v_mfma_f32_16x16x32_bf16 v[84:87], v[192:195], v[32:35], 0
    ds_read_b128 v[56:59], v4 offset:35840
    s_waitcnt lgkmcnt(5)
    v_mfma_f32_16x16x32_bf16 v[88:91], v[128:131], v[36:39], 0
    s_add_u32 m0, s72, 65536
    v_cvt_pk_bf16_f32 v64, v64, v64
    v_lshlrev_b32 v64, 16, v64
    v_mfma_f32_16x16x32_bf16 v[92:95], v[192:195], v[36:39], 0
    ds_read_b128 v[60:63], v4 offset:52224
    v_mul_f32 v20, 0xbfb8aa3b, v64
    v_exp_f32 v20, v20
    s_waitcnt lgkmcnt(5)
    v_mfma_f32_16x16x32_bf16 v[80:83], v[132:135], v[40:43], v[80:83]
    buffer_load_dwordx4 v0, s[8:11], s62 offen offset:0 sc1 lds
    v_add_f32 v20, 1.0, v20
    v_rcp_f32 v20, v20
    v_mfma_f32_16x16x32_bf16 v[84:87], v[196:199], v[40:43], v[84:87]
    ds_read_b128 v[32:35], v4 offset:36864
    v_mul_f32 v64, v64, v20
    v_cvt_pk_bf16_f32 v65, v65, v65
    s_waitcnt lgkmcnt(5)
    v_mfma_f32_16x16x32_bf16 v[88:91], v[132:135], v[44:47], v[88:91]
    buffer_load_dwordx4 v0, s[8:11], s62 offen offset:1024 sc1 lds
    v_lshlrev_b32 v65, 16, v65
    v_mul_f32 v21, 0xbfb8aa3b, v65
    v_mfma_f32_16x16x32_bf16 v[92:95], v[196:199], v[44:47], v[92:95]
    ds_read_b128 v[36:39], v4 offset:53248
    v_exp_f32 v21, v21
    s_nop 0
    v_add_f32 v21, 1.0, v21
    s_waitcnt lgkmcnt(5)
    v_mfma_f32_16x16x32_bf16 v[80:83], v[136:139], v[48:51], v[80:83]
    buffer_load_dwordx4 v0, s[8:11], s62 offen offset:2048 sc1 lds
    v_rcp_f32 v21, v21
    s_nop 0
    v_mul_f32 v65, v65, v21
    v_mfma_f32_16x16x32_bf16 v[84:87], v[200:203], v[48:51], v[84:87]
    ds_read_b128 v[40:43], v4 offset:37888
    v_cvt_pk_bf16_f32 v66, v66, v66
    v_lshlrev_b32 v66, 16, v66
    s_waitcnt lgkmcnt(5)
    v_mfma_f32_16x16x32_bf16 v[88:91], v[136:139], v[52:55], v[88:91]
    buffer_load_dwordx4 v0, s[8:11], s62 offen offset:3072 sc1 lds
    v_mul_f32 v22, 0xbfb8aa3b, v66
    v_exp_f32 v22, v22
    v_mfma_f32_16x16x32_bf16 v[92:95], v[200:203], v[52:55], v[92:95]
    ds_read_b128 v[44:47], v4 offset:54272
    v_add_f32 v22, 1.0, v22
    v_rcp_f32 v22, v22
    s_waitcnt lgkmcnt(5)
    v_mfma_f32_16x16x32_bf16 v[80:83], v[140:143], v[56:59], v[80:83]
    s_add_u32 s62, s62, 4096
    v_mul_f32 v66, v66, v22
    v_cvt_pk_bf16_f32 v67, v67, v67
    v_mfma_f32_16x16x32_bf16 v[84:87], v[204:207], v[56:59], v[84:87]
    ds_read_b128 v[48:51], v4 offset:38912
    v_lshlrev_b32 v67, 16, v67
    v_mul_f32 v23, 0xbfb8aa3b, v67
    s_waitcnt lgkmcnt(5)
    v_mfma_f32_16x16x32_bf16 v[88:91], v[140:143], v[60:63], v[88:91]
    s_add_u32 m0, s72, 69632
    v_exp_f32 v23, v23
    s_nop 0
    v_add_f32 v23, 1.0, v23
    v_mfma_f32_16x16x32_bf16 v[92:95], v[204:207], v[60:63], v[92:95]
    ds_read_b128 v[52:55], v4 offset:55296
    v_rcp_f32 v23, v23
    s_nop 0
    v_mul_f32 v67, v67, v23
    s_waitcnt lgkmcnt(5)
    v_mfma_f32_16x16x32_bf16 v[80:83], v[144:147], v[32:35], v[80:83]
    buffer_load_dwordx4 v0, s[8:11], s62 offen offset:0 sc1 lds
    v_cvt_pk_bf16_f32 v68, v68, v68
    v_lshlrev_b32 v68, 16, v68
    v_mfma_f32_16x16x32_bf16 v[84:87], v[208:211], v[32:35], v[84:87]
    ds_read_b128 v[56:59], v4 offset:39936
    v_mul_f32 v20, 0xbfb8aa3b, v68
    v_exp_f32 v20, v20
    s_waitcnt lgkmcnt(5)
    v_mfma_f32_16x16x32_bf16 v[88:91], v[144:147], v[36:39], v[88:91]
    buffer_load_dwordx4 v0, s[8:11], s62 offen offset:1024 sc1 lds
    v_add_f32 v20, 1.0, v20
    v_rcp_f32 v20, v20
    v_mfma_f32_16x16x32_bf16 v[92:95], v[208:211], v[36:39], v[92:95]
    ds_read_b128 v[60:63], v4 offset:56320
    v_mul_f32 v68, v68, v20
    v_cvt_pk_bf16_f32 v69, v69, v69
    s_waitcnt lgkmcnt(5)
    v_mfma_f32_16x16x32_bf16 v[80:83], v[148:151], v[40:43], v[80:83]
    buffer_load_dwordx4 v0, s[8:11], s62 offen offset:2048 sc1 lds
    v_lshlrev_b32 v69, 16, v69
    v_mul_f32 v21, 0xbfb8aa3b, v69
    v_mfma_f32_16x16x32_bf16 v[84:87], v[212:215], v[40:43], v[84:87]
    ds_read_b128 v[32:35], v4 offset:40960
    v_exp_f32 v21, v21
    s_nop 0
    v_add_f32 v21, 1.0, v21
    s_waitcnt lgkmcnt(5)
    v_mfma_f32_16x16x32_bf16 v[88:91], v[148:151], v[44:47], v[88:91]
    buffer_load_dwordx4 v0, s[8:11], s62 offen offset:3072 sc1 lds
    v_rcp_f32 v21, v21
    s_nop 0
    v_mul_f32 v69, v69, v21
    v_mfma_f32_16x16x32_bf16 v[92:95], v[212:215], v[44:47], v[92:95]
    ds_read_b128 v[36:39], v4 offset:57344
    v_cvt_pk_bf16_f32 v70, v70, v70
    v_lshlrev_b32 v70, 16, v70
    s_waitcnt lgkmcnt(5)
    v_mfma_f32_16x16x32_bf16 v[80:83], v[152:155], v[48:51], v[80:83]
    s_add_u32 s62, s62, 61440
    v_mul_f32 v22, 0xbfb8aa3b, v70
    v_exp_f32 v22, v22
    v_mfma_f32_16x16x32_bf16 v[84:87], v[216:219], v[48:51], v[84:87]
    ds_read_b128 v[40:43], v4 offset:41984
    v_add_f32 v22, 1.0, v22
    v_rcp_f32 v22, v22
    s_waitcnt lgkmcnt(5)
    v_mfma_f32_16x16x32_bf16 v[88:91], v[152:155], v[52:55], v[88:91]
    v_mul_f32 v70, v70, v22
    v_cvt_pk_bf16_f32 v71, v71, v71
    v_mfma_f32_16x16x32_bf16 v[92:95], v[216:219], v[52:55], v[92:95]
    ds_read_b128 v[44:47], v4 offset:58368
    v_lshlrev_b32 v71, 16, v71
    v_mul_f32 v23, 0xbfb8aa3b, v71
    s_waitcnt lgkmcnt(5)
    v_mfma_f32_16x16x32_bf16 v[80:83], v[156:159], v[56:59], v[80:83]
    v_exp_f32 v23, v23
    s_nop 0
    v_add_f32 v23, 1.0, v23
    v_mfma_f32_16x16x32_bf16 v[84:87], v[220:223], v[56:59], v[84:87]
    ds_read_b128 v[48:51], v4 offset:43008
    v_rcp_f32 v23, v23
    s_nop 0
    v_mul_f32 v71, v71, v23
    s_waitcnt lgkmcnt(5)
    v_mfma_f32_16x16x32_bf16 v[88:91], v[156:159], v[60:63], v[88:91]
    v_cvt_pk_bf16_f32 v96, v64, v65
    v_cvt_pk_bf16_f32 v97, v66, v67
    v_mfma_f32_16x16x32_bf16 v[92:95], v[220:223], v[60:63], v[92:95]
    ds_read_b128 v[52:55], v4 offset:59392
    v_cvt_pk_bf16_f32 v98, v68, v69
    v_cvt_pk_bf16_f32 v99, v70, v71
    s_waitcnt lgkmcnt(5)
    v_mfma_f32_16x16x32_bf16 v[80:83], v[160:163], v[32:35], v[80:83]
    buffer_store_dwordx4 v[96:99], v0, s[8:11], s73 offen offset:0 sc1
    v_cvt_pk_bf16_f32 v72, v72, v72
    v_mfma_f32_16x16x32_bf16 v[84:87], v[224:227], v[32:35], v[84:87]
    ds_read_b128 v[56:59], v4 offset:44032
    v_lshlrev_b32 v72, 16, v72
    v_mul_f32 v20, 0xbfb8aa3b, v72
    s_waitcnt lgkmcnt(5)
    v_mfma_f32_16x16x32_bf16 v[88:91], v[160:163], v[36:39], v[88:91]
    v_exp_f32 v20, v20
    s_nop 0
    v_add_f32 v20, 1.0, v20
    v_mfma_f32_16x16x32_bf16 v[92:95], v[224:227], v[36:39], v[92:95]
    ds_read_b128 v[60:63], v4 offset:60416
    v_rcp_f32 v20, v20
    s_nop 0
    v_mul_f32 v72, v72, v20
    s_waitcnt lgkmcnt(5)
    v_mfma_f32_16x16x32_bf16 v[80:83], v[164:167], v[40:43], v[80:83]
    v_cvt_pk_bf16_f32 v73, v73, v73
    v_lshlrev_b32 v73, 16, v73
    v_mfma_f32_16x16x32_bf16 v[84:87], v[228:231], v[40:43], v[84:87]
    ds_read_b128 v[32:35], v4 offset:45056
    v_mul_f32 v21, 0xbfb8aa3b, v73
    v_exp_f32 v21, v21
    s_waitcnt lgkmcnt(5)
    v_mfma_f32_16x16x32_bf16 v[88:91], v[164:167], v[44:47], v[88:91]
    v_add_f32 v21, 1.0, v21
    v_rcp_f32 v21, v21
    v_mfma_f32_16x16x32_bf16 v[92:95], v[228:231], v[44:47], v[92:95]
    ds_read_b128 v[36:39], v4 offset:61440
    v_mul_f32 v73, v73, v21
    v_cvt_pk_bf16_f32 v74, v74, v74
    s_waitcnt lgkmcnt(5)
    v_mfma_f32_16x16x32_bf16 v[80:83], v[168:171], v[48:51], v[80:83]
    v_lshlrev_b32 v74, 16, v74
    v_mul_f32 v22, 0xbfb8aa3b, v74
    v_mfma_f32_16x16x32_bf16 v[84:87], v[232:235], v[48:51], v[84:87]
    ds_read_b128 v[40:43], v4 offset:46080
    v_exp_f32 v22, v22
    s_nop 0
    v_add_f32 v22, 1.0, v22
    s_waitcnt lgkmcnt(5)
    v_mfma_f32_16x16x32_bf16 v[88:91], v[168:171], v[52:55], v[88:91]
    v_rcp_f32 v22, v22
    s_nop 0
    v_mul_f32 v74, v74, v22
    v_mfma_f32_16x16x32_bf16 v[92:95], v[232:235], v[52:55], v[92:95]
    ds_read_b128 v[44:47], v4 offset:62464
    v_cvt_pk_bf16_f32 v75, v75, v75
    v_lshlrev_b32 v75, 16, v75
    s_waitcnt lgkmcnt(5)
    v_mfma_f32_16x16x32_bf16 v[80:83], v[172:175], v[56:59], v[80:83]
    v_mul_f32 v23, 0xbfb8aa3b, v75
    v_exp_f32 v23, v23
    v_mfma_f32_16x16x32_bf16 v[84:87], v[236:239], v[56:59], v[84:87]
    ds_read_b128 v[48:51], v4 offset:47104
    v_add_f32 v23, 1.0, v23
    v_rcp_f32 v23, v23
    s_waitcnt lgkmcnt(5)
    v_mfma_f32_16x16x32_bf16 v[88:91], v[172:175], v[60:63], v[88:91]
    v_mul_f32 v75, v75, v23
    v_cvt_pk_bf16_f32 v76, v76, v76
    v_mfma_f32_16x16x32_bf16 v[92:95], v[236:239], v[60:63], v[92:95]
    ds_read_b128 v[52:55], v4 offset:63488
    v_lshlrev_b32 v76, 16, v76
    v_mul_f32 v20, 0xbfb8aa3b, v76
    s_waitcnt lgkmcnt(5)
    v_mfma_f32_16x16x32_bf16 v[80:83], v[176:179], v[32:35], v[80:83]
    v_exp_f32 v20, v20
    s_nop 0
    v_add_f32 v20, 1.0, v20
    v_mfma_f32_16x16x32_bf16 v[84:87], v[240:243], v[32:35], v[84:87]
    ds_read_b128 v[56:59], v4 offset:48128
    v_rcp_f32 v20, v20
    s_nop 0
    v_mul_f32 v76, v76, v20
    s_waitcnt lgkmcnt(5)
    v_mfma_f32_16x16x32_bf16 v[88:91], v[176:179], v[36:39], v[88:91]
    v_cvt_pk_bf16_f32 v77, v77, v77
    v_lshlrev_b32 v77, 16, v77
    v_mfma_f32_16x16x32_bf16 v[92:95], v[240:243], v[36:39], v[92:95]
    ds_read_b128 v[60:63], v4 offset:64512
    v_mul_f32 v21, 0xbfb8aa3b, v77
    v_exp_f32 v21, v21
    s_waitcnt lgkmcnt(5)
    v_mfma_f32_16x16x32_bf16 v[80:83], v[180:183], v[40:43], v[80:83]
    v_add_f32 v21, 1.0, v21
    v_rcp_f32 v21, v21
    v_mfma_f32_16x16x32_bf16 v[84:87], v[244:247], v[40:43], v[84:87]
    v_mul_f32 v77, v77, v21
    v_cvt_pk_bf16_f32 v78, v78, v78
    s_waitcnt lgkmcnt(4)
    v_mfma_f32_16x16x32_bf16 v[88:91], v[180:183], v[44:47], v[88:91]
    v_lshlrev_b32 v78, 16, v78
    v_mul_f32 v22, 0xbfb8aa3b, v78
    v_mfma_f32_16x16x32_bf16 v[92:95], v[244:247], v[44:47], v[92:95]
    v_exp_f32 v22, v22
    s_nop 0
    v_add_f32 v22, 1.0, v22
    s_waitcnt lgkmcnt(3)
    v_mfma_f32_16x16x32_bf16 v[80:83], v[184:187], v[48:51], v[80:83]
    v_rcp_f32 v22, v22
    s_nop 0
    v_mul_f32 v78, v78, v22
    v_mfma_f32_16x16x32_bf16 v[84:87], v[248:251], v[48:51], v[84:87]
    v_cvt_pk_bf16_f32 v79, v79, v79
    v_lshlrev_b32 v79, 16, v79
    s_waitcnt lgkmcnt(2)
    v_mfma_f32_16x16x32_bf16 v[88:91], v[184:187], v[52:55], v[88:91]
    v_mul_f32 v23, 0xbfb8aa3b, v79
    v_exp_f32 v23, v23
    v_mfma_f32_16x16x32_bf16 v[92:95], v[248:251], v[52:55], v[92:95]
    v_add_f32 v23, 1.0, v23
    v_rcp_f32 v23, v23
    s_waitcnt lgkmcnt(1)
    v_mfma_f32_16x16x32_bf16 v[80:83], v[188:191], v[56:59], v[80:83]
    v_mul_f32 v79, v79, v23
    v_cvt_pk_bf16_f32 v100, v72, v73
    v_mfma_f32_16x16x32_bf16 v[84:87], v[252:255], v[56:59], v[84:87]
    v_cvt_pk_bf16_f32 v101, v74, v75
    v_cvt_pk_bf16_f32 v102, v76, v77
    s_waitcnt lgkmcnt(0)
    v_mfma_f32_16x16x32_bf16 v[88:91], v[188:191], v[60:63], v[88:91]
    v_cvt_pk_bf16_f32 v103, v78, v79
    buffer_store_dwordx4 v[100:103], v0, s[8:11], s73 offen offset:1024 sc1
    v_mfma_f32_16x16x32_bf16 v[92:95], v[252:255], v[60:63], v[92:95]
    s_mov_b32 s73, s76
    s_add_u32 s76, s76, s74
    s_add_u32 s57, s57, 1
    s_cmp_lt_u32 s57, 8
    s_cbranch_scc1 W_str_h
    s_nop 7
    s_nop 3
    v_cvt_pk_bf16_f32 v80, v80, v80
    v_lshlrev_b32 v80, 16, v80
    v_mul_f32 v20, 0xbfb8aa3b, v80
    v_exp_f32 v20, v20
    s_nop 0
    v_add_f32 v20, 1.0, v20
    v_rcp_f32 v20, v20
    s_nop 0
    v_mul_f32 v80, v80, v20
    v_cvt_pk_bf16_f32 v81, v81, v81
    v_lshlrev_b32 v81, 16, v81
    v_mul_f32 v21, 0xbfb8aa3b, v81
    v_exp_f32 v21, v21
    s_nop 0
    v_add_f32 v21, 1.0, v21
    v_rcp_f32 v21, v21
    s_nop 0
    v_mul_f32 v81, v81, v21
    v_cvt_pk_bf16_f32 v82, v82, v82
    v_lshlrev_b32 v82, 16, v82
    v_mul_f32 v22, 0xbfb8aa3b, v82
    v_exp_f32 v22, v22
    s_nop 0
    v_add_f32 v22, 1.0, v22
    v_rcp_f32 v22, v22
    s_nop 0
    v_mul_f32 v82, v82, v22
    v_cvt_pk_bf16_f32 v83, v83, v83
    v_lshlrev_b32 v83, 16, v83
    v_mul_f32 v23, 0xbfb8aa3b, v83
    v_exp_f32 v23, v23
    s_nop 0
    v_add_f32 v23, 1.0, v23
    v_rcp_f32 v23, v23
    s_nop 0
    v_mul_f32 v83, v83, v23
    v_cvt_pk_bf16_f32 v84, v84, v84
    v_lshlrev_b32 v84, 16, v84
    v_mul_f32 v20, 0xbfb8aa3b, v84
    v_exp_f32 v20, v20
    s_nop 0
    v_add_f32 v20, 1.0, v20
    v_rcp_f32 v20, v20
    s_nop 0
    v_mul_f32 v84, v84, v20
    v_cvt_pk_bf16_f32 v85, v85, v85
    v_lshlrev_b32 v85, 16, v85
    v_mul_f32 v21, 0xbfb8aa3b, v85
    v_exp_f32 v21, v21
    s_nop 0
    v_add_f32 v21, 1.0, v21
    v_rcp_f32 v21, v21
    s_nop 0
    v_mul_f32 v85, v85, v21
    v_cvt_pk_bf16_f32 v86, v86, v86
    v_lshlrev_b32 v86, 16, v86
    v_mul_f32 v22, 0xbfb8aa3b, v86
    v_exp_f32 v22, v22
    s_nop 0
    v_add_f32 v22, 1.0, v22
    v_rcp_f32 v22, v22
    s_nop 0
    v_mul_f32 v86, v86, v22
    v_cvt_pk_bf16_f32 v87, v87, v87
    v_lshlrev_b32 v87, 16, v87
    v_mul_f32 v23, 0xbfb8aa3b, v87
    v_exp_f32 v23, v23
    s_nop 0
    v_add_f32 v23, 1.0, v23
    v_rcp_f32 v23, v23
    s_nop 0
    v_mul_f32 v87, v87, v23
    v_cvt_pk_bf16_f32 v96, v80, v81
    v_cvt_pk_bf16_f32 v97, v82, v83
    v_cvt_pk_bf16_f32 v98, v84, v85
    v_cvt_pk_bf16_f32 v99, v86, v87
    buffer_store_dwordx4 v[96:99], v0, s[8:11], s73 offen offset:0 sc1
    v_cvt_pk_bf16_f32 v88, v88, v88
    v_lshlrev_b32 v88, 16, v88
    v_mul_f32 v20, 0xbfb8aa3b, v88
    v_exp_f32 v20, v20
    s_nop 0
    v_add_f32 v20, 1.0, v20
    v_rcp_f32 v20, v20
    s_nop 0
    v_mul_f32 v88, v88, v20
    v_cvt_pk_bf16_f32 v89, v89, v89
    v_lshlrev_b32 v89, 16, v89
    v_mul_f32 v21, 0xbfb8aa3b, v89
    v_exp_f32 v21, v21
    s_nop 0
    v_add_f32 v21, 1.0, v21
    v_rcp_f32 v21, v21
    s_nop 0
    v_mul_f32 v89, v89, v21
    v_cvt_pk_bf16_f32 v90, v90, v90
    v_lshlrev_b32 v90, 16, v90
    v_mul_f32 v22, 0xbfb8aa3b, v90
    v_exp_f32 v22, v22
    s_nop 0
    v_add_f32 v22, 1.0, v22
    v_rcp_f32 v22, v22
    s_nop 0
    v_mul_f32 v90, v90, v22
    v_cvt_pk_bf16_f32 v91, v91, v91
    v_lshlrev_b32 v91, 16, v91
    v_mul_f32 v23, 0xbfb8aa3b, v91
    v_exp_f32 v23, v23
    s_nop 0
    v_add_f32 v23, 1.0, v23
    v_rcp_f32 v23, v23
    s_nop 0
    v_mul_f32 v91, v91, v23
    v_cvt_pk_bf16_f32 v92, v92, v92
    v_lshlrev_b32 v92, 16, v92
    v_mul_f32 v20, 0xbfb8aa3b, v92
    v_exp_f32 v20, v20
    s_nop 0
    v_add_f32 v20, 1.0, v20
    v_rcp_f32 v20, v20
    s_nop 0
    v_mul_f32 v92, v92, v20
    v_cvt_pk_bf16_f32 v93, v93, v93
    v_lshlrev_b32 v93, 16, v93
    v_mul_f32 v21, 0xbfb8aa3b, v93
    v_exp_f32 v21, v21
    s_nop 0
    v_add_f32 v21, 1.0, v21
    v_rcp_f32 v21, v21
    s_nop 0
    v_mul_f32 v93, v93, v21
    v_cvt_pk_bf16_f32 v94, v94, v94
    v_lshlrev_b32 v94, 16, v94
    v_mul_f32 v22, 0xbfb8aa3b, v94
    v_exp_f32 v22, v22
    s_nop 0
    v_add_f32 v22, 1.0, v22
    v_rcp_f32 v22, v22
    s_nop 0
    v_mul_f32 v94, v94, v22
    v_cvt_pk_bf16_f32 v95, v95, v95
    v_lshlrev_b32 v95, 16, v95
    v_mul_f32 v23, 0xbfb8aa3b, v95
    v_exp_f32 v23, v23
    s_nop 0
    v_add_f32 v23, 1.0, v23
    v_rcp_f32 v23, v23
    s_nop 0
    v_mul_f32 v95, v95, v23
    v_cvt_pk_bf16_f32 v100, v88, v89
    v_cvt_pk_bf16_f32 v101, v90, v91
    v_cvt_pk_bf16_f32 v102, v92, v93
    v_cvt_pk_bf16_f32 v103, v94, v95
    buffer_store_dwordx4 v[100:103], v0, s[8:11], s73 offen offset:1024 sc1
    s_mov_b32 s73, s76
    s_add_u32 s76, s76, s74
    s_branch W_str_end
W_str_end:
    s_waitcnt vmcnt(0)
    s_barrier
    s_cmp_lg_u32 s54, 0
    s_cbranch_scc1 W_nosig_73
    s_mov_b64 exec, 1
    s_lshl_b32 s58, s57, 2
    s_add_u32 s58, s58, 124
    s_cmp_lt_u32 s55, 64
    s_cselect_b32 s59, 0x10001, 1
    v_mov_b32 v10, s59
    buffer_atomic_add v10, v1, s[12:15], s58 offen
    s_mov_b64 exec, -1
    s_nop 3
W_nosig_73:
    s_branch W_gemm_done
W_relayout:
    s_mov_b32 s58, 48
    s_mov_b32 s59, 1
    s_waitcnt vmcnt(0)
    s_barrier
    s_cmp_lg_u32 s54, 0
    s_cbranch_scc1 W_sig_74
    v_mov_b32 v10, s59
    s_mov_b64 exec, 1
    buffer_atomic_add v10, v1, s[12:15], s58 offen
    s_mov_b64 exec, -1
W_sig_74:
W_gemm_done:
    s_mov_b32 s58, 48
    s_cmp_lg_u32 s54, 0
    s_cbranch_scc1 W_pok_76
W_poll_75:
    buffer_load_dword v12, v1, s[12:15], s58 offen sc1
    s_waitcnt vmcnt(0)
    v_readfirstlane_b32 s59, v12
    s_nop 0
    s_cmp_ge_u32 s59, 4
    s_cbranch_scc1 W_pok_76
    s_add_u32 s61, s61, 1
    s_cmp_gt_u32 s61, 0x400000
    s_cbranch_scc1 W_fail
    s_sleep 16
    s_branch W_poll_75
W_pok_76:
    s_barrier
    s_mov_b32 s58, 128
    s_cmp_lg_u32 s54, 0
    s_cbranch_scc1 W_pok_78
W_poll_77:
    buffer_load_dword v12, v1, s[12:15], s58 offen sc1
    s_waitcnt vmcnt(0)
    v_readfirstlane_b32 s59, v12
    s_nop 0
    s_and_b32 s59, s59, 0xffff
    s_cmp_ge_u32 s59, 220
    s_cbranch_scc1 W_pok_78
    s_add_u32 s61, s61, 1
    s_cmp_gt_u32 s61, 0x400000
    s_cbranch_scc1 W_fail
    s_sleep 16
    s_branch W_poll_77
W_pok_78:
    s_barrier
    s_mul_i32 s58, s53, 188416
    s_add_u32 s58, s58, 100663296
    s_lshl_b32 s59, s54, 15
    s_add_u32 s59, s59, s58
    buffer_load_dwordx4 a[0:3], v0, s[8:11], s59 offen offset:0 sc1
    buffer_load_dwordx4 a[4:7], v0, s[8:11], s59 offen offset:1024 sc1
    buffer_load_dwordx4 a[8:11], v0, s[8:11], s59 offen offset:2048 sc1
    buffer_load_dwordx4 a[12:15], v0, s[8:11], s59 offen offset:3072 sc1
    s_add_u32 s59, s59, 4096
    buffer_load_dwordx4 a[16:19], v0, s[8:11], s59 offen offset:0 sc1
    buffer_load_dwordx4 a[20:23], v0, s[8:11], s59 offen offset:1024 sc1
    buffer_load_dwordx4 a[24:27], v0, s[8:11], s59 offen offset:2048 sc1
    buffer_load_dwordx4 a[28:31], v0, s[8:11], s59 offen offset:3072 sc1
    s_add_u32 s59, s59, 4096
    buffer_load_dwordx4 a[32:35], v0, s[8:11], s59 offen offset:0 sc1
    buffer_load_dwordx4 a[36:39], v0, s[8:11], s59 offen offset:1024 sc1
    buffer_load_dwordx4 a[40:43], v0, s[8:11], s59 offen offset:2048 sc1
    buffer_load_dwordx4 a[44:47], v0, s[8:11], s59 offen offset:3072 sc1
    s_add_u32 s59, s59, 4096
    buffer_load_dwordx4 a[48:51], v0, s[8:11], s59 offen offset:0 sc1
    buffer_load_dwordx4 a[52:55], v0, s[8:11], s59 offen offset:1024 sc1
    buffer_load_dwordx4 a[56:59], v0, s[8:11], s59 offen offset:2048 sc1
    buffer_load_dwordx4 a[60:63], v0, s[8:11], s59 offen offset:3072 sc1
    s_add_u32 s59, s59, 4096
    buffer_load_dwordx4 a[64:67], v0, s[8:11], s59 offen offset:0 sc1
    buffer_load_dwordx4 a[68:71], v0, s[8:11], s59 offen offset:1024 sc1
    buffer_load_dwordx4 a[72:75], v0, s[8:11], s59 offen offset:2048 sc1
    buffer_load_dwordx4 a[76:79], v0, s[8:11], s59 offen offset:3072 sc1
    s_add_u32 s59, s59, 4096
    buffer_load_dwordx4 a[80:83], v0, s[8:11], s59 offen offset:0 sc1
    buffer_load_dwordx4 a[84:87], v0, s[8:11], s59 offen offset:1024 sc1
    buffer_load_dwordx4 a[88:91], v0, s[8:11], s59 offen offset:2048 sc1
    buffer_load_dwordx4 a[92:95], v0, s[8:11], s59 offen offset:3072 sc1
    s_add_u32 s59, s59, 4096
    buffer_load_dwordx4 a[96:99], v0, s[8:11], s59 offen offset:0 sc1
    buffer_load_dwordx4 a[100:103], v0, s[8:11], s59 offen offset:1024 sc1
    buffer_load_dwordx4 a[104:107], v0, s[8:11], s59 offen offset:2048 sc1
    buffer_load_dwordx4 a[108:111], v0, s[8:11], s59 offen offset:3072 sc1
    s_add_u32 s59, s59, 4096
    buffer_load_dwordx4 a[112:115], v0, s[8:11], s59 offen offset:0 sc1
    buffer_load_dwordx4 a[116:119], v0, s[8:11], s59 offen offset:1024 sc1
    buffer_load_dwordx4 a[120:123], v0, s[8:11], s59 offen offset:2048 sc1
    buffer_load_dwordx4 a[124:127], v0, s[8:11], s59 offen offset:3072 sc1
    s_mul_i32 s59, s54, 14336
    s_add_u32 s59, s59, s58
    s_add_u32 s59, s59, 131072
    buffer_load_dwordx4 a[128:131], v0, s[8:11], s59 offen offset:0 sc1
    buffer_load_dwordx4 a[132:135], v0, s[8:11], s59 offen offset:1024 sc1
    buffer_load_dwordx4 a[136:139], v0, s[8:11], s59 offen offset:2048 sc1
    buffer_load_dwordx4 a[140:143], v0, s[8:11], s59 offen offset:3072 sc1
    s_add_u32 s59, s59, 4096
    buffer_load_dwordx4 a[144:147], v0, s[8:11], s59 offen offset:0 sc1
    buffer_load_dwordx4 a[148:151], v0, s[8:11], s59 offen offset:1024 sc1
    buffer_load_dwordx4 a[152:155], v0, s[8:11], s59 offen offset:2048 sc1
    buffer_load_dwordx4 a[156:159], v0, s[8:11], s59 offen offset:3072 sc1
    s_add_u32 s59, s59, 4096
    buffer_load_dwordx4 a[160:163], v0, s[8:11], s59 offen offset:0 sc1
    buffer_load_dwordx4 a[164:167], v0, s[8:11], s59 offen offset:1024 sc1
    buffer_load_dwordx4 a[168:171], v0, s[8:11], s59 offen offset:2048 sc1
    buffer_load_dwordx4 a[172:175], v0, s[8:11], s59 offen offset:3072 sc1
    s_add_u32 s59, s59, 4096
    buffer_load_dwordx4 a[176:179], v0, s[8:11], s59 offen offset:0 sc1
    buffer_load_dwordx4 a[180:183], v0, s[8:11], s59 offen offset:1024 sc1
    v_lshlrev_b32 v4, 3, v0
    v_and_b32 v4, 0xf80, v4
    v_and_b32 v12, 1, v2
    v_lshlrev_b32 v12, 4, v12
    v_mov_b32 v13, 0x3F80
    v_lshlrev_b32 v12, v12, v13
    v_lshrrev_b32 v13, 2, v2
    v_cmp_eq_u32 vcc, v13, v3
    v_mov_b32 v157, 0
    v_mov_b32 v158, 0
    v_cndmask_b32 v156, 0, v12, vcc
    v_mov_b32 v159, v156
    v_mov_b32 v145, 0
    v_mov_b32 v146, 0
    s_lshl_b32 s58, s54, 12
    v_add_u32 v7, s58, v0
    s_mov_b32 s71, 0x3fb8aa3b
    s_mov_b32 s78, s52
    s_waitcnt vmcnt(0)
    s_mov_b32 s58, 32
    s_cmp_lg_u32 s54, 0
    s_cbranch_scc1 W_pok_80
W_poll_79:
    buffer_load_dword v12, v1, s[12:15], s58 offen sc1
    s_waitcnt vmcnt(0)
    v_readfirstlane_b32 s59, v12
    s_nop 0
    s_and_b32 s59, s59, 0xffff
    s_cmp_ge_u32 s59, 32
    s_cbranch_scc1 W_pok_80
    s_add_u32 s61, s61, 1
    s_cmp_gt_u32 s61, 0x400000
    s_cbranch_scc1 W_fail
    s_sleep 8
    s_branch W_poll_79
W_pok_80:
    s_barrier
    s_and_b32 s58, s54, 1
    s_lshl_b32 s58, s58, 4
    v_add_u32 v5, s58, v2
    v_lshlrev_b32 v12, 2, v3
    v_sub_u32 v5, v5, v12
    v_add_u32 v12, s58, v2
    v_lshlrev_b32 v12, 10, v12
    v_lshl_add_u32 v12, v3, 3, v12
    s_lshl_b32 s58, s53, 5
    v_add_u32 v6, s58, v12
    s_mov_b32 s70, s52
W3_full:
    s_lshr_b32 s58, s70, 3
    s_lshl_b32 s58, s58, 2
    s_add_u32 s58, s58, 128
    s_cmp_lg_u32 s54, 0
    s_cbranch_scc1 W_pok_82
W_poll_81:
    buffer_load_dword v12, v1, s[12:15], s58 offen sc1
    s_waitcnt vmcnt(0)
    v_readfirstlane_b32 s59, v12
    s_nop 0
    s_and_b32 s59, s59, 0xffff
    s_cmp_ge_u32 s59, 220
    s_cbranch_scc1 W_pok_82
    s_add_u32 s61, s61, 1
    s_cmp_gt_u32 s61, 0x400000
    s_cbranch_scc1 W_fail
    s_sleep 8
    s_branch W_poll_81
W_pok_82:
    s_barrier
    s_lshl_b32 s58, s70, 18
    s_lshl_b32 s59, s53, 13
    s_add_u32 s68, s58, s59
    s_mul_i32 s69, s70, 376832
    s_add_u32 s69, s69, 67108864
    s_mul_i32 s58, s54, 28672
    s_add_u32 s58, s58, s69
    s_add_u32 s58, s58, 262144
    buffer_load_dwordx4 v[176:179], v0, s[8:11], s58 offen offset:0 sc1
    buffer_load_dwordx4 v[180:183], v0, s[8:11], s58 offen offset:1024 sc1
    buffer_load_dwordx4 v[184:187], v0, s[8:11], s58 offen offset:2048 sc1
    buffer_load_dwordx4 v[188:191], v0, s[8:11], s58 offen offset:3072 sc1
    s_add_u32 s58, s58, 4096
    buffer_load_dwordx4 v[192:195], v0, s[8:11], s58 offen offset:0 sc1
    buffer_load_dwordx4 v[196:199], v0, s[8:11], s58 offen offset:1024 sc1
    buffer_load_dwordx4 v[200:203], v0, s[8:11], s58 offen offset:2048 sc1
    buffer_load_dwordx4 v[204:207], v0, s[8:11], s58 offen offset:3072 sc1
    s_add_u32 s58, s58, 4096
    buffer_load_dwordx4 v[208:211], v0, s[8:11], s58 offen offset:0 sc1
    buffer_load_dwordx4 v[212:215], v0, s[8:11], s58 offen offset:1024 sc1
    buffer_load_dwordx4 v[216:219], v0, s[8:11], s58 offen offset:2048 sc1
    buffer_load_dwordx4 v[220:223], v0, s[8:11], s58 offen offset:3072 sc1
    s_add_u32 s58, s58, 4096
    buffer_load_dwordx4 v[224:227], v0, s[8:11], s58 offen offset:0 sc1
    buffer_load_dwordx4 v[228:231], v0, s[8:11], s58 offen offset:1024 sc1
    buffer_load_dwordx4 v[232:235], v0, s[8:11], s58 offen offset:2048 sc1
    buffer_load_dwordx4 v[236:239], v0, s[8:11], s58 offen offset:3072 sc1
    s_add_u32 s58, s58, 4096
    buffer_load_dwordx4 v[240:243], v0, s[8:11], s58 offen offset:0 sc1
    buffer_load_dwordx4 v[244:247], v0, s[8:11], s58 offen offset:1024 sc1
    buffer_load_dwordx4 v[248:251], v0, s[8:11], s58 offen offset:2048 sc1
    buffer_load_dwordx4 v[252:255], v0, s[8:11], s58 offen offset:3072 sc1
    s_and_b32 s59, s54, 1
    s_lshl_b32 s59, s59, 10
    s_add_u32 s59, s59, s68
    s_add_u32 s59, s59, 50331648
    buffer_load_dwordx4 v[32:35], v0, s[8:11], s59 offen offset:0 sc1
    buffer_load_dwordx4 v[36:39], v0, s[8:11], s59 offen offset:2048 sc1
    s_add_u32 s59, s59, 4096
    buffer_load_dwordx4 v[40:43], v0, s[8:11], s59 offen offset:0 sc1
    buffer_load_dwordx4 v[44:47], v0, s[8:11], s59 offen offset:2048 sc1
    s_add_u32 s59, s68, 16777216
    buffer_load_dwordx4 v[48:51], v0, s[8:11], s59 offen offset:0 sc1
    buffer_load_dwordx4 v[52:55], v0, s[8:11], s59 offen offset:1024 sc1
    buffer_load_dwordx4 v[56:59], v0, s[8:11], s59 offen offset:2048 sc1
    buffer_load_dwordx4 v[60:63], v0, s[8:11], s59 offen offset:3072 sc1
    s_add_u32 s59, s59, 4096
    buffer_load_dwordx4 v[64:67], v0, s[8:11], s59 offen offset:0 sc1
    buffer_load_dwordx4 v[68:71], v0, s[8:11], s59 offen offset:1024 sc1
    buffer_load_dwordx4 v[72:75], v0, s[8:11], s59 offen offset:2048 sc1
    buffer_load_dwordx4 v[76:79], v0, s[8:11], s59 offen offset:3072 sc1
    s_lshr_b32 s59, s54, 1
    s_lshl_b32 s59, s59, 12
    s_add_u32 s59, s59, s68
    s_add_u32 s59, s59, 33554432
    s_lshl_b32 s76, s70, 15
    buffer_load_dwordx2 v[28:29], v6, s[36:39], s76 offen
    buffer_load_dwordx4 v[80:83], v0, s[8:11], s59 offen offset:0 sc1
    buffer_load_dwordx4 v[84:87], v0, s[8:11], s59 offen offset:1024 sc1
    buffer_load_dwordx4 v[88:91], v0, s[8:11], s59 offen offset:2048 sc1
    buffer_load_dwordx4 v[92:95], v0, s[8:11], s59 offen offset:3072 sc1
    s_waitcnt vmcnt(36)
    v_mfma_f32_16x16x32_bf16 v[160:163], a[128:131], v[176:179], 0
    s_add_u32 s58, s58, 4096
    buffer_load_dwordx4 v[176:179], v0, s[8:11], s58 offen offset:0 sc1
    s_waitcnt vmcnt(36)
    v_mfma_f32_16x16x32_bf16 v[164:167], a[128:131], v[180:183], 0
    buffer_load_dwordx4 v[180:183], v0, s[8:11], s58 offen offset:1024 sc1
    s_waitcnt vmcnt(36)
    v_mfma_f32_16x16x32_bf16 v[160:163], a[132:135], v[184:187], v[160:163]
    buffer_load_dwordx4 v[184:187], v0, s[8:11], s58 offen offset:2048 sc1
    s_waitcnt vmcnt(36)
    v_mfma_f32_16x16x32_bf16 v[164:167], a[132:135], v[188:191], v[164:167]
    buffer_load_dwordx4 v[188:191], v0, s[8:11], s58 offen offset:3072 sc1
    s_waitcnt vmcnt(36)
    v_mfma_f32_16x16x32_bf16 v[160:163], a[136:139], v[192:195], v[160:163]
    s_add_u32 s58, s58, 4096
    buffer_load_dwordx4 v[192:195], v0, s[8:11], s58 offen offset:0 sc1
    s_waitcnt vmcnt(36)
    v_mfma_f32_16x16x32_bf16 v[164:167], a[136:139], v[196:199], v[164:167]
    buffer_load_dwordx4 v[196:199], v0, s[8:11], s58 offen offset:1024 sc1
    s_waitcnt vmcnt(36)
    v_mfma_f32_16x16x32_bf16 v[160:163], a[140:143], v[200:203], v[160:163]
    buffer_load_dwordx4 v[200:203], v0, s[8:11], s58 offen offset:2048 sc1
    s_waitcnt vmcnt(36)
    v_mfma_f32_16x16x32_bf16 v[164:167], a[140:143], v[204:207], v[164:167]
    buffer_load_dwordx4 v[204:207], v0, s[8:11], s58 offen offset:3072 sc1
    s_waitcnt vmcnt(36)
    v_mfma_f32_16x16x32_bf16 v[160:163], a[144:147], v[208:211], v[160:163]
    s_waitcnt vmcnt(35)
    v_mfma_f32_16x16x32_bf16 v[164:167], a[144:147], v[212:215], v[164:167]
    s_waitcnt vmcnt(34)
    v_mfma_f32_16x16x32_bf16 v[160:163], a[148:151], v[216:219], v[160:163]
    s_waitcnt vmcnt(33)
    v_mfma_f32_16x16x32_bf16 v[164:167], a[148:151], v[220:223], v[164:167]
    s_waitcnt vmcnt(32)
    v_mfma_f32_16x16x32_bf16 v[160:163], a[152:155], v[224:227], v[160:163]
    s_waitcnt vmcnt(31)
    v_mfma_f32_16x16x32_bf16 v[164:167], a[152:155], v[228:231], v[164:167]
    s_waitcnt vmcnt(30)
    v_mfma_f32_16x16x32_bf16 v[160:163], a[156:159], v[232:235], v[160:163]
    s_waitcnt vmcnt(29)
    v_mfma_f32_16x16x32_bf16 v[164:167], a[156:159], v[236:239], v[164:167]
    s_waitcnt vmcnt(28)
    v_mfma_f32_16x16x32_bf16 v[160:163], a[160:163], v[240:243], v[160:163]
    s_waitcnt vmcnt(27)
    v_mfma_f32_16x16x32_bf16 v[164:167], a[160:163], v[244:247], v[164:167]
    s_waitcnt vmcnt(26)
    v_mfma_f32_16x16x32_bf16 v[160:163], a[164:167], v[248:251], v[160:163]
    s_waitcnt vmcnt(25)
    v_mfma_f32_16x16x32_bf16 v[164:167], a[164:167], v[252:255], v[164:167]
    s_waitcnt vmcnt(7)
    v_mfma_f32_16x16x32_bf16 v[160:163], a[168:171], v[176:179], v[160:163]
    s_waitcnt vmcnt(6)
    v_mfma_f32_16x16x32_bf16 v[164:167], a[168:171], v[180:183], v[164:167]
    s_waitcnt vmcnt(5)
    v_mfma_f32_16x16x32_bf16 v[160:163], a[172:175], v[184:187], v[160:163]
    s_waitcnt vmcnt(4)
    v_mfma_f32_16x16x32_bf16 v[164:167], a[172:175], v[188:191], v[164:167]
    s_waitcnt vmcnt(3)
    v_mfma_f32_16x16x32_bf16 v[160:163], a[176:179], v[192:195], v[160:163]
    s_waitcnt vmcnt(2)
    v_mfma_f32_16x16x32_bf16 v[164:167], a[176:179], v[196:199], v[164:167]
    s_waitcnt vmcnt(1)
    v_mfma_f32_16x16x32_bf16 v[160:163], a[180:183], v[200:203], v[160:163]
    s_waitcnt vmcnt(0)
    v_mfma_f32_16x16x32_bf16 v[164:167], a[180:183], v[204:207], v[164:167]
    v_mfma_f32_16x16x32_bf16 v[128:131], v[48:51], v[32:35], 0
    v_mfma_f32_16x16x32_bf16 v[128:131], v[56:59], v[36:39], v[128:131]
    v_mfma_f32_16x16x32_bf16 v[128:131], v[64:67], v[40:43], v[128:131]
    v_mfma_f32_16x16x32_bf16 v[128:131], v[72:75], v[44:47], v[128:131]
    v_mfma_f32_16x16x32_bf16 v[132:135], v[52:55], v[32:35], 0
    v_mfma_f32_16x16x32_bf16 v[132:135], v[60:63], v[36:39], v[132:135]
    v_mfma_f32_16x16x32_bf16 v[132:135], v[68:71], v[40:43], v[132:135]
    v_mfma_f32_16x16x32_bf16 v[132:135], v[76:79], v[44:47], v[132:135]
    s_lshl_b32 s58, s53, 7
    s_add_u32 s58, s58, 589824
    s_cmp_lg_u32 s54, 0
    s_cbranch_scc1 W3_pk_84
W3_pp_83:
    buffer_load_dwordx4 v[12:15], v1, s[8:11], s58 offen sc1
    s_waitcnt vmcnt(0)
    v_min_u32 v12, v12, v13
    v_min_u32 v14, v14, v15
    v_min_u32 v12, v12, v14
    s_nop 0
    v_readfirstlane_b32 s59, v12
    s_nop 0
    s_cmp_gt_u32 s59, s70
    s_cbranch_scc1 W3_pk_84
    s_add_u32 s61, s61, 1
    s_cmp_gt_u32 s61, 0x400000
    s_cbranch_scc1 W_fail
    s_sleep 4
    s_branch W3_pp_83
W3_pk_84:
    s_barrier
    s_lshr_b32 s58, s68, 1
    s_add_u32 s58, s58, 1048576
    buffer_load_dwordx4 v[96:99], v0, s[8:11], s58 offen offset:0 sc1
    buffer_load_dwordx4 v[100:103], v0, s[8:11], s58 offen offset:1024 sc1
    buffer_load_dwordx4 v[104:107], v0, s[8:11], s58 offen offset:2048 sc1
    buffer_load_dwordx4 v[108:111], v0, s[8:11], s58 offen offset:3072 sc1
    s_waitcnt vmcnt(0)
    v_mfma_f32_16x16x16_bf16 v[12:15], v[96:97], v[156:157], 0
    v_mfma_f32_16x16x16_bf16 v[16:19], v[96:97], v[158:159], 0
    s_nop 3
    v_cvt_pk_bf16_f32 v112, v12, v13
    v_cvt_pk_bf16_f32 v113, v14, v15
    s_nop 1
    v_cvt_pk_bf16_f32 v114, v16, v17
    v_cvt_pk_bf16_f32 v115, v18, v19
    v_mfma_f32_16x16x16_bf16 v[20:23], v[100:101], v[156:157], 0
    v_mfma_f32_16x16x16_bf16 v[24:27], v[100:101], v[158:159], 0
    s_nop 3
    v_cvt_pk_bf16_f32 v116, v20, v21
    v_cvt_pk_bf16_f32 v117, v22, v23
    s_nop 1
    v_cvt_pk_bf16_f32 v118, v24, v25
    v_cvt_pk_bf16_f32 v119, v26, v27
    v_mfma_f32_16x16x16_bf16 v[12:15], v[104:105], v[156:157], 0
    v_mfma_f32_16x16x16_bf16 v[16:19], v[104:105], v[158:159], 0
    s_nop 3
    v_cvt_pk_bf16_f32 v120, v12, v13
    v_cvt_pk_bf16_f32 v121, v14, v15
    s_nop 1
    v_cvt_pk_bf16_f32 v122, v16, v17
    v_cvt_pk_bf16_f32 v123, v18, v19
    v_mfma_f32_16x16x16_bf16 v[20:23], v[108:109], v[156:157], 0
    v_mfma_f32_16x16x16_bf16 v[24:27], v[108:109], v[158:159], 0
    s_nop 3
    v_cvt_pk_bf16_f32 v124, v20, v21
    v_cvt_pk_bf16_f32 v125, v22, v23
    s_nop 1
    v_cvt_pk_bf16_f32 v126, v24, v25
    v_cvt_pk_bf16_f32 v127, v26, v27
    v_mfma_f32_16x16x32_bf16 v[136:139], v[112:115], v[32:35], 0
    v_mfma_f32_16x16x32_bf16 v[136:139], v[116:119], v[36:39], v[136:139]
    v_mfma_f32_16x16x32_bf16 v[136:139], v[120:123], v[40:43], v[136:139]
    v_mfma_f32_16x16x32_bf16 v[136:139], v[124:127], v[44:47], v[136:139]
    v_cvt_pk_bf16_f32 v12, v128, v129
    v_lshlrev_b32 v128, 16, v12
    v_and_b32 v129, 0xffff0000, v12
    v_mul_f32 v128, 0x3db504f3, v128
    v_mul_f32 v129, 0x3db504f3, v129
    v_cvt_pk_bf16_f32 v12, v128, v129
    v_lshlrev_b32 v128, 16, v12
    v_and_b32 v129, 0xffff0000, v12
    v_cvt_pk_bf16_f32 v12, v130, v131
    v_lshlrev_b32 v130, 16, v12
    v_and_b32 v131, 0xffff0000, v12
    v_mul_f32 v130, 0x3db504f3, v130
    v_mul_f32 v131, 0x3db504f3, v131
    v_cvt_pk_bf16_f32 v12, v130, v131
    v_lshlrev_b32 v130, 16, v12
    v_and_b32 v131, 0xffff0000, v12
    v_cvt_pk_bf16_f32 v12, v132, v133
    v_lshlrev_b32 v132, 16, v12
    v_and_b32 v133, 0xffff0000, v12
    v_mul_f32 v132, 0x3db504f3, v132
    v_mul_f32 v133, 0x3db504f3, v133
    v_cvt_pk_bf16_f32 v12, v132, v133
    v_lshlrev_b32 v132, 16, v12
    v_and_b32 v133, 0xffff0000, v12
    v_cvt_pk_bf16_f32 v12, v134, v135
    v_lshlrev_b32 v134, 16, v12
    v_and_b32 v135, 0xffff0000, v12
    v_mul_f32 v134, 0x3db504f3, v134
    v_mul_f32 v135, 0x3db504f3, v135
    v_cvt_pk_bf16_f32 v12, v134, v135
    v_lshlrev_b32 v134, 16, v12
    v_and_b32 v135, 0xffff0000, v12
    v_cvt_pk_bf16_f32 v12, v136, v137
    v_lshlrev_b32 v136, 16, v12
    v_and_b32 v137, 0xffff0000, v12
    v_mul_f32 v136, 0x3db504f3, v136
    v_mul_f32 v137, 0x3db504f3, v137
    v_cvt_pk_bf16_f32 v12, v136, v137
    v_lshlrev_b32 v136, 16, v12
    v_and_b32 v137, 0xffff0000, v12
    v_mov_b32 v12, 0xff800000
    v_cmp_le_i32 vcc, 0, v5
    s_nop 1
    v_cndmask_b32 v128, v12, v128, vcc
    v_cmp_le_i32 vcc, 1, v5
    s_nop 1
    v_cndmask_b32 v129, v12, v129, vcc
    v_cmp_le_i32 vcc, 2, v5
    s_nop 1
    v_cndmask_b32 v130, v12, v130, vcc
    v_cmp_le_i32 vcc, 3, v5
    s_nop 1
    v_cndmask_b32 v131, v12, v131, vcc
    v_cmp_le_i32 vcc, 16, v5
    s_nop 1
    v_cndmask_b32 v132, v12, v132, vcc
    v_cmp_le_i32 vcc, 17, v5
    s_nop 1
    v_cndmask_b32 v133, v12, v133, vcc
    v_cmp_le_i32 vcc, 18, v5
    s_nop 1
    v_cndmask_b32 v134, v12, v134, vcc
    v_cmp_le_i32 vcc, 19, v5
    s_nop 1
    v_cndmask_b32 v135, v12, v135, vcc
    v_max3_f32 v13, v128, v129, v130
    v_max3_f32 v13, v13, v131, v132
    v_max3_f32 v13, v13, v133, v134
    v_max3_f32 v13, v13, v135, v136
    v_max_f32 v13, v13, v137
    v_mov_b32 v14, v13
    s_nop 1
    v_permlane32_swap_b32 v13, v14
    v_max_f32 v13, v13, v14
    v_mov_b32 v14, v13
    s_nop 1
    v_permlane16_swap_b32 v13, v14
    v_max_f32 v13, v13, v14
    v_sub_f32 v128, v128, v13
    v_mul_f32 v128, s71, v128
    v_exp_f32 v128, v128
    v_sub_f32 v129, v129, v13
    v_mul_f32 v129, s71, v129
    v_exp_f32 v129, v129
    v_sub_f32 v130, v130, v13
    v_mul_f32 v130, s71, v130
    v_exp_f32 v130, v130
    v_sub_f32 v131, v131, v13
    v_mul_f32 v131, s71, v131
    v_exp_f32 v131, v131
    v_sub_f32 v132, v132, v13
    v_mul_f32 v132, s71, v132
    v_exp_f32 v132, v132
    v_sub_f32 v133, v133, v13
    v_mul_f32 v133, s71, v133
    v_exp_f32 v133, v133
    v_sub_f32 v134, v134, v13
    v_mul_f32 v134, s71, v134
    v_exp_f32 v134, v134
    v_sub_f32 v135, v135, v13
    v_mul_f32 v135, s71, v135
    v_exp_f32 v135, v135
    v_sub_f32 v136, v136, v13
    v_mul_f32 v136, s71, v136
    v_exp_f32 v136, v136
    v_sub_f32 v137, v137, v13
    v_mul_f32 v137, s71, v137
    v_exp_f32 v137, v137
    v_add_f32 v13, v128, v129
    v_add_f32 v13, v13, v130
    v_add_f32 v13, v13, v131
    v_add_f32 v13, v13, v132
    v_add_f32 v13, v13, v133
    v_add_f32 v13, v13, v134
    v_add_f32 v13, v13, v135
    v_add_f32 v13, v13, v136
    v_add_f32 v13, v13, v137
    v_mov_b32 v14, v13
    s_nop 1
    v_permlane32_swap_b32 v13, v14
    v_add_f32 v13, v13, v14
    v_mov_b32 v14, v13
    s_nop 1
    v_permlane16_swap_b32 v13, v14
    v_add_f32 v13, v13, v14
    v_rcp_f32 v13, v13
    s_nop 0
    v_mul_f32 v128, v128, v13
    v_mul_f32 v129, v129, v13
    v_mul_f32 v130, v130, v13
    v_mul_f32 v131, v131, v13
    v_mul_f32 v132, v132, v13
    v_mul_f32 v133, v133, v13
    v_mul_f32 v134, v134, v13
    v_mul_f32 v135, v135, v13
    v_mul_f32 v136, v136, v13
    v_mul_f32 v137, v137, v13
    v_cvt_pk_bf16_f32 v140, v128, v129
    v_cvt_pk_bf16_f32 v141, v130, v131
    v_cvt_pk_bf16_f32 v142, v132, v133
    v_cvt_pk_bf16_f32 v143, v134, v135
    v_cvt_pk_bf16_f32 v144, v136, v137
    v_cvt_pk_bf16_f32 v147, v136, v137
    s_cmp_ge_u32 s54, 2
    s_cbranch_scc1 W3_e_85
    v_mov_b32 v16, v98
    v_mov_b32 v17, v99
    v_mov_b32 v18, v102
    v_mov_b32 v19, v103
    s_branch W3_e_86
W3_e_85:
    v_mov_b32 v16, v106
    v_mov_b32 v17, v107
    v_mov_b32 v18, v110
    v_mov_b32 v19, v111
W3_e_86:
    s_nop 1
    s_lshl_b32 s58, s53, 13
    s_add_u32 s58, s58, s69
    s_lshr_b32 s59, s54, 1
    s_lshl_b32 s59, s59, 12
    s_add_u32 s58, s58, s59
    s_and_b32 s59, s54, 1
    s_lshl_b32 s59, s59, 10
    s_add_u32 s58, s58, s59
    v_mfma_f32_16x16x32_bf16 v[148:151], v[80:83], v[140:143], 0
    v_mfma_f32_16x16x32_bf16 v[152:155], v[84:87], v[140:143], 0
    s_nop 3
    v_mfma_f32_16x16x16_bf16 v[148:151], v[16:17], v[144:145], v[148:151]
    v_mfma_f32_16x16x16_bf16 v[152:155], v[16:17], v[146:147], v[152:155]
    s_nop 3
    v_cvt_pk_bf16_f32 v20, v148, v149
    v_cvt_pk_bf16_f32 v21, v150, v151
    s_nop 1
    v_cvt_pk_bf16_f32 v22, v152, v153
    v_cvt_pk_bf16_f32 v23, v154, v155
    buffer_store_dwordx4 v[20:23], v0, s[8:11], s58 offen offset:0 sc1
    v_mfma_f32_16x16x32_bf16 v[148:151], v[88:91], v[140:143], 0
    v_mfma_f32_16x16x32_bf16 v[152:155], v[92:95], v[140:143], 0
    s_nop 3
    v_mfma_f32_16x16x16_bf16 v[148:151], v[18:19], v[144:145], v[148:151]
    v_mfma_f32_16x16x16_bf16 v[152:155], v[18:19], v[146:147], v[152:155]
    s_nop 3
    v_cvt_pk_bf16_f32 v24, v148, v149
    v_cvt_pk_bf16_f32 v25, v150, v151
    s_nop 1
    v_cvt_pk_bf16_f32 v26, v152, v153
    v_cvt_pk_bf16_f32 v27, v154, v155
    buffer_store_dwordx4 v[24:27], v0, s[8:11], s58 offen offset:2048 sc1
    s_waitcnt vmcnt(0)
    s_barrier
    s_cmp_lg_u32 s54, 0
    s_cbranch_scc1 W3_g_88
    s_add_u32 s59, s70, 1
    v_mov_b32 v12, s59
    s_mov_b64 exec, 1
    buffer_store_dword v12, v1, s[8:11], s77 offen sc1
    s_mov_b64 exec, -1
    s_lshl_b32 s58, s52, 12
    s_add_u32 s58, s58, 786432
W3_g_87:
    buffer_load_dword v13, v4, s[8:11], s58 offen sc1
    s_waitcnt vmcnt(0)
    v_cmp_gt_u32 vcc, s59, v13
    s_cbranch_vccz W3_g_88
    s_add_u32 s61, s61, 1
    s_cmp_gt_u32 s61, 0x400000
    s_cbranch_scc1 W_fail
    s_sleep 2
    s_branch W3_g_87
W3_g_88:
    s_barrier
    s_lshl_b32 s58, s54, 16
    s_add_u32 s58, s58, s69
    buffer_load_dwordx4 v[176:179], v0, s[8:11], s58 offen offset:0 sc1
    buffer_load_dwordx4 v[180:183], v0, s[8:11], s58 offen offset:1024 sc1
    buffer_load_dwordx4 v[184:187], v0, s[8:11], s58 offen offset:2048 sc1
    buffer_load_dwordx4 v[188:191], v0, s[8:11], s58 offen offset:3072 sc1
    s_add_u32 s58, s58, 4096
    buffer_load_dwordx4 v[192:195], v0, s[8:11], s58 offen offset:0 sc1
    buffer_load_dwordx4 v[196:199], v0, s[8:11], s58 offen offset:1024 sc1
    buffer_load_dwordx4 v[200:203], v0, s[8:11], s58 offen offset:2048 sc1
    buffer_load_dwordx4 v[204:207], v0, s[8:11], s58 offen offset:3072 sc1
    s_add_u32 s58, s58, 4096
    buffer_load_dwordx4 v[208:211], v0, s[8:11], s58 offen offset:0 sc1
    buffer_load_dwordx4 v[212:215], v0, s[8:11], s58 offen offset:1024 sc1
    buffer_load_dwordx4 v[216:219], v0, s[8:11], s58 offen offset:2048 sc1
    buffer_load_dwordx4 v[220:223], v0, s[8:11], s58 offen offset:3072 sc1
    s_add_u32 s58, s58, 4096
    buffer_load_dwordx4 v[224:227], v0, s[8:11], s58 offen offset:0 sc1
    buffer_load_dwordx4 v[228:231], v0, s[8:11], s58 offen offset:1024 sc1
    buffer_load_dwordx4 v[232:235], v0, s[8:11], s58 offen offset:2048 sc1
    buffer_load_dwordx4 v[236:239], v0, s[8:11], s58 offen offset:3072 sc1
    s_add_u32 s58, s58, 4096
    buffer_load_dwordx4 v[240:243], v0, s[8:11], s58 offen offset:0 sc1
    buffer_load_dwordx4 v[244:247], v0, s[8:11], s58 offen offset:1024 sc1
    buffer_load_dwordx4 v[248:251], v0, s[8:11], s58 offen offset:2048 sc1
    buffer_load_dwordx4 v[252:255], v0, s[8:11], s58 offen offset:3072 sc1
    s_add_u32 s58, s58, 4096
    buffer_load_dwordx4 v[32:35], v0, s[8:11], s58 offen offset:0 sc1
    buffer_load_dwordx4 v[36:39], v0, s[8:11], s58 offen offset:1024 sc1
    buffer_load_dwordx4 v[40:43], v0, s[8:11], s58 offen offset:2048 sc1
    buffer_load_dwordx4 v[44:47], v0, s[8:11], s58 offen offset:3072 sc1
    s_add_u32 s58, s58, 4096
    buffer_load_dwordx4 v[48:51], v0, s[8:11], s58 offen offset:0 sc1
    buffer_load_dwordx4 v[52:55], v0, s[8:11], s58 offen offset:1024 sc1
    buffer_load_dwordx4 v[56:59], v0, s[8:11], s58 offen offset:2048 sc1
    buffer_load_dwordx4 v[60:63], v0, s[8:11], s58 offen offset:3072 sc1
    s_add_u32 s58, s58, 4096
    buffer_load_dwordx4 v[64:67], v0, s[8:11], s58 offen offset:0 sc1
    buffer_load_dwordx4 v[68:71], v0, s[8:11], s58 offen offset:1024 sc1
    buffer_load_dwordx4 v[72:75], v0, s[8:11], s58 offen offset:2048 sc1
    buffer_load_dwordx4 v[76:79], v0, s[8:11], s58 offen offset:3072 sc1
    s_add_u32 s58, s58, 4096
    buffer_load_dwordx4 v[80:83], v0, s[8:11], s58 offen offset:0 sc1
    buffer_load_dwordx4 v[84:87], v0, s[8:11], s58 offen offset:1024 sc1
    buffer_load_dwordx4 v[88:91], v0, s[8:11], s58 offen offset:2048 sc1
    buffer_load_dwordx4 v[92:95], v0, s[8:11], s58 offen offset:3072 sc1
    s_add_u32 s58, s58, 4096
    buffer_load_dwordx4 v[96:99], v0, s[8:11], s58 offen offset:0 sc1
    buffer_load_dwordx4 v[100:103], v0, s[8:11], s58 offen offset:1024 sc1
    buffer_load_dwordx4 v[104:107], v0, s[8:11], s58 offen offset:2048 sc1
    buffer_load_dwordx4 v[108:111], v0, s[8:11], s58 offen offset:3072 sc1
    s_add_u32 s58, s58, 4096
    buffer_load_dwordx4 v[112:115], v0, s[8:11], s58 offen offset:0 sc1
    buffer_load_dwordx4 v[116:119], v0, s[8:11], s58 offen offset:1024 sc1
    buffer_load_dwordx4 v[120:123], v0, s[8:11], s58 offen offset:2048 sc1
    buffer_load_dwordx4 v[124:127], v0, s[8:11], s58 offen offset:3072 sc1
    s_waitcnt vmcnt(43)
    v_mfma_f32_16x16x32_bf16 v[168:171], a[0:3], v[176:179], 0
    s_add_u32 s58, s58, 4096
    buffer_load_dwordx4 v[176:179], v0, s[8:11], s58 offen offset:0 sc1
    s_waitcnt vmcnt(43)
    v_mfma_f32_16x16x32_bf16 v[172:175], a[0:3], v[180:183], 0
    buffer_load_dwordx4 v[180:183], v0, s[8:11], s58 offen offset:1024 sc1
    s_waitcnt vmcnt(43)
    v_mfma_f32_16x16x32_bf16 v[168:171], a[4:7], v[184:187], v[168:171]
    buffer_load_dwordx4 v[184:187], v0, s[8:11], s58 offen offset:2048 sc1
    s_waitcnt vmcnt(43)
    v_mfma_f32_16x16x32_bf16 v[172:175], a[4:7], v[188:191], v[172:175]
    buffer_load_dwordx4 v[188:191], v0, s[8:11], s58 offen offset:3072 sc1
    s_waitcnt vmcnt(43)
    v_mfma_f32_16x16x32_bf16 v[168:171], a[8:11], v[192:195], v[168:171]
    s_add_u32 s58, s58, 4096
    buffer_load_dwordx4 v[192:195], v0, s[8:11], s58 offen offset:0 sc1
    s_waitcnt vmcnt(43)
    v_mfma_f32_16x16x32_bf16 v[172:175], a[8:11], v[196:199], v[172:175]
    buffer_load_dwordx4 v[196:199], v0, s[8:11], s58 offen offset:1024 sc1
    s_waitcnt vmcnt(43)
    v_mfma_f32_16x16x32_bf16 v[168:171], a[12:15], v[200:203], v[168:171]
    buffer_load_dwordx4 v[200:203], v0, s[8:11], s58 offen offset:2048 sc1
    s_waitcnt vmcnt(43)
    v_mfma_f32_16x16x32_bf16 v[172:175], a[12:15], v[204:207], v[172:175]
    buffer_load_dwordx4 v[204:207], v0, s[8:11], s58 offen offset:3072 sc1
    s_waitcnt vmcnt(43)
    v_mfma_f32_16x16x32_bf16 v[168:171], a[16:19], v[208:211], v[168:171]
    s_add_u32 s58, s58, 4096
    buffer_load_dwordx4 v[208:211], v0, s[8:11], s58 offen offset:0 sc1
    s_waitcnt vmcnt(43)
    v_mfma_f32_16x16x32_bf16 v[172:175], a[16:19], v[212:215], v[172:175]
    buffer_load_dwordx4 v[212:215], v0, s[8:11], s58 offen offset:1024 sc1
    s_waitcnt vmcnt(43)
    v_mfma_f32_16x16x32_bf16 v[168:171], a[20:23], v[216:219], v[168:171]
    buffer_load_dwordx4 v[216:219], v0, s[8:11], s58 offen offset:2048 sc1
    s_waitcnt vmcnt(43)
    v_mfma_f32_16x16x32_bf16 v[172:175], a[20:23], v[220:223], v[172:175]
    buffer_load_dwordx4 v[220:223], v0, s[8:11], s58 offen offset:3072 sc1
    s_waitcnt vmcnt(43)
    v_mfma_f32_16x16x32_bf16 v[168:171], a[24:27], v[224:227], v[168:171]
    s_add_u32 s58, s58, 4096
    buffer_load_dwordx4 v[224:227], v0, s[8:11], s58 offen offset:0 sc1
    s_waitcnt vmcnt(43)
    v_mfma_f32_16x16x32_bf16 v[172:175], a[24:27], v[228:231], v[172:175]
    buffer_load_dwordx4 v[228:231], v0, s[8:11], s58 offen offset:1024 sc1
    s_waitcnt vmcnt(43)
    v_mfma_f32_16x16x32_bf16 v[168:171], a[28:31], v[232:235], v[168:171]
    buffer_load_dwordx4 v[232:235], v0, s[8:11], s58 offen offset:2048 sc1
    s_waitcnt vmcnt(43)
    v_mfma_f32_16x16x32_bf16 v[172:175], a[28:31], v[236:239], v[172:175]
    buffer_load_dwordx4 v[236:239], v0, s[8:11], s58 offen offset:3072 sc1
    s_waitcnt vmcnt(43)
    v_mfma_f32_16x16x32_bf16 v[168:171], a[32:35], v[240:243], v[168:171]
    s_add_u32 s58, s58, 4096
    buffer_load_dwordx4 v[240:243], v0, s[8:11], s58 offen offset:0 sc1
    s_waitcnt vmcnt(43)
    v_mfma_f32_16x16x32_bf16 v[172:175], a[32:35], v[244:247], v[172:175]
    buffer_load_dwordx4 v[244:247], v0, s[8:11], s58 offen offset:1024 sc1
    s_waitcnt vmcnt(43)
    v_mfma_f32_16x16x32_bf16 v[168:171], a[36:39], v[248:251], v[168:171]
    buffer_load_dwordx4 v[248:251], v0, s[8:11], s58 offen offset:2048 sc1
    s_waitcnt vmcnt(43)
    v_mfma_f32_16x16x32_bf16 v[172:175], a[36:39], v[252:255], v[172:175]
    buffer_load_dwordx4 v[252:255], v0, s[8:11], s58 offen offset:3072 sc1
    s_waitcnt vmcnt(43)
    v_mfma_f32_16x16x32_bf16 v[168:171], a[40:43], v[32:35], v[168:171]
    s_waitcnt vmcnt(42)
    v_mfma_f32_16x16x32_bf16 v[172:175], a[40:43], v[36:39], v[172:175]
    s_waitcnt vmcnt(41)
    v_mfma_f32_16x16x32_bf16 v[168:171], a[44:47], v[40:43], v[168:171]
    s_waitcnt vmcnt(40)
    v_mfma_f32_16x16x32_bf16 v[172:175], a[44:47], v[44:47], v[172:175]
    s_waitcnt vmcnt(39)
    v_mfma_f32_16x16x32_bf16 v[168:171], a[48:51], v[48:51], v[168:171]
    s_waitcnt vmcnt(38)
    v_mfma_f32_16x16x32_bf16 v[172:175], a[48:51], v[52:55], v[172:175]
    s_waitcnt vmcnt(37)
    v_mfma_f32_16x16x32_bf16 v[168:171], a[52:55], v[56:59], v[168:171]
    s_waitcnt vmcnt(36)
    v_mfma_f32_16x16x32_bf16 v[172:175], a[52:55], v[60:63], v[172:175]
    s_waitcnt vmcnt(35)
    v_mfma_f32_16x16x32_bf16 v[168:171], a[56:59], v[64:67], v[168:171]
    s_waitcnt vmcnt(34)
    v_mfma_f32_16x16x32_bf16 v[172:175], a[56:59], v[68:71], v[172:175]
    s_waitcnt vmcnt(33)
    v_mfma_f32_16x16x32_bf16 v[168:171], a[60:63], v[72:75], v[168:171]
    s_waitcnt vmcnt(32)
    v_mfma_f32_16x16x32_bf16 v[172:175], a[60:63], v[76:79], v[172:175]
    s_waitcnt vmcnt(31)
    v_mfma_f32_16x16x32_bf16 v[168:171], a[64:67], v[80:83], v[168:171]
    s_waitcnt vmcnt(30)
    v_mfma_f32_16x16x32_bf16 v[172:175], a[64:67], v[84:87], v[172:175]
    s_waitcnt vmcnt(29)
    v_mfma_f32_16x16x32_bf16 v[168:171], a[68:71], v[88:91], v[168:171]
    s_waitcnt vmcnt(28)
    v_mfma_f32_16x16x32_bf16 v[172:175], a[68:71], v[92:95], v[172:175]
    s_waitcnt vmcnt(27)
    v_mfma_f32_16x16x32_bf16 v[168:171], a[72:75], v[96:99], v[168:171]
    s_waitcnt vmcnt(26)
    v_mfma_f32_16x16x32_bf16 v[172:175], a[72:75], v[100:103], v[172:175]
    s_waitcnt vmcnt(25)
    v_mfma_f32_16x16x32_bf16 v[168:171], a[76:79], v[104:107], v[168:171]
    s_waitcnt vmcnt(24)
    v_mfma_f32_16x16x32_bf16 v[172:175], a[76:79], v[108:111], v[172:175]
    s_waitcnt vmcnt(23)
    v_mfma_f32_16x16x32_bf16 v[168:171], a[80:83], v[112:115], v[168:171]
    s_waitcnt vmcnt(22)
    v_mfma_f32_16x16x32_bf16 v[172:175], a[80:83], v[116:119], v[172:175]
    s_waitcnt vmcnt(21)
    v_mfma_f32_16x16x32_bf16 v[168:171], a[84:87], v[120:123], v[168:171]
    s_waitcnt vmcnt(20)
    v_mfma_f32_16x16x32_bf16 v[172:175], a[84:87], v[124:127], v[172:175]
    s_waitcnt vmcnt(19)
    v_mfma_f32_16x16x32_bf16 v[168:171], a[88:91], v[176:179], v[168:171]
    s_waitcnt vmcnt(18)
    v_mfma_f32_16x16x32_bf16 v[172:175], a[88:91], v[180:183], v[172:175]
    s_waitcnt vmcnt(17)
    v_mfma_f32_16x16x32_bf16 v[168:171], a[92:95], v[184:187], v[168:171]
    s_waitcnt vmcnt(16)
    v_mfma_f32_16x16x32_bf16 v[172:175], a[92:95], v[188:191], v[172:175]
    s_waitcnt vmcnt(15)
    v_mfma_f32_16x16x32_bf16 v[168:171], a[96:99], v[192:195], v[168:171]
    s_waitcnt vmcnt(14)
    v_mfma_f32_16x16x32_bf16 v[172:175], a[96:99], v[196:199], v[172:175]
    s_waitcnt vmcnt(13)
    v_mfma_f32_16x16x32_bf16 v[168:171], a[100:103], v[200:203], v[168:171]
    s_waitcnt vmcnt(12)
    v_mfma_f32_16x16x32_bf16 v[172:175], a[100:103], v[204:207], v[172:175]
    s_waitcnt vmcnt(11)
    v_mfma_f32_16x16x32_bf16 v[168:171], a[104:107], v[208:211], v[168:171]
    s_waitcnt vmcnt(10)
    v_mfma_f32_16x16x32_bf16 v[172:175], a[104:107], v[212:215], v[172:175]
    s_waitcnt vmcnt(9)
    v_mfma_f32_16x16x32_bf16 v[168:171], a[108:111], v[216:219], v[168:171]
    s_waitcnt vmcnt(8)
    v_mfma_f32_16x16x32_bf16 v[172:175], a[108:111], v[220:223], v[172:175]
    s_waitcnt vmcnt(7)
    v_mfma_f32_16x16x32_bf16 v[168:171], a[112:115], v[224:227], v[168:171]
    s_waitcnt vmcnt(6)
    v_mfma_f32_16x16x32_bf16 v[172:175], a[112:115], v[228:231], v[172:175]
    s_waitcnt vmcnt(5)
    v_mfma_f32_16x16x32_bf16 v[168:171], a[116:119], v[232:235], v[168:171]
    s_waitcnt vmcnt(4)
    v_mfma_f32_16x16x32_bf16 v[172:175], a[116:119], v[236:239], v[172:175]
    s_waitcnt vmcnt(3)
    v_mfma_f32_16x16x32_bf16 v[168:171], a[120:123], v[240:243], v[168:171]
    s_waitcnt vmcnt(2)
    v_mfma_f32_16x16x32_bf16 v[172:175], a[120:123], v[244:247], v[172:175]
    s_waitcnt vmcnt(1)
    v_mfma_f32_16x16x32_bf16 v[168:171], a[124:127], v[248:251], v[168:171]
    s_waitcnt vmcnt(0)
    v_mfma_f32_16x16x32_bf16 v[172:175], a[124:127], v[252:255], v[172:175]
    ds_write_b128 v7, v[160:163] offset:0
    ds_write_b128 v7, v[164:167] offset:1024
    s_nop 1
    ds_write_b128 v7, v[168:171] offset:2048
    s_nop 2
    ds_write_b128 v7, v[172:175] offset:3072
    s_waitcnt lgkmcnt(0)
    s_barrier
    s_cmp_ge_u32 s54, 2
    s_cbranch_scc1 W3_nofin_90
    s_lshl_b32 s58, s54, 10
    v_add_u32 v12, s58, v0
    ds_read_b128 v[176:179], v12 offset:0
    ds_read_b128 v[180:183], v12 offset:2048
    ds_read_b128 v[184:187], v12 offset:4096
    ds_read_b128 v[188:191], v12 offset:6144
    ds_read_b128 v[192:195], v12 offset:8192
    ds_read_b128 v[196:199], v12 offset:10240
    ds_read_b128 v[200:203], v12 offset:12288
    ds_read_b128 v[204:207], v12 offset:14336
    s_waitcnt lgkmcnt(0)
    v_add_f32 v176, v176, v184
    v_add_f32 v192, v192, v200
    v_add_f32 v176, v176, v192
    v_add_f32 v177, v177, v185
    v_add_f32 v193, v193, v201
    v_add_f32 v177, v177, v193
    v_add_f32 v178, v178, v186
    v_add_f32 v194, v194, v202
    v_add_f32 v178, v178, v194
    v_add_f32 v179, v179, v187
    v_add_f32 v195, v195, v203
    v_add_f32 v179, v179, v195
    v_add_f32 v180, v180, v188
    v_add_f32 v196, v196, v204
    v_add_f32 v180, v180, v196
    v_add_f32 v181, v181, v189
    v_add_f32 v197, v197, v205
    v_add_f32 v181, v181, v197
    v_add_f32 v182, v182, v190
    v_add_f32 v198, v198, v206
    v_add_f32 v182, v182, v198
    v_add_f32 v183, v183, v191
    v_add_f32 v199, v199, v207
    v_add_f32 v183, v183, v199
    v_cvt_pk_bf16_f32 v14, v176, v177
    v_cvt_pk_bf16_f32 v15, v180, v181
    v_lshlrev_b32 v16, 16, v15
    v_and_b32 v17, 0xffff0000, v15
    v_lshlrev_b32 v18, 16, v28
    v_and_b32 v19, 0xffff0000, v28
    v_add_f32 v16, v16, v18
    v_add_f32 v17, v17, v19
    v_cvt_pk_bf16_f32 v15, v16, v17
    v_lshlrev_b32 v16, 16, v15
    v_and_b32 v17, 0xffff0000, v15
    v_lshlrev_b32 v18, 16, v14
    v_and_b32 v19, 0xffff0000, v14
    v_add_f32 v16, v16, v18
    v_add_f32 v17, v17, v19
    v_cvt_pk_bf16_f32 v20, v16, v17
    v_cvt_pk_bf16_f32 v14, v178, v179
    v_cvt_pk_bf16_f32 v15, v182, v183
    v_lshlrev_b32 v16, 16, v15
    v_and_b32 v17, 0xffff0000, v15
    v_lshlrev_b32 v18, 16, v29
    v_and_b32 v19, 0xffff0000, v29
    v_add_f32 v16, v16, v18
    v_add_f32 v17, v17, v19
    v_cvt_pk_bf16_f32 v15, v16, v17
    v_lshlrev_b32 v16, 16, v15
    v_and_b32 v17, 0xffff0000, v15
    v_lshlrev_b32 v18, 16, v14
    v_and_b32 v19, 0xffff0000, v14
    v_add_f32 v16, v16, v18
    v_add_f32 v17, v17, v19
    v_cvt_pk_bf16_f32 v21, v16, v17
    buffer_store_dwordx2 v[20:21], v6, s[48:51], s76 offen
W3_nofin_90:
    s_barrier
    s_add_u32 s70, s70, 7
    s_cmp_lt_u32 s70, 62
    s_cbranch_scc1 W3_full
    s_add_u32 s78, s52, 1
    s_cmp_eq_u32 s78, 7
    s_cselect_b32 s78, 0, s78
    s_add_u32 s78, s78, 124
    s_cmp_ge_u32 s78, 128
    s_cbranch_scc1 W3_done
W3_seg:
    s_lshr_b32 s70, s78, 1
    s_and_b32 s79, s78, 1
    s_lshl_b32 s58, s79, 4
    v_add_u32 v5, s58, v2
    v_lshlrev_b32 v12, 10, v5
    v_lshl_add_u32 v12, v3, 3, v12
    s_lshl_b32 s58, s53, 5
    v_add_u32 v6, s58, v12
    v_lshlrev_b32 v12, 2, v3
    v_sub_u32 v5, v5, v12
    s_lshl_b32 s79, s79, 10
    s_lshr_b32 s58, s70, 3
    s_lshl_b32 s58, s58, 2
    s_add_u32 s58, s58, 128
    s_cmp_lg_u32 s54, 0
    s_cbranch_scc1 W_pok_92
W_poll_91:
    buffer_load_dword v12, v1, s[12:15], s58 offen sc1
    s_waitcnt vmcnt(0)
    v_readfirstlane_b32 s59, v12
    s_nop 0
    s_and_b32 s59, s59, 0xffff
    s_cmp_ge_u32 s59, 220
    s_cbranch_scc1 W_pok_92
    s_add_u32 s61, s61, 1
    s_cmp_gt_u32 s61, 0x400000
    s_cbranch_scc1 W_fail
    s_sleep 8
    s_branch W_poll_91
W_pok_92:
    s_barrier
    s_lshl_b32 s58, s70, 18
    s_lshl_b32 s59, s53, 13
    s_add_u32 s68, s58, s59
    s_mul_i32 s69, s70, 376832
    s_add_u32 s69, s69, 67108864
    s_add_u32 s69, s69, s79
    s_mul_i32 s58, s54, 28672
    s_add_u32 s58, s58, s69
    s_add_u32 s58, s58, 262144
    buffer_load_dwordx4 v[176:179], v0, s[8:11], s58 offen offset:0 sc1
    buffer_load_dwordx4 v[180:183], v0, s[8:11], s58 offen offset:2048 sc1
    s_add_u32 s58, s58, 4096
    buffer_load_dwordx4 v[184:187], v0, s[8:11], s58 offen offset:0 sc1
    buffer_load_dwordx4 v[188:191], v0, s[8:11], s58 offen offset:2048 sc1
    s_add_u32 s58, s58, 4096
    buffer_load_dwordx4 v[192:195], v0, s[8:11], s58 offen offset:0 sc1
    buffer_load_dwordx4 v[196:199], v0, s[8:11], s58 offen offset:2048 sc1
    s_add_u32 s58, s58, 4096
    buffer_load_dwordx4 v[200:203], v0, s[8:11], s58 offen offset:0 sc1
    buffer_load_dwordx4 v[204:207], v0, s[8:11], s58 offen offset:2048 sc1
    s_add_u32 s58, s58, 4096
    buffer_load_dwordx4 v[208:211], v0, s[8:11], s58 offen offset:0 sc1
    buffer_load_dwordx4 v[212:215], v0, s[8:11], s58 offen offset:2048 sc1
    s_add_u32 s58, s58, 4096
    buffer_load_dwordx4 v[216:219], v0, s[8:11], s58 offen offset:0 sc1
    buffer_load_dwordx4 v[220:223], v0, s[8:11], s58 offen offset:2048 sc1
    s_add_u32 s58, s58, 4096
    buffer_load_dwordx4 v[224:227], v0, s[8:11], s58 offen offset:0 sc1
    buffer_load_dwordx4 v[228:231], v0, s[8:11], s58 offen offset:2048 sc1
    s_add_u32 s59, s79, s68
    s_add_u32 s59, s59, 50331648
    buffer_load_dwordx4 v[32:35], v0, s[8:11], s59 offen offset:0 sc1
    buffer_load_dwordx4 v[36:39], v0, s[8:11], s59 offen offset:2048 sc1
    s_add_u32 s59, s59, 4096
    buffer_load_dwordx4 v[40:43], v0, s[8:11], s59 offen offset:0 sc1
    buffer_load_dwordx4 v[44:47], v0, s[8:11], s59 offen offset:2048 sc1
    s_add_u32 s59, s68, 16777216
    buffer_load_dwordx4 v[48:51], v0, s[8:11], s59 offen offset:0 sc1
    buffer_load_dwordx4 v[52:55], v0, s[8:11], s59 offen offset:1024 sc1
    buffer_load_dwordx4 v[56:59], v0, s[8:11], s59 offen offset:2048 sc1
    buffer_load_dwordx4 v[60:63], v0, s[8:11], s59 offen offset:3072 sc1
    s_add_u32 s59, s59, 4096
    buffer_load_dwordx4 v[64:67], v0, s[8:11], s59 offen offset:0 sc1
    buffer_load_dwordx4 v[68:71], v0, s[8:11], s59 offen offset:1024 sc1
    buffer_load_dwordx4 v[72:75], v0, s[8:11], s59 offen offset:2048 sc1
    buffer_load_dwordx4 v[76:79], v0, s[8:11], s59 offen offset:3072 sc1
    s_lshl_b32 s59, s54, 11
    s_add_u32 s59, s59, s68
    s_add_u32 s59, s59, 33554432
    s_lshl_b32 s76, s70, 15
    buffer_load_dwordx2 v[28:29], v6, s[36:39], s76 offen
    buffer_load_dwordx4 v[80:83], v0, s[8:11], s59 offen offset:0 sc1
    buffer_load_dwordx4 v[84:87], v0, s[8:11], s59 offen offset:1024 sc1
    s_waitcnt vmcnt(28)
    v_mfma_f32_16x16x32_bf16 v[160:163], a[128:131], v[176:179], 0
    s_waitcnt vmcnt(27)
    v_mfma_f32_16x16x32_bf16 v[160:163], a[132:135], v[180:183], v[160:163]
    s_waitcnt vmcnt(26)
    v_mfma_f32_16x16x32_bf16 v[160:163], a[136:139], v[184:187], v[160:163]
    s_waitcnt vmcnt(25)
    v_mfma_f32_16x16x32_bf16 v[160:163], a[140:143], v[188:191], v[160:163]
    s_waitcnt vmcnt(24)
    v_mfma_f32_16x16x32_bf16 v[160:163], a[144:147], v[192:195], v[160:163]
    s_waitcnt vmcnt(23)
    v_mfma_f32_16x16x32_bf16 v[160:163], a[148:151], v[196:199], v[160:163]
    s_waitcnt vmcnt(22)
    v_mfma_f32_16x16x32_bf16 v[160:163], a[152:155], v[200:203], v[160:163]
    s_waitcnt vmcnt(21)
    v_mfma_f32_16x16x32_bf16 v[160:163], a[156:159], v[204:207], v[160:163]
    s_waitcnt vmcnt(20)
    v_mfma_f32_16x16x32_bf16 v[160:163], a[160:163], v[208:211], v[160:163]
    s_waitcnt vmcnt(19)
    v_mfma_f32_16x16x32_bf16 v[160:163], a[164:167], v[212:215], v[160:163]
    s_waitcnt vmcnt(18)
    v_mfma_f32_16x16x32_bf16 v[160:163], a[168:171], v[216:219], v[160:163]
    s_waitcnt vmcnt(17)
    v_mfma_f32_16x16x32_bf16 v[160:163], a[172:175], v[220:223], v[160:163]
    s_waitcnt vmcnt(16)
    v_mfma_f32_16x16x32_bf16 v[160:163], a[176:179], v[224:227], v[160:163]
    s_waitcnt vmcnt(15)
    v_mfma_f32_16x16x32_bf16 v[160:163], a[180:183], v[228:231], v[160:163]
    s_waitcnt vmcnt(0)
    v_mfma_f32_16x16x32_bf16 v[128:131], v[48:51], v[32:35], 0
    v_mfma_f32_16x16x32_bf16 v[128:131], v[56:59], v[36:39], v[128:131]
    v_mfma_f32_16x16x32_bf16 v[128:131], v[64:67], v[40:43], v[128:131]
    v_mfma_f32_16x16x32_bf16 v[128:131], v[72:75], v[44:47], v[128:131]
    v_mfma_f32_16x16x32_bf16 v[132:135], v[52:55], v[32:35], 0
    v_mfma_f32_16x16x32_bf16 v[132:135], v[60:63], v[36:39], v[132:135]
    v_mfma_f32_16x16x32_bf16 v[132:135], v[68:71], v[40:43], v[132:135]
    v_mfma_f32_16x16x32_bf16 v[132:135], v[76:79], v[44:47], v[132:135]
    s_lshl_b32 s58, s53, 7
    s_add_u32 s58, s58, 589824
    s_cmp_lg_u32 s54, 0
    s_cbranch_scc1 W3_pk_94
W3_pp_93:
    buffer_load_dwordx4 v[12:15], v1, s[8:11], s58 offen sc1
    s_waitcnt vmcnt(0)
    v_min_u32 v12, v12, v13
    v_min_u32 v14, v14, v15
    v_min_u32 v12, v12, v14
    s_nop 0
    v_readfirstlane_b32 s59, v12
    s_nop 0
    s_cmp_gt_u32 s59, s70
    s_cbranch_scc1 W3_pk_94
    s_add_u32 s61, s61, 1
    s_cmp_gt_u32 s61, 0x400000
    s_cbranch_scc1 W_fail
    s_sleep 4
    s_branch W3_pp_93
W3_pk_94:
    s_barrier
    s_lshr_b32 s58, s68, 1
    s_add_u32 s58, s58, 1048576
    buffer_load_dwordx4 v[96:99], v0, s[8:11], s58 offen offset:0 sc1
    buffer_load_dwordx4 v[100:103], v0, s[8:11], s58 offen offset:1024 sc1
    buffer_load_dwordx4 v[104:107], v0, s[8:11], s58 offen offset:2048 sc1
    buffer_load_dwordx4 v[108:111], v0, s[8:11], s58 offen offset:3072 sc1
    s_lshl_b32 s59, s54, 10
    s_add_u32 s58, s58, s59
    buffer_load_dwordx4 v[88:91], v0, s[8:11], s58 offen sc1
    s_waitcnt vmcnt(0)
    v_mfma_f32_16x16x16_bf16 v[12:15], v[96:97], v[156:157], 0
    v_mfma_f32_16x16x16_bf16 v[16:19], v[96:97], v[158:159], 0
    s_nop 3
    v_cvt_pk_bf16_f32 v112, v12, v13
    v_cvt_pk_bf16_f32 v113, v14, v15
    s_nop 1
    v_cvt_pk_bf16_f32 v114, v16, v17
    v_cvt_pk_bf16_f32 v115, v18, v19
    v_mfma_f32_16x16x16_bf16 v[20:23], v[100:101], v[156:157], 0
    v_mfma_f32_16x16x16_bf16 v[24:27], v[100:101], v[158:159], 0
    s_nop 3
    v_cvt_pk_bf16_f32 v116, v20, v21
    v_cvt_pk_bf16_f32 v117, v22, v23
    s_nop 1
    v_cvt_pk_bf16_f32 v118, v24, v25
    v_cvt_pk_bf16_f32 v119, v26, v27
    v_mfma_f32_16x16x16_bf16 v[12:15], v[104:105], v[156:157], 0
    v_mfma_f32_16x16x16_bf16 v[16:19], v[104:105], v[158:159], 0
    s_nop 3
    v_cvt_pk_bf16_f32 v120, v12, v13
    v_cvt_pk_bf16_f32 v121, v14, v15
    s_nop 1
    v_cvt_pk_bf16_f32 v122, v16, v17
    v_cvt_pk_bf16_f32 v123, v18, v19
    v_mfma_f32_16x16x16_bf16 v[20:23], v[108:109], v[156:157], 0
    v_mfma_f32_16x16x16_bf16 v[24:27], v[108:109], v[158:159], 0
    s_nop 3
    v_cvt_pk_bf16_f32 v124, v20, v21
    v_cvt_pk_bf16_f32 v125, v22, v23
    s_nop 1
    v_cvt_pk_bf16_f32 v126, v24, v25
    v_cvt_pk_bf16_f32 v127, v26, v27
    v_mfma_f32_16x16x32_bf16 v[136:139], v[112:115], v[32:35], 0
    v_mfma_f32_16x16x32_bf16 v[136:139], v[116:119], v[36:39], v[136:139]
    v_mfma_f32_16x16x32_bf16 v[136:139], v[120:123], v[40:43], v[136:139]
    v_mfma_f32_16x16x32_bf16 v[136:139], v[124:127], v[44:47], v[136:139]
    v_cvt_pk_bf16_f32 v12, v128, v129
    v_lshlrev_b32 v128, 16, v12
    v_and_b32 v129, 0xffff0000, v12
    v_mul_f32 v128, 0x3db504f3, v128
    v_mul_f32 v129, 0x3db504f3, v129
    v_cvt_pk_bf16_f32 v12, v128, v129
    v_lshlrev_b32 v128, 16, v12
    v_and_b32 v129, 0xffff0000, v12
    v_cvt_pk_bf16_f32 v12, v130, v131
    v_lshlrev_b32 v130, 16, v12
    v_and_b32 v131, 0xffff0000, v12
    v_mul_f32 v130, 0x3db504f3, v130
    v_mul_f32 v131, 0x3db504f3, v131
    v_cvt_pk_bf16_f32 v12, v130, v131
    v_lshlrev_b32 v130, 16, v12
    v_and_b32 v131, 0xffff0000, v12
    v_cvt_pk_bf16_f32 v12, v132, v133
    v_lshlrev_b32 v132, 16, v12
    v_and_b32 v133, 0xffff0000, v12
    v_mul_f32 v132, 0x3db504f3, v132
    v_mul_f32 v133, 0x3db504f3, v133
    v_cvt_pk_bf16_f32 v12, v132, v133
    v_lshlrev_b32 v132, 16, v12
    v_and_b32 v133, 0xffff0000, v12
    v_cvt_pk_bf16_f32 v12, v134, v135
    v_lshlrev_b32 v134, 16, v12
    v_and_b32 v135, 0xffff0000, v12
    v_mul_f32 v134, 0x3db504f3, v134
    v_mul_f32 v135, 0x3db504f3, v135
    v_cvt_pk_bf16_f32 v12, v134, v135
    v_lshlrev_b32 v134, 16, v12
    v_and_b32 v135, 0xffff0000, v12
    v_cvt_pk_bf16_f32 v12, v136, v137
    v_lshlrev_b32 v136, 16, v12
    v_and_b32 v137, 0xffff0000, v12
    v_mul_f32 v136, 0x3db504f3, v136
    v_mul_f32 v137, 0x3db504f3, v137
    v_cvt_pk_bf16_f32 v12, v136, v137
    v_lshlrev_b32 v136, 16, v12
    v_and_b32 v137, 0xffff0000, v12
    v_mov_b32 v12, 0xff800000
    v_cmp_le_i32 vcc, 0, v5
    s_nop 1
    v_cndmask_b32 v128, v12, v128, vcc
    v_cmp_le_i32 vcc, 1, v5
    s_nop 1
    v_cndmask_b32 v129, v12, v129, vcc
    v_cmp_le_i32 vcc, 2, v5
    s_nop 1
    v_cndmask_b32 v130, v12, v130, vcc
    v_cmp_le_i32 vcc, 3, v5
    s_nop 1
    v_cndmask_b32 v131, v12, v131, vcc
    v_cmp_le_i32 vcc, 16, v5
    s_nop 1
    v_cndmask_b32 v132, v12, v132, vcc
    v_cmp_le_i32 vcc, 17, v5
    s_nop 1
    v_cndmask_b32 v133, v12, v133, vcc
    v_cmp_le_i32 vcc, 18, v5
    s_nop 1
    v_cndmask_b32 v134, v12, v134, vcc
    v_cmp_le_i32 vcc, 19, v5
    s_nop 1
    v_cndmask_b32 v135, v12, v135, vcc
    v_max3_f32 v13, v128, v129, v130
    v_max3_f32 v13, v13, v131, v132
    v_max3_f32 v13, v13, v133, v134
    v_max3_f32 v13, v13, v135, v136
    v_max_f32 v13, v13, v137
    v_mov_b32 v14, v13
    s_nop 1
    v_permlane32_swap_b32 v13, v14
    v_max_f32 v13, v13, v14
    v_mov_b32 v14, v13
    s_nop 1
    v_permlane16_swap_b32 v13, v14
    v_max_f32 v13, v13, v14
    v_sub_f32 v128, v128, v13
    v_mul_f32 v128, s71, v128
    v_exp_f32 v128, v128
    v_sub_f32 v129, v129, v13
    v_mul_f32 v129, s71, v129
    v_exp_f32 v129, v129
    v_sub_f32 v130, v130, v13
    v_mul_f32 v130, s71, v130
    v_exp_f32 v130, v130
    v_sub_f32 v131, v131, v13
    v_mul_f32 v131, s71, v131
    v_exp_f32 v131, v131
    v_sub_f32 v132, v132, v13
    v_mul_f32 v132, s71, v132
    v_exp_f32 v132, v132
    v_sub_f32 v133, v133, v13
    v_mul_f32 v133, s71, v133
    v_exp_f32 v133, v133
    v_sub_f32 v134, v134, v13
    v_mul_f32 v134, s71, v134
    v_exp_f32 v134, v134
    v_sub_f32 v135, v135, v13
    v_mul_f32 v135, s71, v135
    v_exp_f32 v135, v135
    v_sub_f32 v136, v136, v13
    v_mul_f32 v136, s71, v136
    v_exp_f32 v136, v136
    v_sub_f32 v137, v137, v13
    v_mul_f32 v137, s71, v137
    v_exp_f32 v137, v137
    v_add_f32 v13, v128, v129
    v_add_f32 v13, v13, v130
    v_add_f32 v13, v13, v131
    v_add_f32 v13, v13, v132
    v_add_f32 v13, v13, v133
    v_add_f32 v13, v13, v134
    v_add_f32 v13, v13, v135
    v_add_f32 v13, v13, v136
    v_add_f32 v13, v13, v137
    v_mov_b32 v14, v13
    s_nop 1
    v_permlane32_swap_b32 v13, v14
    v_add_f32 v13, v13, v14
    v_mov_b32 v14, v13
    s_nop 1
    v_permlane16_swap_b32 v13, v14
    v_add_f32 v13, v13, v14
    v_rcp_f32 v13, v13
    s_nop 0
    v_mul_f32 v128, v128, v13
    v_mul_f32 v129, v129, v13
    v_mul_f32 v130, v130, v13
    v_mul_f32 v131, v131, v13
    v_mul_f32 v132, v132, v13
    v_mul_f32 v133, v133, v13
    v_mul_f32 v134, v134, v13
    v_mul_f32 v135, v135, v13
    v_mul_f32 v136, v136, v13
    v_mul_f32 v137, v137, v13
    v_cvt_pk_bf16_f32 v140, v128, v129
    v_cvt_pk_bf16_f32 v141, v130, v131
    v_cvt_pk_bf16_f32 v142, v132, v133
    v_cvt_pk_bf16_f32 v143, v134, v135
    v_cvt_pk_bf16_f32 v144, v136, v137
    v_cvt_pk_bf16_f32 v147, v136, v137
    s_lshl_b32 s58, s53, 13
    s_add_u32 s58, s58, s69
    s_lshl_b32 s59, s54, 11
    s_add_u32 s58, s58, s59
    v_mfma_f32_16x16x32_bf16 v[148:151], v[80:83], v[140:143], 0
    v_mfma_f32_16x16x32_bf16 v[152:155], v[84:87], v[140:143], 0
    s_nop 3
    v_mfma_f32_16x16x16_bf16 v[148:151], v[90:91], v[144:145], v[148:151]
    v_mfma_f32_16x16x16_bf16 v[152:155], v[90:91], v[146:147], v[152:155]
    s_nop 3
    v_cvt_pk_bf16_f32 v20, v148, v149
    v_cvt_pk_bf16_f32 v21, v150, v151
    s_nop 1
    v_cvt_pk_bf16_f32 v22, v152, v153
    v_cvt_pk_bf16_f32 v23, v154, v155
    buffer_store_dwordx4 v[20:23], v0, s[8:11], s58 offen sc1
    s_waitcnt vmcnt(0)
    s_barrier
    s_cmp_lg_u32 s54, 0
    s_cbranch_scc1 W3_g_96
    s_add_u32 s59, s78, 1
    v_mov_b32 v12, s59
    s_mov_b64 exec, 1
    buffer_store_dword v12, v1, s[8:11], s77 offen sc1
    s_mov_b64 exec, -1
    s_lshl_b32 s58, s52, 12
    s_add_u32 s58, s58, 786432
W3_g_95:
    buffer_load_dword v13, v4, s[8:11], s58 offen sc1
    s_waitcnt vmcnt(0)
    v_cmp_gt_u32 vcc, s59, v13
    s_cbranch_vccz W3_g_96
    s_add_u32 s61, s61, 1
    s_cmp_gt_u32 s61, 0x400000
    s_cbranch_scc1 W_fail
    s_sleep 2
    s_branch W3_g_95
W3_g_96:
    s_barrier
    s_lshl_b32 s58, s54, 16
    s_add_u32 s58, s58, s69
    buffer_load_dwordx4 v[176:179], v0, s[8:11], s58 offen offset:0 sc1
    buffer_load_dwordx4 v[180:183], v0, s[8:11], s58 offen offset:2048 sc1
    s_add_u32 s58, s58, 4096
    buffer_load_dwordx4 v[184:187], v0, s[8:11], s58 offen offset:0 sc1
    buffer_load_dwordx4 v[188:191], v0, s[8:11], s58 offen offset:2048 sc1
    s_add_u32 s58, s58, 4096
    buffer_load_dwordx4 v[192:195], v0, s[8:11], s58 offen offset:0 sc1
    buffer_load_dwordx4 v[196:199], v0, s[8:11], s58 offen offset:2048 sc1
    s_add_u32 s58, s58, 4096
    buffer_load_dwordx4 v[200:203], v0, s[8:11], s58 offen offset:0 sc1
    buffer_load_dwordx4 v[204:207], v0, s[8:11], s58 offen offset:2048 sc1
    s_add_u32 s58, s58, 4096
    buffer_load_dwordx4 v[208:211], v0, s[8:11], s58 offen offset:0 sc1
    buffer_load_dwordx4 v[212:215], v0, s[8:11], s58 offen offset:2048 sc1
    s_add_u32 s58, s58, 4096
    buffer_load_dwordx4 v[216:219], v0, s[8:11], s58 offen offset:0 sc1
    buffer_load_dwordx4 v[220:223], v0, s[8:11], s58 offen offset:2048 sc1
    s_add_u32 s58, s58, 4096
    buffer_load_dwordx4 v[224:227], v0, s[8:11], s58 offen offset:0 sc1
    buffer_load_dwordx4 v[228:231], v0, s[8:11], s58 offen offset:2048 sc1
    s_add_u32 s58, s58, 4096
    buffer_load_dwordx4 v[232:235], v0, s[8:11], s58 offen offset:0 sc1
    buffer_load_dwordx4 v[236:239], v0, s[8:11], s58 offen offset:2048 sc1
    s_add_u32 s58, s58, 4096
    buffer_load_dwordx4 v[240:243], v0, s[8:11], s58 offen offset:0 sc1
    buffer_load_dwordx4 v[244:247], v0, s[8:11], s58 offen offset:2048 sc1
    s_add_u32 s58, s58, 4096
    buffer_load_dwordx4 v[248:251], v0, s[8:11], s58 offen offset:0 sc1
    buffer_load_dwordx4 v[252:255], v0, s[8:11], s58 offen offset:2048 sc1
    s_add_u32 s58, s58, 4096
    buffer_load_dwordx4 v[32:35], v0, s[8:11], s58 offen offset:0 sc1
    buffer_load_dwordx4 v[36:39], v0, s[8:11], s58 offen offset:2048 sc1
    s_add_u32 s58, s58, 4096
    buffer_load_dwordx4 v[40:43], v0, s[8:11], s58 offen offset:0 sc1
    buffer_load_dwordx4 v[44:47], v0, s[8:11], s58 offen offset:2048 sc1
    s_add_u32 s58, s58, 4096
    buffer_load_dwordx4 v[48:51], v0, s[8:11], s58 offen offset:0 sc1
    buffer_load_dwordx4 v[52:55], v0, s[8:11], s58 offen offset:2048 sc1
    s_add_u32 s58, s58, 4096
    buffer_load_dwordx4 v[56:59], v0, s[8:11], s58 offen offset:0 sc1
    buffer_load_dwordx4 v[60:63], v0, s[8:11], s58 offen offset:2048 sc1
    s_add_u32 s58, s58, 4096
    buffer_load_dwordx4 v[64:67], v0, s[8:11], s58 offen offset:0 sc1
    buffer_load_dwordx4 v[68:71], v0, s[8:11], s58 offen offset:2048 sc1
    s_add_u32 s58, s58, 4096
    buffer_load_dwordx4 v[72:75], v0, s[8:11], s58 offen offset:0 sc1
    buffer_load_dwordx4 v[76:79], v0, s[8:11], s58 offen offset:2048 sc1
    s_waitcnt vmcnt(31)
    v_mfma_f32_16x16x32_bf16 v[164:167], a[0:3], v[176:179], 0
    s_waitcnt vmcnt(30)
    v_mfma_f32_16x16x32_bf16 v[168:171], a[4:7], v[180:183], 0
    s_waitcnt vmcnt(29)
    v_mfma_f32_16x16x32_bf16 v[164:167], a[8:11], v[184:187], v[164:167]
    s_waitcnt vmcnt(28)
    v_mfma_f32_16x16x32_bf16 v[168:171], a[12:15], v[188:191], v[168:171]
    s_waitcnt vmcnt(27)
    v_mfma_f32_16x16x32_bf16 v[164:167], a[16:19], v[192:195], v[164:167]
    s_waitcnt vmcnt(26)
    v_mfma_f32_16x16x32_bf16 v[168:171], a[20:23], v[196:199], v[168:171]
    s_waitcnt vmcnt(25)
    v_mfma_f32_16x16x32_bf16 v[164:167], a[24:27], v[200:203], v[164:167]
    s_waitcnt vmcnt(24)
    v_mfma_f32_16x16x32_bf16 v[168:171], a[28:31], v[204:207], v[168:171]
    s_waitcnt vmcnt(23)
    v_mfma_f32_16x16x32_bf16 v[164:167], a[32:35], v[208:211], v[164:167]
    s_waitcnt vmcnt(22)
    v_mfma_f32_16x16x32_bf16 v[168:171], a[36:39], v[212:215], v[168:171]
    s_waitcnt vmcnt(21)
    v_mfma_f32_16x16x32_bf16 v[164:167], a[40:43], v[216:219], v[164:167]
    s_waitcnt vmcnt(20)
    v_mfma_f32_16x16x32_bf16 v[168:171], a[44:47], v[220:223], v[168:171]
    s_waitcnt vmcnt(19)
    v_mfma_f32_16x16x32_bf16 v[164:167], a[48:51], v[224:227], v[164:167]
    s_waitcnt vmcnt(18)
    v_mfma_f32_16x16x32_bf16 v[168:171], a[52:55], v[228:231], v[168:171]
    s_waitcnt vmcnt(17)
    v_mfma_f32_16x16x32_bf16 v[164:167], a[56:59], v[232:235], v[164:167]
    s_waitcnt vmcnt(16)
    v_mfma_f32_16x16x32_bf16 v[168:171], a[60:63], v[236:239], v[168:171]
    s_waitcnt vmcnt(15)
    v_mfma_f32_16x16x32_bf16 v[164:167], a[64:67], v[240:243], v[164:167]
    s_waitcnt vmcnt(14)
    v_mfma_f32_16x16x32_bf16 v[168:171], a[68:71], v[244:247], v[168:171]
    s_waitcnt vmcnt(13)
    v_mfma_f32_16x16x32_bf16 v[164:167], a[72:75], v[248:251], v[164:167]
    s_waitcnt vmcnt(12)
    v_mfma_f32_16x16x32_bf16 v[168:171], a[76:79], v[252:255], v[168:171]
    s_waitcnt vmcnt(11)
    v_mfma_f32_16x16x32_bf16 v[164:167], a[80:83], v[32:35], v[164:167]
    s_waitcnt vmcnt(10)
    v_mfma_f32_16x16x32_bf16 v[168:171], a[84:87], v[36:39], v[168:171]
    s_waitcnt vmcnt(9)
    v_mfma_f32_16x16x32_bf16 v[164:167], a[88:91], v[40:43], v[164:167]
    s_waitcnt vmcnt(8)
    v_mfma_f32_16x16x32_bf16 v[168:171], a[92:95], v[44:47], v[168:171]
    s_waitcnt vmcnt(7)
    v_mfma_f32_16x16x32_bf16 v[164:167], a[96:99], v[48:51], v[164:167]
    s_waitcnt vmcnt(6)
    v_mfma_f32_16x16x32_bf16 v[168:171], a[100:103], v[52:55], v[168:171]
    s_waitcnt vmcnt(5)
    v_mfma_f32_16x16x32_bf16 v[164:167], a[104:107], v[56:59], v[164:167]
    s_waitcnt vmcnt(4)
    v_mfma_f32_16x16x32_bf16 v[168:171], a[108:111], v[60:63], v[168:171]
    s_waitcnt vmcnt(3)
    v_mfma_f32_16x16x32_bf16 v[164:167], a[112:115], v[64:67], v[164:167]
    s_waitcnt vmcnt(2)
    v_mfma_f32_16x16x32_bf16 v[168:171], a[116:119], v[68:71], v[168:171]
    s_waitcnt vmcnt(1)
    v_mfma_f32_16x16x32_bf16 v[164:167], a[120:123], v[72:75], v[164:167]
    s_waitcnt vmcnt(0)
    v_mfma_f32_16x16x32_bf16 v[168:171], a[124:127], v[76:79], v[168:171]
    s_nop 7
    v_add_f32 v164, v164, v168
    v_add_f32 v165, v165, v169
    v_add_f32 v166, v166, v170
    v_add_f32 v167, v167, v171
    ds_write_b128 v7, v[160:163] offset:0
    ds_write_b128 v7, v[164:167] offset:1024
    s_waitcnt lgkmcnt(0)
    s_barrier
    s_cmp_ge_u32 s54, 1
    s_cbranch_scc1 W3_nofin_98
    ds_read_b128 v[176:179], v0 offset:0
    ds_read_b128 v[180:183], v0 offset:1024
    ds_read_b128 v[184:187], v0 offset:4096
    ds_read_b128 v[188:191], v0 offset:5120
    ds_read_b128 v[192:195], v0 offset:8192
    ds_read_b128 v[196:199], v0 offset:9216
    ds_read_b128 v[200:203], v0 offset:12288
    ds_read_b128 v[204:207], v0 offset:13312
    s_waitcnt lgkmcnt(0)
    v_add_f32 v176, v176, v184
    v_add_f32 v192, v192, v200
    v_add_f32 v176, v176, v192
    v_add_f32 v177, v177, v185
    v_add_f32 v193, v193, v201
    v_add_f32 v177, v177, v193
    v_add_f32 v178, v178, v186
    v_add_f32 v194, v194, v202
    v_add_f32 v178, v178, v194
    v_add_f32 v179, v179, v187
    v_add_f32 v195, v195, v203
    v_add_f32 v179, v179, v195
    v_add_f32 v180, v180, v188
    v_add_f32 v196, v196, v204
    v_add_f32 v180, v180, v196
    v_add_f32 v181, v181, v189
    v_add_f32 v197, v197, v205
    v_add_f32 v181, v181, v197
    v_add_f32 v182, v182, v190
    v_add_f32 v198, v198, v206
    v_add_f32 v182, v182, v198
    v_add_f32 v183, v183, v191
    v_add_f32 v199, v199, v207
    v_add_f32 v183, v183, v199
    v_cvt_pk_bf16_f32 v14, v176, v177
    v_cvt_pk_bf16_f32 v15, v180, v181
    v_lshlrev_b32 v16, 16, v15
    v_and_b32 v17, 0xffff0000, v15
    v_lshlrev_b32 v18, 16, v28
    v_and_b32 v19, 0xffff0000, v28
    v_add_f32 v16, v16, v18
    v_add_f32 v17, v17, v19
    v_cvt_pk_bf16_f32 v15, v16, v17
    v_lshlrev_b32 v16, 16, v15
    v_and_b32 v17, 0xffff0000, v15
    v_lshlrev_b32 v18, 16, v14
    v_and_b32 v19, 0xffff0000, v14
    v_add_f32 v16, v16, v18
    v_add_f32 v17, v17, v19
    v_cvt_pk_bf16_f32 v20, v16, v17
    v_cvt_pk_bf16_f32 v14, v178, v179
    v_cvt_pk_bf16_f32 v15, v182, v183
    v_lshlrev_b32 v16, 16, v15
    v_and_b32 v17, 0xffff0000, v15
    v_lshlrev_b32 v18, 16, v29
    v_and_b32 v19, 0xffff0000, v29
    v_add_f32 v16, v16, v18
    v_add_f32 v17, v17, v19
    v_cvt_pk_bf16_f32 v15, v16, v17
    v_lshlrev_b32 v16, 16, v15
    v_and_b32 v17, 0xffff0000, v15
    v_lshlrev_b32 v18, 16, v14
    v_and_b32 v19, 0xffff0000, v14
    v_add_f32 v16, v16, v18
    v_add_f32 v17, v17, v19
    v_cvt_pk_bf16_f32 v21, v16, v17
    buffer_store_dwordx2 v[20:21], v6, s[48:51], s76 offen
W3_nofin_98:
    s_barrier
    s_add_u32 s78, s78, 7
    s_cmp_lt_u32 s78, 128
    s_cbranch_scc1 W3_seg
W3_done:
    s_endpgm
W_fail:
    v_mov_b32 v10, 0x100
    s_mov_b32 s58, 36
    s_mov_b64 exec, 1
    buffer_atomic_add v10, v1, s[12:15], s58 offen
    s_waitcnt vmcnt(0)
    s_endpgm
L_exit:
    s_endpgm
.section .rodata,"a"
.p2align 6
.amdhsa_kernel parallel_sum__memory_aug_recurrent_mem_tr__dense_activation_silu__prompt_kernel
  .amdhsa_next_free_vgpr 512
  .amdhsa_next_free_sgpr 102
  .amdhsa_accum_offset 256
  .amdhsa_group_segment_fixed_size 0
  .amdhsa_kernarg_size 104
  .amdhsa_user_sgpr_count 2
  .amdhsa_user_sgpr_kernarg_segment_ptr 1
  .amdhsa_system_sgpr_workgroup_id_x 1
.end_amdhsa_kernel
```
